```python
import torch

def _softmax(x, axis=-1):
    return torch.softmax(x, dim=axis)
def _gelu(x):
    return torch.nn.functional.gelu(x, approximate="tanh")
def _silu(x):
    return torch.nn.functional.silu(x)
def _sigmoid(x):
    return torch.sigmoid(x)
def _layernorm(x, axis=-1, eps=1e-5):
    m = x.mean(dim=axis, keepdim=True)
    v = x.var(dim=axis, keepdim=True, unbiased=False)
    return (x - m) / torch.sqrt(v + eps)
def _scatter_add(tgt, idx, src, axis=0):
    return tgt.clone().index_add_(axis, idx, src)
def _segment_sum(src, seg, n):
    out = torch.zeros((n,) + src.shape[1:], dtype=src.dtype)
    return out.index_add_(0, seg, src)
def _pad(x, pw):
    flat = tuple(v for pair in reversed(pw) for v in pair)
    return torch.nn.functional.pad(x, flat)

kernel_name = 'sequential_preLN__ssm_conv_s4__glu_gated_reglu__prompt'

def setup_inputs():

    _w = (lambda a: (lambda t: t.to(torch.bfloat16) if t.is_floating_point() else t)(torch.as_tensor(a)))
    def _A_setup():
        B, L, D, N = 1, 2048, 640, 128
        A_re = -(lambda _x: torch.exp(torch.as_tensor(_x)))((lambda *s: torch.randn(*s, dtype=torch.bfloat16) * 6.4)(D, N))
        A_im = torch.pi * (lambda *s: torch.randn(*s, dtype=torch.bfloat16) * 0.05)(D, N)
        B_re = (lambda *s: torch.randn(*s, dtype=torch.bfloat16) * 0.05)(D, N)
        B_im = (lambda *s: torch.randn(*s, dtype=torch.bfloat16) * 0.05)(D, N)
        C_re = (lambda *s: torch.randn(*s, dtype=torch.bfloat16) * 0.05)(D, N)
        C_im = (lambda *s: torch.randn(*s, dtype=torch.bfloat16) * 0.05)(D, N)
        log_dt = (lambda *s: torch.randn(*s, dtype=torch.bfloat16) * 0.05)(D) * 0.5 - 4.0
        Dskip = (lambda *s: torch.randn(*s, dtype=torch.bfloat16) * 0.05)(D)
        return {
            "u": _w((lambda *s: torch.randn(*s, dtype=torch.bfloat16) * 0.05)(B, L, D)),
            "A_re": _w(A_re),
            "A_im": _w(A_im),
            "B_re": _w(B_re),
            "B_im": _w(B_im),
            "C_re": _w(C_re),
            "C_im": _w(C_im),
            "log_dt": _w(log_dt),
            "Dskip": _w(Dskip),
        }
    _A_in = _A_setup()

    def _B_setup():
        B, S, D, F = 1, 2048, 640, 1728
        return {
            "x": _w((lambda *s: torch.randn(*s, dtype=torch.bfloat16) * 0.05)(B, S, D)),
            "W_gate": _w((lambda *s: torch.randn(*s, dtype=torch.bfloat16) * 0.4)(D, F) * (2.0 / D) ** 0.5),
            "W_up": _w((lambda *s: torch.randn(*s, dtype=torch.bfloat16) * 0.4)(D, F) * (2.0 / D) ** 0.5),
            "W_down": _w((lambda *s: torch.randn(*s, dtype=torch.bfloat16) * 0.4)(F, D) * (1.0 / F) ** 0.5),
        }
    _B_in = _B_setup()

    return {
        "A_u": _A_in["u"],
        "A_A_re": _A_in["A_re"],
        "A_A_im": _A_in["A_im"],
        "A_B_re": _A_in["B_re"],
        "A_B_im": _A_in["B_im"],
        "A_C_re": _A_in["C_re"],
        "A_C_im": _A_in["C_im"],
        "A_log_dt": _A_in["log_dt"],
        "A_Dskip": _A_in["Dskip"],
        "B_x": _B_in["x"],
        "B_W_gate": _B_in["W_gate"],
        "B_W_up": _B_in["W_up"],
        "B_W_down": _B_in["W_down"],
    }

def reference(A_u, A_A_re, A_A_im, A_B_re, A_B_im, A_C_re, A_C_im, A_log_dt, A_Dskip, B_x, B_W_gate, B_W_up, B_W_down):
    def _A_ref(u, A_re, A_im, B_re, B_im, C_re, C_im, log_dt, Dskip):
        Bsz, L, D = u.shape
        dt = torch.exp(log_dt)[:, None]
        A = A_re + 1j * A_im
        Bc = B_re + 1j * B_im
        Cc = C_re + 1j * C_im
        logdA = dt * A
        dB = dt * Bc
        l = (lambda x, dt: x.to(dt))(torch.arange(L), A_re.dtype)
        P = torch.exp(logdA[:, :, None] * l[None, None, :])
        K = torch.einsum("dn,dnl,dn->dl", Cc, P, dB).real
        L2 = 2 * L
        Kp = _pad(K, ((0, 0), (0, L)))
        up = (lambda x, *d: x.permute(*d))(u, 0, 2, 1)
        up = _pad(up, ((0, 0), (0, 0), (0, L)))
        Kf = (lambda x, axes=(-2,-1): torch.fft.rfft2(x.float(), dim=axes))(Kp[:, None, :], axes=(-2, -1))
        Uf = (lambda x, axes=(-2,-1): torch.fft.rfft2(x.float(), dim=axes))(up[:, :, None, :], axes=(-2, -1))
        Yf = Uf * Kf[None, :, :, :]
        y = (lambda x, s, axes=(-2,-1): torch.fft.irfft2(x, s=s, dim=axes).to(torch.bfloat16))(Yf, (1, L2), axes=(-2, -1))[:, :, 0, :L]
        y = (lambda x, *d: x.permute(*d))(y, 0, 2, 1) + u * Dskip[None, None, :]
        return y

    def _B_ref(x, W_gate, W_up, W_down):
        gate = torch.einsum("bsd,df->bsf", x, W_gate)
        up = torch.einsum("bsd,df->bsf", x, W_up)
        gate = gate * (lambda x, dt: x.to(dt))(gate > 0, gate.dtype)
        h = gate * up
        return torch.einsum("bsf,fd->bsd", h, W_down)

    x = A_u
    h = x + _A_ref(_layernorm(x, axis=-1), A_A_re, A_A_im, A_B_re, A_B_im, A_C_re, A_C_im, A_log_dt, A_Dskip)
    h2 = h + _B_ref(_layernorm(h, axis=-1), B_W_gate, B_W_up, B_W_down)
    return h2
```

```asm
; @launch grid=(256,1,1) block=(256,1,1) lds=163840
.amdgcn_target "amdgcn-amd-amdhsa--gfx950"
.text
.globl sequential_preLN__ssm_conv_s4__glu_gated_reglu__prompt_kernel
.p2align 8
.type sequential_preLN__ssm_conv_s4__glu_gated_reglu__prompt_kernel,@function
sequential_preLN__ssm_conv_s4__glu_gated_reglu__prompt_kernel:
    s_load_dwordx16 s[16:31], s[0:1], 0
    s_load_dwordx16 s[32:47], s[0:1], 64
    s_lshl_b32 s61, s2, 10
    v_lshl_add_u32 v3, v0, 2, s61
    s_cmp_ge_u32 s2, 160
    s_cbranch_scc1 L_help
    v_lshrrev_b32 v2, 6, v0
    v_and_b32 v1, 63, v0
    v_readfirstlane_b32 s48, v2
    s_and_b32 s49, s2, 7
    s_getpc_b64 s[76:77]
L_pc1:
    s_sub_u32 s76, s76, L_pc1-sequential_preLN__ssm_conv_s4__glu_gated_reglu__prompt_kernel
    s_subb_u32 s77, s77, 0
    s_lshr_b32 s55, s2, 3
    s_lshl_b32 s55, s55, 2
    s_add_u32 s55, s55, s48
    s_and_b32 s55, s55, 31
    s_mul_i32 s3, s55, (((L_code_end-sequential_preLN__ssm_conv_s4__glu_gated_reglu__prompt_kernel)+4095)/4096)*128
    s_add_u32 s3, s3, sequential_preLN__ssm_conv_s4__glu_gated_reglu__prompt_kernel-sequential_preLN__ssm_conv_s4__glu_gated_reglu__prompt_kernel
    v_min_u32 v26, (((L_code_end-sequential_preLN__ssm_conv_s4__glu_gated_reglu__prompt_kernel)+4095)/4096)-1, v1
    v_lshl_add_u32 v26, v26, 7, s3
    s_mov_b32 s3, L_code_end-sequential_preLN__ssm_conv_s4__glu_gated_reglu__prompt_kernel-4
    v_min_u32 v26, s3, v26
    global_load_dword a254, v26, s[76:77]
    s_mov_b32 s50, s2
    s_cmp_lt_u32 s50, 128
    s_cselect_b32 s60, 0, 1073741824
    v_lshl_add_u32 v2, v1, 4, s60
    s_mul_i32 s57, s50, 20480
    s_mul_i32 s58, s48, 5120
    s_add_u32 s57, s57, s58
    s_mul_i32 s58, s48, 5184
    s_add_u32 s58, s58, 143104
    s_mov_b32 m0, s58
    s_mov_b32 s6, 2621440
    s_lshl_b32 s59, s50, 3
    s_mov_b32 s7, 0x20000
    s_mov_b32 s10, 24117248
    s_mov_b32 s11, 0x20000
    s_movk_i32 s14, 128
    s_mov_b32 s15, 0x20000
    s_waitcnt lgkmcnt(0)
    s_load_dwordx2 s[62:63], s[30:31], s59
    s_load_dwordx2 s[64:65], s[32:33], s59
    global_load_dword v4, v3, s[18:19] nt
    global_load_dword v5, v3, s[20:21] nt
    global_load_dword v6, v3, s[22:23] nt
    global_load_dword v7, v3, s[24:25] nt
    global_load_dword v8, v3, s[26:27] nt
    global_load_dword v9, v3, s[28:29] nt
    s_mov_b32 s4, s16
    s_mov_b32 s5, s17
    s_mov_b32 s8, s46
    s_mov_b32 s9, s47
    s_mov_b32 s12, s44
    s_mov_b32 s13, s45
    buffer_load_dwordx4 v2, s[4:7], s57 offen offset:0 nt lds
    buffer_load_dwordx4 v2, s[4:7], s57 offen offset:1024 nt lds
    s_mov_b32 exec_hi, 0
    buffer_load_dwordx4 v2, s[4:7], s57 offen offset:2048 nt lds
    s_mov_b32 exec_hi, -1
    s_add_u32 m0, s58, 2592
    s_addk_i32 s57, 2560
    buffer_load_dwordx4 v2, s[4:7], s57 offen offset:0 nt lds
    buffer_load_dwordx4 v2, s[4:7], s57 offen offset:1024 nt lds
    s_mov_b32 exec_hi, 0
    buffer_load_dwordx4 v2, s[4:7], s57 offen offset:2048 nt lds
    s_mov_b32 exec_hi, -1
    s_branch L_conv
L_help:
    s_cmp_ge_u32 s2, 256
    s_cbranch_scc1 L_exit
    v_lshrrev_b32 v2, 6, v0
    v_and_b32_e64 v1, 63, v0
    v_readfirstlane_b32 s48, v2
    s_and_b32 s49, s2, 7
    s_getpc_b64 s[76:77]
L_pc2:
    s_sub_u32 s76, s76, L_pc2-sequential_preLN__ssm_conv_s4__glu_gated_reglu__prompt_kernel
    s_subb_u32 s77, s77, 0
    s_lshr_b32 s55, s2, 3
    s_lshl_b32 s55, s55, 2
    s_add_u32 s55, s55, s48
    s_and_b32 s55, s55, 31
    s_mul_i32 s3, s55, (((L_code_end-sequential_preLN__ssm_conv_s4__glu_gated_reglu__prompt_kernel)+4095)/4096)*128
    s_add_u32 s3, s3, sequential_preLN__ssm_conv_s4__glu_gated_reglu__prompt_kernel-sequential_preLN__ssm_conv_s4__glu_gated_reglu__prompt_kernel
    v_min_u32 v26, (((L_code_end-sequential_preLN__ssm_conv_s4__glu_gated_reglu__prompt_kernel)+4095)/4096)-1, v1
    v_lshl_add_u32 v26, v26, 7, s3
    s_mov_b32 s3, L_code_end-sequential_preLN__ssm_conv_s4__glu_gated_reglu__prompt_kernel-4
    v_min_u32_e64 v26, s3, v26
    global_load_dword a254, v26, s[76:77]
    s_mov_b32 s7, 0x20000
    s_mov_b32 s10, 24117248
    s_mov_b32 s11, 0x20000
    s_movk_i32 s14, 128
    s_mov_b32 s15, 0x20000
    s_waitcnt lgkmcnt(0)
    s_mov_b32 s4, s16
    s_mov_b32 s5, s17
    s_mov_b32 s8, s46
    s_mov_b32 s9, s47
    s_mov_b32 s12, s44
    s_mov_b32 s13, s45
    s_sub_u32 s2, s2, 160
    s_cmp_lg_u32 s2, 0
    s_cbranch_scc1 L_noinit
    s_cmp_lg_u32 s48, 3
    s_cbranch_scc1 L_noinit
    v_mov_b32_e64 v4, 0
    s_mov_b32 s56, 32768
    buffer_load_dwordx2 v[8:9], v4, s[8:11], s56 offen sc1
    v_lshlrev_b32 v10, 4, v1
    s_waitcnt vmcnt(0)
    v_add_co_u32 v12, vcc, 1, v8
    s_nop 1
    v_addc_co_u32 v13, vcc, 0, v9, vcc
    v_not_b32 v14, v12
    v_not_b32_e64 v15, v13
    buffer_store_dwordx4 v[12:15], v10, s[12:15], 0 offen sc1
    s_mov_b64 exec, 1
    buffer_store_dwordx2 v[12:13], v4, s[8:11], s56 offen sc1
    s_mov_b64 exec, -1
L_noinit:
    s_mov_b32 s4, s40
    s_mov_b32 s5, s41
    s_mov_b32 s6, 2211840
    s_mov_b32 s7, 0x20000
    s_mul_i32 s50, s48, 20480
    s_mul_i32 s56, s2, 3
    s_add_u32 s56, s56, s48
    s_cmp_lt_u32 s48, 3
    s_cselect_b32 s56, s56, 999
    s_cmp_lt_u32 s56, 270
    s_cselect_b32 s76, 0, 1073741824
    s_cmp_lt_u32 s56, 280
    s_cselect_b32 s66, 0, 1073741824
    s_cselect_b32 s56, s56, 0
    s_mul_i32 s60, s56, 13108
    s_lshr_b32 s60, s60, 16
    s_mul_i32 s59, s60, 5
    s_sub_u32 s59, s56, s59
    s_cmp_ge_u32 s60, 31
    s_cbranch_scc1 L_w2late
    s_lshr_b32 s61, s60, 1
    s_mul_i32 s61, s61, 112
    s_and_b32 s62, s60, 1
    s_lshl_b32 s62, s62, 5
    s_add_u32 s61, s61, s62
    s_add_u32 s62, s61, 16
    s_and_b32 s63, s60, 3
    s_lshr_b32 s64, s60, 2
    s_branch L_w2go
L_w2late:
    s_sub_u32 s60, s60, 31
    s_mul_i32 s61, s60, 112
    s_add_u32 s61, s61, 64
    s_add_u32 s62, s61, 16
    s_nop 0
    s_sub_u32 s70, s60, 15
    s_mul_i32 s64, s70, 224
    s_add_u32 s64, s64, 96
    s_add_u32 s65, s64, 112
    s_min_u32 s65, s65, 1712
    s_bitcmp1_b32 s70, 0
    s_cselect_b32 s71, s65, s64
    s_cselect_b32 s65, s64, s65
    s_add_u32 s70, s70, 16
    s_cmp_lt_u32 s60, 15
    s_cselect_b32 s61, s61, s71
    s_cselect_b32 s62, s62, s65
    s_cselect_b32 s70, s60, s70
    s_and_b32 s63, s70, 3
    s_lshr_b32 s64, s70, 2
    s_add_u32 s64, s64, 8
    s_cmp_eq_u32 s60, 23
    s_cselect_b32 s63, 3, s63
    s_cselect_b32 s64, 11, s64
    s_cmp_eq_u32 s60, 24
    s_cselect_b32 s63, 3, s63
    s_cselect_b32 s64, 7, s64
L_w2go:
    v_lshrrev_b32 v4, 4, v1
    v_and_b32 v5, 15, v1
    v_lshlrev_b32 v6, 1, v4
    v_xor_b32_e64 v6, v6, v5
    v_mul_u32_u24 v7, 1280, v4
    v_lshl_add_u32 v24, v6, 4, v7
    v_add_u32 v24, s76, v24
    v_xor_b32 v25, 0x80, v24
    s_lshl_b32 s65, s59, 8
    s_mul_i32 s61, s61, 1280
    s_mul_i32 s62, s62, 1280
    s_add_u32 s61, s61, s65
    s_add_u32 s62, s62, s65
    s_mov_b32 s54, s61
    s_mov_b32 s53, s62
    s_mov_b32 s52, s4
    s_mov_b32 s51, s5
    s_lshl_b32 s56, s2, 2
    s_add_u32 s56, s56, s48
    s_cmp_lt_u32 s56, 378
    s_cselect_b32 s67, 0, 1073741824
    s_cselect_b32 s56, s56, 0
    s_mul_i32 s60, s56, 9363
    s_lshr_b32 s60, s60, 16
    s_mul_i32 s68, s60, 7
    s_sub_u32 s68, s56, s68
    s_and_b32 s69, s60, 1
    s_lshr_b32 s60, s60, 1
    s_cmp_eq_u32 s69, 0
    s_cselect_b32 s4, s36, s38
    s_cselect_b32 s5, s37, s39
    v_lshrrev_b32 v6, 3, v1
    v_and_b32 v7, 7, v1
    v_bfe_u32 v8, v1, 4, 1
    v_lshlrev_b32 v8, 1, v8
    v_xor_b32 v7, v7, v8
    v_mul_u32_u24 v6, 3456, v6
    v_lshl_add_u32 v12, v7, 4, v6
    v_add_u32 v12, s67, v12
    v_xor_b32 v13, 0x40, v12
    s_cmp_eq_u32 s68, 6
    s_cselect_b32 s56, 1073741824, 0
    v_or_b32 v14, s56, v12
    v_or_b32 v15, s56, v13
    s_mul_i32 s61, s68, 331776
    s_lshl_b32 s62, s60, 7
    s_add_u32 s61, s61, s62
    s_mul_i32 s63, s63, 14
    s_lshl_b32 s56, s59, 3
    s_mul_i32 s57, s56, 205
    s_lshr_b32 s57, s57, 10
    s_mul_i32 s62, s57, 5
    s_sub_u32 s56, s56, s62
    s_cmp_lt_u32 s64, 12
    s_cselect_b32 s77, 3, 1
    s_cmp_lt_u32 s64, 8
    s_cselect_b32 s77, 7, s77
    s_mul_i32 s62, s57, 1
    s_sub_u32 s70, s64, s62
    s_and_b32 s70, s70, s77
    s_andn2_b32 s71, s64, s77
    s_or_b32 s70, s70, s71
    s_mul_i32 s71, s57, 56
    s_add_u32 s71, s71, s63
    s_add_u32 s71, s71, s70
    s_mul_i32 s71, s71, 5
    s_add_u32 s71, s71, s56
    s_lshl_b32 s71, s71, 10
    s_add_u32 s73, s71, 11534336
    s_add_u32 s57, s57, 1
    s_mul_i32 s62, s57, 1
    s_sub_u32 s70, s64, s62
    s_and_b32 s70, s70, s77
    s_andn2_b32 s71, s64, s77
    s_or_b32 s70, s70, s71
    s_mul_i32 s71, s57, 56
    s_add_u32 s71, s71, s63
    s_add_u32 s71, s71, s70
    s_mul_i32 s71, s71, 5
    s_add_u32 s71, s71, s56
    s_lshl_b32 s71, s71, 10
    s_add_u32 s74, s71, 11529216
    s_add_u32 s57, s57, 1
    s_mul_i32 s62, s57, 1
    s_sub_u32 s70, s64, s62
    s_and_b32 s70, s70, s77
    s_andn2_b32 s71, s64, s77
    s_or_b32 s70, s70, s71
    s_mul_i32 s71, s57, 56
    s_add_u32 s71, s71, s63
    s_add_u32 s71, s71, s70
    s_mul_i32 s71, s71, 5
    s_add_u32 s71, s71, s56
    s_lshl_b32 s71, s71, 10
    s_add_u32 s75, s71, 11524096
    s_add_u32 s57, s57, 1
    s_cmp_ge_u32 s56, 5
    s_cselect_b32 s71, s74, s73
    s_cmp_ge_u32 s56, 10
    s_cselect_b32 s71, s75, s71
    s_add_u32 s16, s71, 0
    s_cmp_ge_u32 s56, 4
    s_cselect_b32 s71, s74, s73
    s_cmp_ge_u32 s56, 9
    s_cselect_b32 s71, s75, s71
    s_add_u32 s17, s71, 1024
    s_cmp_ge_u32 s56, 3
    s_cselect_b32 s71, s74, s73
    s_cmp_ge_u32 s56, 8
    s_cselect_b32 s71, s75, s71
    s_add_u32 s18, s71, 2048
    s_cmp_ge_u32 s56, 2
    s_cselect_b32 s71, s74, s73
    s_cmp_ge_u32 s56, 7
    s_cselect_b32 s71, s75, s71
    s_add_u32 s19, s71, 3072
    s_cmp_ge_u32 s56, 1
    s_cselect_b32 s71, s74, s73
    s_cmp_ge_u32 s56, 6
    s_cselect_b32 s71, s75, s71
    s_add_u32 s20, s71, 4096
    s_cmp_ge_u32 s56, 0
    s_cselect_b32 s71, s74, s73
    s_cmp_ge_u32 s56, 5
    s_cselect_b32 s71, s75, s71
    s_add_u32 s21, s71, 5120
    s_cmp_ge_u32 s56, 0
    s_cselect_b32 s71, s74, s73
    s_cmp_ge_u32 s56, 4
    s_cselect_b32 s71, s75, s71
    s_add_u32 s22, s71, 6144
    s_cmp_ge_u32 s56, 0
    s_cselect_b32 s71, s74, s73
    s_cmp_ge_u32 s56, 3
    s_cselect_b32 s71, s75, s71
    s_add_u32 s23, s71, 7168
    v_bfe_u32 v6, v1, 2, 2
    v_and_b32_e64 v11, 1, v4
    v_lshl_add_u32 v11, v11, 2, v6
    v_lshlrev_b32_e64 v11, 5, v11
    v_lshl_add_u32 v11, v6, 8, v11
    v_lshl_add_u32 v11, v4, 10, v11
    v_and_b32_e64 v6, 3, v1
    v_lshl_add_u32 v11, v6, 3, v11
    v_add_u32 v11, s50, v11
    v_lshlrev_b32 v9, 4, v1
    v_add_u32 v10, s66, v9
    s_mov_b32 s70, s61
    s_mov_b32 s71, s4
    s_mov_b32 s72, s5
    s_mov_b32 s61, s54
    s_mov_b32 s62, s53
    s_mov_b32 s4, s52
    s_mov_b32 s5, s51
    s_add_u32 m0, s50, 0
    s_nop 0
    buffer_load_dwordx4 v24, s[4:7], s61 offen nt lds
    s_add_u32 m0, s50, 1024
    s_add_u32 s61, s61, 5120
    buffer_load_dwordx4 v25, s[4:7], s61 offen nt lds
    s_add_u32 m0, s50, 2048
    s_add_u32 s61, s61, 5120
    buffer_load_dwordx4 v24, s[4:7], s61 offen nt lds
    s_add_u32 m0, s50, 3072
    s_add_u32 s61, s61, 5120
    buffer_load_dwordx4 v25, s[4:7], s61 offen nt lds
    s_add_u32 m0, s50, 4096
    s_nop 0
    buffer_load_dwordx4 v24, s[4:7], s62 offen nt lds
    s_add_u32 m0, s50, 5120
    s_addk_i32 s62, 5120
    buffer_load_dwordx4 v25, s[4:7], s62 offen nt lds
    s_add_u32 m0, s50, 6144
    s_add_u32 s62, s62, 5120
    buffer_load_dwordx4 v24, s[4:7], s62 offen nt lds
    s_add_u32 m0, s50, 7168
    s_add_u32 s62, s62, 5120
    buffer_load_dwordx4 v25, s[4:7], s62 offen nt lds
    s_mov_b32 s61, s70
    s_mov_b32 s4, s71
    s_mov_b32 s5, s72
    s_waitcnt vmcnt(0)
    v_xor_b32_e64 v98, 0, v11
    ds_read_b64_tr_b16 v[64:65], v98
    ds_read_b64_tr_b16 v[66:67], v98 offset:4096
    v_xor_b32_e64 v99, 32, v11
    ds_read_b64_tr_b16 v[68:69], v99
    ds_read_b64_tr_b16 v[70:71], v99 offset:4096
    v_xor_b32_e64 v100, 64, v11
    ds_read_b64_tr_b16 v[72:73], v100
    ds_read_b64_tr_b16 v[74:75], v100 offset:4096
    v_xor_b32 v101, 96, v11
    ds_read_b64_tr_b16 v[76:77], v101
    ds_read_b64_tr_b16 v[78:79], v101 offset:4096
    v_xor_b32 v102, 128, v11
    ds_read_b64_tr_b16 v[80:81], v102
    ds_read_b64_tr_b16 v[82:83], v102 offset:4096
    v_xor_b32 v103, 160, v11
    ds_read_b64_tr_b16 v[84:85], v103
    ds_read_b64_tr_b16 v[86:87], v103 offset:4096
    v_xor_b32 v104, 192, v11
    ds_read_b64_tr_b16 v[88:89], v104
    ds_read_b64_tr_b16 v[90:91], v104 offset:4096
    v_xor_b32 v105, 224, v11
    ds_read_b64_tr_b16 v[92:93], v105
    ds_read_b64_tr_b16 v[94:95], v105 offset:4096
    s_waitcnt lgkmcnt(14)
    buffer_store_dwordx4 v[64:67], v10, s[8:11], s16 offen sc1
    s_waitcnt lgkmcnt(12)
    buffer_store_dwordx4 v[68:71], v10, s[8:11], s17 offen sc1
    s_waitcnt lgkmcnt(10)
    buffer_store_dwordx4 v[72:75], v10, s[8:11], s18 offen sc1
    s_waitcnt lgkmcnt(8)
    buffer_store_dwordx4 v[76:79], v10, s[8:11], s19 offen sc1
    s_waitcnt lgkmcnt(6)
    buffer_store_dwordx4 v[80:83], v10, s[8:11], s20 offen sc1
    s_waitcnt lgkmcnt(4)
    buffer_store_dwordx4 v[84:87], v10, s[8:11], s21 offen sc1
    s_waitcnt lgkmcnt(2)
    buffer_store_dwordx4 v[88:91], v10, s[8:11], s22 offen sc1
    s_waitcnt lgkmcnt(0)
    buffer_store_dwordx4 v[92:95], v10, s[8:11], s23 offen sc1
    v_mov_b32 v26, 0
    buffer_load_dwordx4 v[28:31], v26, s[12:15], 0 offen sc1
    s_add_u32 m0, s50, 8192
    s_nop 0
    buffer_load_dwordx4 v12, s[4:7], s61 offen nt lds
    s_add_u32 m0, s50, 9216
    s_add_u32 s61, s61, 27648
    buffer_load_dwordx4 v13, s[4:7], s61 offen nt lds
    s_add_u32 m0, s50, 10240
    s_add_u32 s61, s61, 27648
    buffer_load_dwordx4 v12, s[4:7], s61 offen nt lds
    s_add_u32 m0, s50, 11264
    s_add_u32 s61, s61, 27648
    buffer_load_dwordx4 v13, s[4:7], s61 offen nt lds
    s_add_u32 m0, s50, 12288
    s_add_u32 s61, s61, 27648
    buffer_load_dwordx4 v12, s[4:7], s61 offen nt lds
    s_add_u32 m0, s50, 13312
    s_add_u32 s61, s61, 27648
    buffer_load_dwordx4 v13, s[4:7], s61 offen nt lds
    s_lshl_b32 s62, s60, 2
    s_add_u32 s62, s62, 0
    s_mul_i32 s63, s62, 9363
    s_lshr_b32 s63, s63, 16
    s_mul_i32 s64, s63, 7
    s_sub_u32 s64, s62, s64
    s_cmp_eq_u32 s63, 15
    s_cselect_b32 s65, 2, 4
    s_cselect_b32 s56, 2, 6
    s_mul_i32 s57, s65, 40
    s_mul_i32 s3, s56, 40
    s_cmp_eq_u32 s64, s56
    s_cselect_b32 s25, 1, 2
    s_cselect_b32 s57, s3, s57
    s_cselect_b32 s56, s56, s65
    s_cmp_lt_u32 s64, s65
    s_cselect_b32 s25, s65, s25
    s_cselect_b32 s57, 0, s57
    s_cselect_b32 s56, 0, s56
    s_sub_u32 s64, s64, s56
    s_lshl_b32 s64, s64, 1
    s_add_u32 s64, s64, s69
    s_add_u32 s64, s64, s57
    s_lshl_b32 s25, s25, 11
    s_lshl_b32 s64, s64, 10
    s_and_b32 s56, s63, 3
    s_mul_i32 s56, s56, 0
    s_and_b32 s56, s56, -2
    s_mul_i32 s57, s68, 3
    s_add_u32 s57, s57, 20
    s_sub_u32 s70, s57, s56
    s_mul_i32 s63, s63, 286720
    s_add_u32 s24, s63, s64
    s_add_u32 s24, s24, 6291456
    s_lshl_b32 s62, s60, 2
    s_add_u32 s62, s62, 1
    s_mul_i32 s63, s62, 9363
    s_lshr_b32 s63, s63, 16
    s_mul_i32 s64, s63, 7
    s_sub_u32 s64, s62, s64
    s_cmp_eq_u32 s63, 15
    s_cselect_b32 s65, 2, 4
    s_cselect_b32 s56, 2, 6
    s_mul_i32 s57, s65, 40
    s_mul_i32 s3, s56, 40
    s_cmp_eq_u32 s64, s56
    s_cselect_b32 s27, 1, 2
    s_cselect_b32 s57, s3, s57
    s_cselect_b32 s56, s56, s65
    s_cmp_lt_u32 s64, s65
    s_cselect_b32 s27, s65, s27
    s_cselect_b32 s57, 0, s57
    s_cselect_b32 s56, 0, s56
    s_sub_u32 s64, s64, s56
    s_lshl_b32 s64, s64, 1
    s_add_u32 s64, s64, s69
    s_add_u32 s64, s64, s57
    s_lshl_b32 s27, s27, 11
    s_lshl_b32 s64, s64, 10
    s_and_b32 s56, s63, 3
    s_mul_i32 s56, s56, 0
    s_and_b32 s56, s56, -2
    s_mul_i32 s57, s68, 3
    s_add_u32 s57, s57, 20
    s_sub_u32 s71, s57, s56
    s_mul_i32 s63, s63, 286720
    s_add_u32 s26, s63, s64
    s_add_u32 s26, s26, 6291456
    s_lshl_b32 s62, s60, 2
    s_add_u32 s62, s62, 2
    s_mul_i32 s63, s62, 9363
    s_lshr_b32 s63, s63, 16
    s_mul_i32 s64, s63, 7
    s_sub_u32 s64, s62, s64
    s_cmp_eq_u32 s63, 15
    s_cselect_b32 s65, 2, 4
    s_cselect_b32 s56, 2, 6
    s_mul_i32 s57, s65, 40
    s_mul_i32 s3, s56, 40
    s_cmp_eq_u32 s64, s56
    s_cselect_b32 s29, 1, 2
    s_cselect_b32 s57, s3, s57
    s_cselect_b32 s56, s56, s65
    s_cmp_lt_u32 s64, s65
    s_cselect_b32 s29, s65, s29
    s_cselect_b32 s57, 0, s57
    s_cselect_b32 s56, 0, s56
    s_sub_u32 s64, s64, s56
    s_lshl_b32 s64, s64, 1
    s_add_u32 s64, s64, s69
    s_add_u32 s64, s64, s57
    s_lshl_b32 s29, s29, 11
    s_lshl_b32 s64, s64, 10
    s_and_b32 s56, s63, 3
    s_mul_i32 s56, s56, 0
    s_and_b32 s56, s56, -2
    s_mul_i32 s57, s68, 3
    s_add_u32 s57, s57, 20
    s_sub_u32 s72, s57, s56
    s_mul_i32 s63, s63, 286720
    s_add_u32 s28, s63, s64
    s_add_u32 s28, s28, 6291456
    s_lshl_b32 s62, s60, 2
    s_add_u32 s62, s62, 3
    s_mul_i32 s63, s62, 9363
    s_lshr_b32 s63, s63, 16
    s_mul_i32 s64, s63, 7
    s_sub_u32 s64, s62, s64
    s_cmp_eq_u32 s63, 15
    s_cselect_b32 s65, 2, 4
    s_cselect_b32 s56, 2, 6
    s_mul_i32 s57, s65, 40
    s_mul_i32 s3, s56, 40
    s_cmp_eq_u32 s64, s56
    s_cselect_b32 s31, 1, 2
    s_cselect_b32 s57, s3, s57
    s_cselect_b32 s56, s56, s65
    s_cmp_lt_u32 s64, s65
    s_cselect_b32 s31, s65, s31
    s_cselect_b32 s57, 0, s57
    s_cselect_b32 s56, 0, s56
    s_sub_u32 s64, s64, s56
    s_lshl_b32 s64, s64, 1
    s_add_u32 s64, s64, s69
    s_add_u32 s64, s64, s57
    s_lshl_b32 s31, s31, 11
    s_lshl_b32 s64, s64, 10
    s_and_b32 s56, s63, 3
    s_mul_i32 s56, s56, 0
    s_and_b32 s56, s56, -2
    s_mul_i32 s57, s68, 3
    s_add_u32 s57, s57, 20
    s_sub_u32 s73, s57, s56
    s_mul_i32 s63, s63, 286720
    s_add_u32 s30, s63, s64
    s_add_u32 s30, s30, 6291456
    v_bfe_u32 v6, v1, 2, 2
    v_bfe_u32 v7, v1, 3, 1
    v_and_b32_e64 v8, 1, v4
    v_lshl_add_u32 v7, v8, 1, v7
    v_lshlrev_b32_e64 v7, 5, v7
    v_lshl_add_u32 v7, v6, 7, v7
    v_lshl_add_u32 v7, v4, 10, v7
    v_and_b32_e64 v6, 3, v1
    v_lshl_add_u32 v7, v6, 3, v7
    s_add_u32 s56, s50, 8192
    v_add_u32 v56, s56, v7
    v_xor_b32 v57, 32, v56
    v_xor_b32_e64 v58, 64, v56
    v_xor_b32 v59, 0x60, v56
    v_add_u32 v96, s67, v9
    s_cmp_eq_u32 s68, 6
    s_cselect_b32 s56, 1073741824, s67
    v_add_u32 v97, s56, v9
    s_mov_b32 s3, 0x3f803f80
    v_mov_b32 v60, s3
    v_mov_b32 v61, s3
    v_mov_b32 v62, s3
    v_mov_b32 v63, s3
    s_waitcnt vmcnt(6)
    v_xor_b32 v26, v28, v30
    v_xor_b32 v27, v29, v31
    v_and_b32 v26, v26, v27
    v_cmp_ne_u32 vcc, -1, v26
    s_cbranch_vccz L_ok4
    s_mov_b32 s3, 0
L_poll3:
    v_mov_b32 v26, 0
    buffer_load_dwordx4 v[28:31], v26, s[12:15], 0 offen sc1
    s_waitcnt vmcnt(0)
    v_xor_b32 v26, v28, v30
    v_xor_b32 v27, v29, v31
    v_and_b32 v26, v26, v27
    v_cmp_ne_u32 vcc, -1, v26
    s_add_u32 s3, s3, 1
    s_cmp_gt_u32 s3, 1000000
    s_cbranch_scc1 L_ok4
    s_cbranch_vccnz L_poll3
L_ok4:
    v_readfirstlane_b32 s0, v28
    v_readfirstlane_b32 s1, v29
    s_barrier
    s_lshl_b32 s3, s2, 7
    s_add_u32 s3, s3, 22151168
    s_lshl_b32 s55, s48, 30
    v_lshl_add_u32 v26, v1, 3, s55
    v_mov_b32 v28, s0
    v_mov_b32_e64 v29, s1
    s_mov_b64 exec, 0xffff
    buffer_store_dwordx2 v[28:29], v26, s[8:11], s3 offen sc1
    s_mov_b64 exec, -1
    s_add_u32 m0, s50, 14336
    s_addk_i32 s61, 27648
    buffer_load_dwordx4 v12, s[4:7], s61 offen nt lds
    s_add_u32 m0, s50, 15360
    s_add_u32 s61, s61, 27648
    buffer_load_dwordx4 v13, s[4:7], s61 offen nt lds
    s_add_u32 m0, s50, 16384
    s_add_u32 s61, s61, 27648
    buffer_load_dwordx4 v14, s[4:7], s61 offen nt lds
    s_add_u32 m0, s50, 17408
    s_add_u32 s61, s61, 27648
    buffer_load_dwordx4 v15, s[4:7], s61 offen nt lds
    s_add_u32 m0, s50, 18432
    s_add_u32 s61, s61, 27648
    buffer_load_dwordx4 v14, s[4:7], s61 offen nt lds
    s_add_u32 m0, s50, 19456
    s_addk_i32 s61, 27648
    buffer_load_dwordx4 v15, s[4:7], s61 offen nt lds
    s_waitcnt vmcnt(9)
    ds_read_b64_tr_b16 v[128:129], v56 offset:0
    ds_read_b64_tr_b16 v[130:131], v56 offset:512
    ds_read_b64_tr_b16 v[132:133], v57 offset:0
    ds_read_b64_tr_b16 v[134:135], v57 offset:512
    ds_read_b64_tr_b16 v[136:137], v58 offset:0
    ds_read_b64_tr_b16 v[138:139], v58 offset:512
    ds_read_b64_tr_b16 v[140:141], v59 offset:0
    ds_read_b64_tr_b16 v[142:143], v59 offset:512
    s_add_u32 s56, s70, 0
    s_sub_u32 s57, s56, 20
    s_cmp_ge_u32 s56, 20
    s_cselect_b32 s56, s57, s56
    s_sub_u32 s57, s56, 20
    s_cmp_ge_u32 s56, 20
    s_cselect_b32 s56, s57, s56
    s_mul_i32 s56, s56, s25
    s_add_u32 s57, s56, s24
    s_waitcnt lgkmcnt(6)
    buffer_store_dwordx4 v[128:131], v96, s[8:11], s57 offen sc1
    v_mfma_f32_16x16x32_bf16 v[112:115], v[128:131], v[60:63], 0
    s_add_u32 s56, s71, 0
    s_sub_u32 s57, s56, 20
    s_cmp_ge_u32 s56, 20
    s_cselect_b32 s56, s57, s56
    s_sub_u32 s57, s56, 20
    s_cmp_ge_u32 s56, 20
    s_cselect_b32 s56, s57, s56
    s_mul_i32 s56, s56, s27
    s_add_u32 s57, s56, s26
    s_waitcnt lgkmcnt(4)
    buffer_store_dwordx4 v[132:135], v96, s[8:11], s57 offen sc1
    v_mfma_f32_16x16x32_bf16 v[116:119], v[132:135], v[60:63], 0
    s_add_u32 s56, s72, 0
    s_sub_u32 s57, s56, 20
    s_cmp_ge_u32 s56, 20
    s_cselect_b32 s56, s57, s56
    s_sub_u32 s57, s56, 20
    s_cmp_ge_u32 s56, 20
    s_cselect_b32 s56, s57, s56
    s_mul_i32 s56, s56, s29
    s_add_u32 s57, s56, s28
    s_waitcnt lgkmcnt(2)
    buffer_store_dwordx4 v[136:139], v96, s[8:11], s57 offen sc1
    v_mfma_f32_16x16x32_bf16 v[120:123], v[136:139], v[60:63], 0
    s_add_u32 s56, s73, 0
    s_sub_u32 s57, s56, 20
    s_cmp_ge_u32 s56, 20
    s_cselect_b32 s56, s57, s56
    s_sub_u32 s57, s56, 20
    s_cmp_ge_u32 s56, 20
    s_cselect_b32 s56, s57, s56
    s_mul_i32 s56, s56, s31
    s_add_u32 s57, s56, s30
    s_waitcnt lgkmcnt(0)
    buffer_store_dwordx4 v[140:143], v96, s[8:11], s57 offen sc1
    v_mfma_f32_16x16x32_bf16 v[124:127], v[140:143], v[60:63], 0
    s_waitcnt vmcnt(8)
    ds_read_b64_tr_b16 v[144:145], v56 offset:4096
    ds_read_b64_tr_b16 v[146:147], v56 offset:4608
    ds_read_b64_tr_b16 v[148:149], v57 offset:4096
    ds_read_b64_tr_b16 v[150:151], v57 offset:4608
    ds_read_b64_tr_b16 v[152:153], v58 offset:4096
    ds_read_b64_tr_b16 v[154:155], v58 offset:4608
    ds_read_b64_tr_b16 v[156:157], v59 offset:4096
    ds_read_b64_tr_b16 v[158:159], v59 offset:4608
    s_add_u32 s56, s70, 1
    s_sub_u32 s57, s56, 20
    s_cmp_ge_u32 s56, 20
    s_cselect_b32 s56, s57, s56
    s_sub_u32 s57, s56, 20
    s_cmp_ge_u32 s56, 20
    s_cselect_b32 s56, s57, s56
    s_mul_i32 s56, s56, s25
    s_add_u32 s57, s56, s24
    s_waitcnt lgkmcnt(6)
    buffer_store_dwordx4 v[144:147], v96, s[8:11], s57 offen sc1
    v_mfma_f32_16x16x32_bf16 v[112:115], v[144:147], v[60:63], v[112:115]
    s_add_u32 s56, s71, 1
    s_sub_u32 s57, s56, 20
    s_cmp_ge_u32 s56, 20
    s_cselect_b32 s56, s57, s56
    s_sub_u32 s57, s56, 20
    s_cmp_ge_u32 s56, 20
    s_cselect_b32 s56, s57, s56
    s_mul_i32 s56, s56, s27
    s_add_u32 s57, s56, s26
    s_waitcnt lgkmcnt(4)
    buffer_store_dwordx4 v[148:151], v96, s[8:11], s57 offen sc1
    v_mfma_f32_16x16x32_bf16 v[116:119], v[148:151], v[60:63], v[116:119]
    s_add_u32 s56, s72, 1
    s_sub_u32 s57, s56, 20
    s_cmp_ge_u32 s56, 20
    s_cselect_b32 s56, s57, s56
    s_sub_u32 s57, s56, 20
    s_cmp_ge_u32 s56, 20
    s_cselect_b32 s56, s57, s56
    s_mul_i32 s56, s56, s29
    s_add_u32 s57, s56, s28
    s_waitcnt lgkmcnt(2)
    buffer_store_dwordx4 v[152:155], v96, s[8:11], s57 offen sc1
    v_mfma_f32_16x16x32_bf16 v[120:123], v[152:155], v[60:63], v[120:123]
    s_add_u32 s56, s73, 1
    s_sub_u32 s57, s56, 20
    s_cmp_ge_u32 s56, 20
    s_cselect_b32 s56, s57, s56
    s_sub_u32 s57, s56, 20
    s_cmp_ge_u32 s56, 20
    s_cselect_b32 s56, s57, s56
    s_mul_i32 s56, s56, s31
    s_add_u32 s57, s56, s30
    s_waitcnt lgkmcnt(0)
    buffer_store_dwordx4 v[156:159], v96, s[8:11], s57 offen sc1
    v_mfma_f32_16x16x32_bf16 v[124:127], v[156:159], v[60:63], v[124:127]
    s_waitcnt vmcnt(8)
    ds_read_b64_tr_b16 v[160:161], v56 offset:8192
    ds_read_b64_tr_b16 v[162:163], v56 offset:8704
    ds_read_b64_tr_b16 v[164:165], v57 offset:8192
    ds_read_b64_tr_b16 v[166:167], v57 offset:8704
    ds_read_b64_tr_b16 v[168:169], v58 offset:8192
    ds_read_b64_tr_b16 v[170:171], v58 offset:8704
    ds_read_b64_tr_b16 v[172:173], v59 offset:8192
    ds_read_b64_tr_b16 v[174:175], v59 offset:8704
    s_add_u32 s56, s70, 2
    s_sub_u32 s57, s56, 20
    s_cmp_ge_u32 s56, 20
    s_cselect_b32 s56, s57, s56
    s_sub_u32 s57, s56, 20
    s_cmp_ge_u32 s56, 20
    s_cselect_b32 s56, s57, s56
    s_mul_i32 s56, s56, s25
    s_add_u32 s57, s56, s24
    s_waitcnt lgkmcnt(6)
    buffer_store_dwordx4 v[160:163], v97, s[8:11], s57 offen sc1
    v_mfma_f32_16x16x32_bf16 v[112:115], v[160:163], v[60:63], v[112:115]
    s_add_u32 s56, s71, 2
    s_sub_u32 s57, s56, 20
    s_cmp_ge_u32 s56, 20
    s_cselect_b32 s56, s57, s56
    s_sub_u32 s57, s56, 20
    s_cmp_ge_u32 s56, 20
    s_cselect_b32 s56, s57, s56
    s_mul_i32 s56, s56, s27
    s_add_u32 s57, s56, s26
    s_waitcnt lgkmcnt(4)
    buffer_store_dwordx4 v[164:167], v97, s[8:11], s57 offen sc1
    v_mfma_f32_16x16x32_bf16 v[116:119], v[164:167], v[60:63], v[116:119]
    s_add_u32 s56, s72, 2
    s_sub_u32 s57, s56, 20
    s_cmp_ge_u32 s56, 20
    s_cselect_b32 s56, s57, s56
    s_sub_u32 s57, s56, 20
    s_cmp_ge_u32 s56, 20
    s_cselect_b32 s56, s57, s56
    s_mul_i32 s56, s56, s29
    s_add_u32 s57, s56, s28
    s_waitcnt lgkmcnt(2)
    buffer_store_dwordx4 v[168:171], v97, s[8:11], s57 offen sc1
    v_mfma_f32_16x16x32_bf16 v[120:123], v[168:171], v[60:63], v[120:123]
    s_add_u32 s56, s73, 2
    s_sub_u32 s57, s56, 20
    s_cmp_ge_u32 s56, 20
    s_cselect_b32 s56, s57, s56
    s_sub_u32 s57, s56, 20
    s_cmp_ge_u32 s56, 20
    s_cselect_b32 s56, s57, s56
    s_mul_i32 s56, s56, s31
    s_add_u32 s57, s56, s30
    s_waitcnt lgkmcnt(0)
    buffer_store_dwordx4 v[172:175], v97, s[8:11], s57 offen sc1
    v_mfma_f32_16x16x32_bf16 v[124:127], v[172:175], v[60:63], v[124:127]
    v_and_b32_e64 v3, 3, v1
    v_cmp_eq_u32 s[62:63], 1, v3
    v_cmp_eq_u32 s[64:65], 2, v3
    v_cmp_eq_u32 vcc, 3, v3
    v_lshlrev_b32 v2, 4, v4
    v_lshl_add_u32 v2, v3, 6, v2
    v_add_u32_e64 v2, s67, v2
    s_lshl_b32 s56, s68, 1
    s_add_u32 s56, s56, s69
    s_mul_i32 s56, s56, 7168
    s_lshl_b32 s57, s60, 8
    s_add_u32 s56, s56, s57
    s_add_u32 s56, s56, 22020096
    v_cndmask_b32 v112, v112, v116, s[62:63]
    v_cndmask_b32 v112, v112, v120, s[64:65]
    v_cndmask_b32_e64 v112, v112, v124, vcc
    v_cndmask_b32 v113, v113, v117, s[62:63]
    v_cndmask_b32 v113, v113, v121, s[64:65]
    v_cndmask_b32_e64 v113, v113, v125, vcc
    v_cndmask_b32 v114, v114, v118, s[62:63]
    v_cndmask_b32 v114, v114, v122, s[64:65]
    v_cndmask_b32_e64 v114, v114, v126, vcc
    v_cndmask_b32 v115, v115, v119, s[62:63]
    v_cndmask_b32 v115, v115, v123, s[64:65]
    v_cndmask_b32_e64 v115, v115, v127, vcc
    s_mov_b32 exec_lo, 0xf000f
    s_mov_b32 exec_hi, 0xf000f
    buffer_store_dwordx4 v[112:115], v2, s[8:11], s56 offen sc1
    s_mov_b64 exec, -1
    s_waitcnt vmcnt(0) lgkmcnt(0)
    s_barrier
    s_lshl_b32 s3, s2, 7
    s_add_u32 s3, s3, 22167552
    s_lshl_b32 s55, s48, 30
    v_lshl_add_u32 v26, v1, 3, s55
    v_mov_b32 v28, s0
    v_mov_b32_e64 v29, s1
    s_mov_b64 exec, 0xffff
    buffer_store_dwordx2 v[28:29], v26, s[8:11], s3 offen sc1
    s_mov_b64 exec, -1
    s_lshr_b32 s76, s2, 3
    s_mul_i32 s52, s76, 43
    s_lshr_b32 s52, s52, 7
    s_mul_i32 s58, s52, 3
    s_sub_u32 s77, s76, s58
    s_and_b32 s58, s49, 1
    s_mul_i32 s58, s58, 3
    s_add_u32 s51, s77, s58
    s_mul_i32 s59, s77, 3
    s_lshr_b32 s54, s76, 2
    s_lshr_b32 s58, s49, 1
    s_lshl_b32 s58, s58, 2
    s_add_u32 s52, s52, s58
    s_and_b32 s76, s76, 3
    s_lshl_b32 s53, s49, 2
    s_add_u32 s53, s53, s76
    v_lshlrev_b32_e64 v4, 4, v1
    s_lshl_b32 s62, s48, 12
    s_mul_i32 s61, s52, 286720
    s_add_u32 s61, s61, s62
    s_add_u32 s61, s61, 6291456
    s_mul_i32 s58, s54, 56
    s_mul_i32 s63, s48, 14
    s_add_u32 s58, s58, s63
    s_mul_i32 s63, s58, 5120
    s_add_u32 s63, s63, 11534336
    s_mul_i32 s55, s48, 3072
    s_add_u32 s55, s55, 22151168
    v_min_u32 v26, 23, v1
    v_lshlrev_b32 v26, 7, v26
    buffer_load_dwordx2 v[28:29], v26, s[8:11], s55 offen sc1
    s_waitcnt vmcnt(0)
    v_xor_b32 v28, s0, v28
    v_xor_b32 v29, s1, v29
    v_or_b32 v26, v28, v29
    v_cmp_ne_u32_e64 vcc, 0, v26
    s_cbranch_vccz L_ok6
    s_mov_b32 s3, 0
L_poll5:
    s_mul_i32 s55, s48, 3072
    s_add_u32 s55, s55, 22151168
    v_min_u32 v26, 23, v1
    v_lshlrev_b32 v26, 7, v26
    buffer_load_dwordx2 v[28:29], v26, s[8:11], s55 offen sc1
    s_waitcnt vmcnt(0)
    v_xor_b32 v28, s0, v28
    v_xor_b32 v29, s1, v29
    v_or_b32 v26, v28, v29
    v_cmp_ne_u32_e64 vcc, 0, v26
    s_add_u32 s3, s3, 1
    s_cmp_gt_u32 s3, 1000000
    s_cbranch_scc1 L_ok6
    s_cbranch_vccnz L_poll5
L_ok6:
    s_barrier
    buffer_load_dwordx4 a[80:83], v4, s[8:11], s63 offen offset:0 sc1
    buffer_load_dwordx4 a[84:87], v4, s[8:11], s63 offen offset:1024 sc1
    buffer_load_dwordx4 a[88:91], v4, s[8:11], s63 offen offset:2048 sc1
    buffer_load_dwordx4 a[92:95], v4, s[8:11], s63 offen offset:3072 sc1
    s_add_u32 s63, s63, 4096
    buffer_load_dwordx4 a[96:99], v4, s[8:11], s63 offen offset:0 sc1
    buffer_load_dwordx4 a[100:103], v4, s[8:11], s63 offen offset:1024 sc1
    buffer_load_dwordx4 a[104:107], v4, s[8:11], s63 offen offset:2048 sc1
    buffer_load_dwordx4 a[108:111], v4, s[8:11], s63 offen offset:3072 sc1
    s_add_u32 s63, s63, 4096
    buffer_load_dwordx4 a[112:115], v4, s[8:11], s63 offen offset:0 sc1
    buffer_load_dwordx4 a[116:119], v4, s[8:11], s63 offen offset:1024 sc1
    buffer_load_dwordx4 a[120:123], v4, s[8:11], s63 offen offset:2048 sc1
    buffer_load_dwordx4 a[124:127], v4, s[8:11], s63 offen offset:3072 sc1
    s_add_u32 s63, s63, 4096
    buffer_load_dwordx4 a[128:131], v4, s[8:11], s63 offen offset:0 sc1
    buffer_load_dwordx4 a[132:135], v4, s[8:11], s63 offen offset:1024 sc1
    buffer_load_dwordx4 a[136:139], v4, s[8:11], s63 offen offset:2048 sc1
    buffer_load_dwordx4 a[140:143], v4, s[8:11], s63 offen offset:3072 sc1
    s_add_u32 s63, s63, 4096
    buffer_load_dwordx4 a[144:147], v4, s[8:11], s63 offen offset:0 sc1
    buffer_load_dwordx4 a[148:151], v4, s[8:11], s63 offen offset:1024 sc1
    buffer_load_dwordx4 a[152:155], v4, s[8:11], s63 offen offset:2048 sc1
    buffer_load_dwordx4 a[156:159], v4, s[8:11], s63 offen offset:3072 sc1
    s_add_u32 s63, s63, 4096
    buffer_load_dwordx4 a[160:163], v4, s[8:11], s63 offen offset:0 sc1
    buffer_load_dwordx4 a[164:167], v4, s[8:11], s63 offen offset:1024 sc1
    buffer_load_dwordx4 a[168:171], v4, s[8:11], s63 offen offset:2048 sc1
    buffer_load_dwordx4 a[172:175], v4, s[8:11], s63 offen offset:3072 sc1
    s_add_u32 s63, s63, 4096
    buffer_load_dwordx4 a[176:179], v4, s[8:11], s63 offen offset:0 sc1
    buffer_load_dwordx4 a[180:183], v4, s[8:11], s63 offen offset:1024 sc1
    buffer_load_dwordx4 a[184:187], v4, s[8:11], s63 offen offset:2048 sc1
    buffer_load_dwordx4 a[188:191], v4, s[8:11], s63 offen offset:3072 sc1
    s_mul_i32 s55, s48, 3072
    s_add_u32 s55, s55, 22167552
    v_min_u32 v26, 23, v1
    v_lshlrev_b32 v26, 7, v26
    buffer_load_dwordx2 v[28:29], v26, s[8:11], s55 offen sc1
    s_waitcnt vmcnt(0)
    v_xor_b32 v28, s0, v28
    v_xor_b32 v29, s1, v29
    v_or_b32 v26, v28, v29
    v_cmp_ne_u32 vcc, 0, v26
    s_cbranch_vccz L_ok8
    s_mov_b32 s3, 0
L_poll7:
    s_sleep 4
    s_mul_i32 s55, s48, 3072
    s_add_u32 s55, s55, 22167552
    v_min_u32 v26, 23, v1
    v_lshlrev_b32 v26, 7, v26
    buffer_load_dwordx2 v[28:29], v26, s[8:11], s55 offen sc1
    s_waitcnt vmcnt(0)
    v_xor_b32 v28, s0, v28
    v_xor_b32 v29, s1, v29
    v_or_b32 v26, v28, v29
    v_cmp_ne_u32_e64 vcc, 0, v26
    s_add_u32 s3, s3, 1
    s_cmp_gt_u32 s3, 1000000
    s_cbranch_scc1 L_ok8
    s_cbranch_vccnz L_poll7
L_ok8:
    s_barrier
    s_lshl_b32 s56, s59, 14
    s_add_u32 m0, s62, s56
    s_add_u32 s57, s61, s56
    s_add_u32 s59, s59, 1
    s_cmp_eq_u32 s59, 9
    s_cselect_b32 s59, 0, s59
    buffer_load_dwordx4 v4, s[8:11], s57 offen offset:0 sc1 lds
    buffer_load_dwordx4 v4, s[8:11], s57 offen offset:1024 sc1 lds
    buffer_load_dwordx4 v4, s[8:11], s57 offen offset:2048 sc1 lds
    buffer_load_dwordx4 v4, s[8:11], s57 offen offset:3072 sc1 lds
    s_lshl_b32 s56, s59, 14
    s_add_u32 m0, s62, s56
    s_add_u32 s57, s61, s56
    s_add_u32 s59, s59, 1
    s_cmp_eq_u32 s59, 9
    s_cselect_b32 s59, 0, s59
    buffer_load_dwordx4 v4, s[8:11], s57 offen offset:0 sc1 lds
    buffer_load_dwordx4 v4, s[8:11], s57 offen offset:1024 sc1 lds
    buffer_load_dwordx4 v4, s[8:11], s57 offen offset:2048 sc1 lds
    buffer_load_dwordx4 v4, s[8:11], s57 offen offset:3072 sc1 lds
    s_lshl_b32 s56, s59, 14
    s_add_u32 m0, s62, s56
    s_add_u32 s57, s61, s56
    s_add_u32 s59, s59, 1
    s_cmp_eq_u32 s59, 9
    s_cselect_b32 s59, 0, s59
    buffer_load_dwordx4 v4, s[8:11], s57 offen offset:0 sc1 lds
    buffer_load_dwordx4 v4, s[8:11], s57 offen offset:1024 sc1 lds
    buffer_load_dwordx4 v4, s[8:11], s57 offen offset:2048 sc1 lds
    buffer_load_dwordx4 v4, s[8:11], s57 offen offset:3072 sc1 lds
    s_lshl_b32 s56, s59, 14
    s_add_u32 m0, s62, s56
    s_add_u32 s57, s61, s56
    s_add_u32 s59, s59, 1
    s_cmp_eq_u32 s59, 9
    s_cselect_b32 s59, 0, s59
    buffer_load_dwordx4 v4, s[8:11], s57 offen offset:0 sc1 lds
    buffer_load_dwordx4 v4, s[8:11], s57 offen offset:1024 sc1 lds
    buffer_load_dwordx4 v4, s[8:11], s57 offen offset:2048 sc1 lds
    buffer_load_dwordx4 v4, s[8:11], s57 offen offset:3072 sc1 lds
    s_lshl_b32 s56, s59, 14
    s_add_u32 m0, s62, s56
    s_add_u32 s57, s61, s56
    s_add_u32 s59, s59, 1
    s_cmp_eq_u32 s59, 9
    s_cselect_b32 s59, 0, s59
    buffer_load_dwordx4 v4, s[8:11], s57 offen offset:0 sc1 lds
    buffer_load_dwordx4 v4, s[8:11], s57 offen offset:1024 sc1 lds
    buffer_load_dwordx4 v4, s[8:11], s57 offen offset:2048 sc1 lds
    buffer_load_dwordx4 v4, s[8:11], s57 offen offset:3072 sc1 lds
    s_lshl_b32 s56, s59, 14
    s_add_u32 m0, s62, s56
    s_add_u32 s57, s61, s56
    s_add_u32 s59, s59, 1
    s_cmp_eq_u32 s59, 9
    s_cselect_b32 s59, 0, s59
    buffer_load_dwordx4 v4, s[8:11], s57 offen offset:0 sc1 lds
    buffer_load_dwordx4 v4, s[8:11], s57 offen offset:1024 sc1 lds
    buffer_load_dwordx4 v4, s[8:11], s57 offen offset:2048 sc1 lds
    buffer_load_dwordx4 v4, s[8:11], s57 offen offset:3072 sc1 lds
    s_lshl_b32 s56, s59, 14
    s_add_u32 m0, s62, s56
    s_add_u32 s57, s61, s56
    s_add_u32 s59, s59, 1
    s_cmp_eq_u32 s59, 9
    s_cselect_b32 s59, 0, s59
    buffer_load_dwordx4 v4, s[8:11], s57 offen offset:0 sc1 lds
    buffer_load_dwordx4 v4, s[8:11], s57 offen offset:1024 sc1 lds
    buffer_load_dwordx4 v4, s[8:11], s57 offen offset:2048 sc1 lds
    buffer_load_dwordx4 v4, s[8:11], s57 offen offset:3072 sc1 lds
    s_lshl_b32 s56, s59, 14
    s_add_u32 m0, s62, s56
    s_add_u32 s57, s61, s56
    s_add_u32 s59, s59, 1
    s_cmp_eq_u32 s59, 9
    s_cselect_b32 s59, 0, s59
    buffer_load_dwordx4 v4, s[8:11], s57 offen offset:0 sc1 lds
    buffer_load_dwordx4 v4, s[8:11], s57 offen offset:1024 sc1 lds
    buffer_load_dwordx4 v4, s[8:11], s57 offen offset:2048 sc1 lds
    buffer_load_dwordx4 v4, s[8:11], s57 offen offset:3072 sc1 lds
    s_lshl_b32 s56, s59, 14
    s_add_u32 m0, s62, s56
    s_add_u32 s57, s61, s56
    s_add_u32 s59, s59, 1
    s_cmp_eq_u32 s59, 9
    s_cselect_b32 s59, 0, s59
    buffer_load_dwordx4 v4, s[8:11], s57 offen offset:0 sc1 lds
    buffer_load_dwordx4 v4, s[8:11], s57 offen offset:1024 sc1 lds
    buffer_load_dwordx4 v4, s[8:11], s57 offen offset:2048 sc1 lds
    buffer_load_dwordx4 v4, s[8:11], s57 offen offset:3072 sc1 lds
    s_add_u32 s61, s61, 131072
    v_cmp_lt_u32 vcc, 111, v0
    v_mov_b32_e64 v2, 0
    v_mov_b32 v3, 6720
    v_cndmask_b32_e64 v2, v2, v3, vcc
    v_lshl_add_u32 v2, v0, 2, v2
    s_mul_i32 s56, s52, 448
    s_add_u32 s56, s56, 22020096
    buffer_load_dword v16, v2, s[8:11], s56 offen sc1
    s_add_u32 s56, s56, 14336
    buffer_load_dword v17, v2, s[8:11], s56 offen sc1
    s_add_u32 s56, s56, 14336
    buffer_load_dword v18, v2, s[8:11], s56 offen sc1
    s_add_u32 s56, s56, 14336
    buffer_load_dword v19, v2, s[8:11], s56 offen sc1
    s_add_u32 s56, s56, 14336
    buffer_load_dword v20, v2, s[8:11], s56 offen sc1
    s_add_u32 s56, s56, 14336
    buffer_load_dword v21, v2, s[8:11], s56 offen sc1
    s_add_u32 s56, s56, 14336
    buffer_load_dword v22, v2, s[8:11], s56 offen sc1
    s_addk_i32 s56, 14336
    s_addk_i32 s63, 4096
    buffer_load_dwordx4 a[192:195], v4, s[8:11], s63 offen offset:0 sc1
    buffer_load_dwordx4 a[196:199], v4, s[8:11], s63 offen offset:1024 sc1
    buffer_load_dwordx4 a[200:203], v4, s[8:11], s63 offen offset:2048 sc1
    buffer_load_dwordx4 a[204:207], v4, s[8:11], s63 offen offset:3072 sc1
    s_add_u32 s63, s63, 4096
    buffer_load_dwordx4 a[208:211], v4, s[8:11], s63 offen offset:0 sc1
    buffer_load_dwordx4 a[212:215], v4, s[8:11], s63 offen offset:1024 sc1
    buffer_load_dwordx4 a[216:219], v4, s[8:11], s63 offen offset:2048 sc1
    buffer_load_dwordx4 a[220:223], v4, s[8:11], s63 offen offset:3072 sc1
    s_add_u32 s63, s63, 4096
    buffer_load_dwordx4 a[224:227], v4, s[8:11], s63 offen offset:0 sc1
    buffer_load_dwordx4 a[228:231], v4, s[8:11], s63 offen offset:1024 sc1
    buffer_load_dwordx4 a[232:235], v4, s[8:11], s63 offen offset:2048 sc1
    buffer_load_dwordx4 a[236:239], v4, s[8:11], s63 offen offset:3072 sc1
    s_add_u32 s2, s2, 160
    s_branch L_g1
L_conv:
    v_and_b32 v2, 7, v1
    v_lshrrev_b32_e64 v3, 3, v1
    v_mul_u32_u24 v240, 2592, v2
    v_lshl_add_u32 v240, v3, 3, v240
    s_lshl_b32 s3, s48, 6
    s_add_u32 s3, s3, 143104
    v_add_u32 v240, s3, v240
    v_lshlrev_b32_e64 v241, 8, v3
    v_lshl_add_u32 v241, v2, 4, v241
    s_lshl_b32 s3, s48, 11
    s_add_u32 s3, s3, s60
    v_add_u32 v241, s3, v241
    v_lshrrev_b32 v2, 5, v1
    v_bfe_u32 v3, v1, 4, 1
    v_mul_u32_u24 v242, 2592, v2
    v_mul_u32_u24 v3, 1280, v3
    v_and_b32_e64 v2, 15, v1
    v_lshl_add_u32 v242, v2, 4, v242
    v_add3_u32 v242, v242, v3, s58
    s_lshl_b32 s3, s48, 4
    s_add_u32 s3, s3, 142976
    v_lshrrev_b32 v2, 4, v1
    v_lshl_add_u32 v243, v2, 2, s3
    s_lshr_b32 s57, s50, 1
    s_mul_i32 s57, s57, 40960
    s_and_b32 s3, s50, 1
    s_lshl_b32 s3, s3, 7
    s_add_u32 s57, s57, s3
    s_add_u32 s57, s57, 65536
    s_mul_i32 s76, s48, 33856
    v_lshl_add_u32 v10, v1, 3, s76
    v_and_b32 v2, 31, v1
    v_lshrrev_b32 v3, 5, v1
    v_lshl_add_u32 v3, v3, 4, s76
    v_lshrrev_b32 v11, 3, v2
    v_lshlrev_b32 v11, 2, v11
    v_and_b32 v12, 3, v2
    v_add_u32 v11, v11, v12
    v_bfe_u32 v12, v2, 2, 1
    s_mov_b32 s72, 0x86444200
    s_mov_b32 s73, 0xfedcba88
    v_lshlrev_b32_e64 v16, 2, v11
    v_lshrrev_b64 v[16:17], v16, s[72:73]
    v_and_b32 v16, 15, v16
    v_add_u32 v16, 16, v16
    v_cmp_eq_u32 vcc, 1, v12
    s_nop 1
    v_cndmask_b32_e64 v11, v11, v16, vcc
    v_add_u32 v13, 32, v2
    s_movk_i32 s3, 528
    v_mad_u32_u24 v11, v11, s3, v3
    v_mad_u32_u24 v13, v13, s3, v3
    v_sub_u32_e64 v2, 63, v1
    v_lshl_add_u32 v12, v2, 4, s76
    v_lshl_add_u32 v253, v1, 4, s76
    v_and_b32 v250, 15, v1
    v_lshrrev_b32 v251, 4, v1
    v_sub_u32 v16, 2, v250
    v_and_b32 v16, 3, v16
    v_add_u32 v17, v250, v16
    v_sub_u32 v17, 18, v17
    v_lshlrev_b32_e64 v17, 1, v17
    v_mul_u32_u24 v16, 2368, v16
    v_add3_u32 v17, v17, v16, s76
    v_lshl_add_u32 v236, v251, 4, v17
    v_lshlrev_b32_e64 v17, 5, v250
    v_lshl_add_u32 v17, v251, 4, v17
    s_add_u32 s3, s76, 11008
    v_add_u32_e64 v237, s3, v17
    s_add_u32 s3, s76, 9598
    v_subrev_u32 v16, 1, v1
    v_and_b32 v16, -2, v16
    v_and_b32_e64 v17, 1, v1
    v_mul_u32_u24 v17, 768, v17
    v_sub_u32 v17, v17, v16
    v_add_u32 v254, s3, v17
    v_subrev_u32 v255, 64, v254
    v_cmp_eq_u32 s[70:71], 0, v1
    s_sub_u32 s3, s3, 126
    v_writelane_b32 v254, s3, 0
    s_add_u32 s3, s3, 64
    v_writelane_b32 v255, s3, 0
    s_mov_b32 s72, 0x01028403
    s_mov_b32 s73, 0x8500
    v_lshlrev_b32_e64 v16, 3, v1
    v_lshrrev_b64 v[16:17], v16, s[72:73]
    v_and_b32 v16, 0xff, v16
    v_lshl_add_u32 v252, v16, 4, s76
    v_lshrrev_b32_e64 v2, 4, v0
    v_mul_u32_u24 v2, 40960, v2
    v_lshl_add_u32 v192, v250, 4, v2
    v_lshlrev_b32 v193, 4, v0
    s_movk_i32 s72, 4096
    s_movk_i32 s73, 8192
    v_lshlrev_b32 v194, 2, v0
    v_add_u32 v194, 11520, v194
    v_add_u32 v195, 67712, v194
    s_lshl_b32 s74, s50, 8
    s_add_u32 s75, s74, 65536
    s_add_u32 s74, s74, 3145728
    s_lshr_b32 s54, s50, 5
    s_add_u32 s54, s54, 3
    s_mul_i32 s3, s54, 56
    s_mul_i32 s61, s48, 14
    s_add_u32 s3, s3, s61
    s_mul_i32 s3, s3, 5120
    s_add_u32 s61, s3, 11534336
    s_waitcnt lgkmcnt(0)
    s_lshr_b32 s3, s48, 1
    s_cmp_eq_u32 s3, 0
    s_cselect_b32 s62, s62, s63
    s_and_b32 s3, s48, 1
    s_lshl_b32 s3, s3, 4
    s_lshr_b32 s62, s62, s3
    s_lshl_b32 s62, s62, 16
    v_mov_b32_e64 v14, s62
    s_lshl_b32 s66, s64, 16
    s_and_b32 s67, s64, 0xffff0000
    s_lshl_b32 s68, s65, 16
    s_and_b32 s69, s65, 0xffff0000
    s_mov_b32 s64, 0x3fb8aa3b
    v_mul_f32_e64 v15, s64, v14
    v_fma_f32 v16, v14, s64, -v15
    v_fmac_f32 v16, 0x32a57060, v14
    v_exp_f32_e64 v15, v15
    v_mul_f32 v16, 0x3f317218, v16
    v_fmac_f32_e64 v15, v15, v16
    v_cvt_pk_bf16_f32 v15, v15, v15
    v_lshlrev_b32 v14, 16, v15
    s_mov_b32 s63, s61
    s_waitcnt vmcnt(6)
    v_lshlrev_b32 v32, 16, v4
    v_lshlrev_b32 v34, 16, v5
    v_lshlrev_b32 v46, 16, v6
    v_lshlrev_b32 v47, 16, v7
    v_lshlrev_b32 v36, 16, v8
    v_lshlrev_b32_e64 v37, 16, v9
    v_and_b32 v64, 0xffff0000, v4
    v_and_b32 v66, 0xffff0000, v5
    v_and_b32 v78, 0xffff0000, v6
    v_and_b32 v79, 0xffff0000, v7
    v_and_b32 v68, 0xffff0000, v8
    v_and_b32 v69, 0xffff0000, v9
    v_mul_f32 v32, v14, v32
    v_mul_f32 v34, v14, v34
    v_pk_mul_f32 v[46:47], v[46:47], v[14:15] op_sel_hi:[1,0]
    v_mul_f32 v32, s64, v32
    v_mul_f32 v34, 0.15915494, v34
    v_mul_f32 v64, v14, v64
    v_mul_f32 v66, v14, v66
    v_pk_mul_f32 v[78:79], v[78:79], v[14:15] op_sel_hi:[1,0]
    v_mul_f32 v64, s64, v64
    v_mul_f32 v66, 0.15915494, v66
    v_lshlrev_b32 v4, 4, v1
    v_mov_b32 v6, v236
    v_mov_b32_e64 v7, v237
    v_pk_mul_f32 v[44:45], v[36:37], v[46:47] op_sel_hi:[1,0]
    v_pk_fma_f32 v[48:49], v[36:37], v[46:47], v[44:45] op_sel:[1,1,0] op_sel_hi:[0,1,1] neg_lo:[0,1,0]
    v_pk_mul_f32 v[76:77], v[68:69], v[78:79] op_sel_hi:[1,0]
    v_pk_fma_f32 v[80:81], v[68:69], v[78:79], v[76:77] op_sel:[1,1,0] op_sel_hi:[0,1,1] neg_lo:[0,1,0]
    v_mul_f32 v44, 0x41000000, v32
    v_mul_f32 v45, 0x41000000, v34
    v_exp_f32 v44, v44
    v_fract_f32 v45, v45
    v_mul_f32 v76, 0x41000000, v64
    v_mul_f32 v77, 0x41000000, v66
    v_exp_f32 v76, v76
    v_fract_f32 v77, v77
    v_cos_f32 v40, v45
    v_sin_f32 v41, v45
    v_cos_f32 v72, v77
    v_sin_f32 v73, v77
    v_pk_mul_f32 v[40:41], v[40:41], v[44:45] op_sel_hi:[1,0]
    v_pk_mul_f32 v[72:73], v[72:73], v[76:77] op_sel_hi:[1,0]
    v_exp_f32 v44, v32
    v_fract_f32 v45, v34
    v_exp_f32 v76, v64
    v_fract_f32 v77, v66
    v_cos_f32 v38, v45
    v_sin_f32 v39, v45
    v_cos_f32 v70, v77
    v_sin_f32 v71, v77
    v_pk_mul_f32 v[38:39], v[38:39], v[44:45] op_sel_hi:[1,0]
    v_pk_mul_f32 v[70:71], v[70:71], v[76:77] op_sel_hi:[1,0]
    v_mul_f32 v44, 0x43800000, v32
    v_mul_f32 v45, 0x43800000, v34
    v_exp_f32 v44, v44
    v_fract_f32 v45, v45
    v_mul_f32 v76, 0x43800000, v64
    v_mul_f32 v77, 0x43800000, v66
    v_exp_f32 v76, v76
    v_fract_f32 v77, v77
    v_cos_f32 v42, v45
    v_sin_f32 v43, v45
    v_cos_f32 v74, v77
    v_sin_f32 v75, v77
    v_pk_mul_f32 v[42:43], v[42:43], v[44:45] op_sel_hi:[1,0]
    v_pk_mul_f32 v[74:75], v[74:75], v[76:77] op_sel_hi:[1,0]
    v_mov_b32 v24, 0x3f80
    v_mov_b32 v25, 0x3f80
    ds_write_b64 v10, v[24:25] offset:16896
    v_cvt_pk_bf16_f32 v16, v40, -v41
    v_cvt_pk_bf16_f32 v17, v72, -v73
    ds_write_b64 v10, v[16:17] offset:17424
    v_pk_mul_f32 v[44:45], v[40:41], v[40:41] op_sel_hi:[1,0]
    v_pk_mul_f32 v[76:77], v[72:73], v[72:73] op_sel_hi:[1,0]
    v_pk_fma_f32 v[60:61], v[40:41], v[40:41], v[44:45] op_sel:[1,1,0] op_sel_hi:[0,1,1] neg_lo:[0,1,0]
    v_pk_fma_f32 v[92:93], v[72:73], v[72:73], v[76:77] op_sel:[1,1,0] op_sel_hi:[0,1,1] neg_lo:[0,1,0]
    v_cvt_pk_bf16_f32 v18, v60, -v61
    v_cvt_pk_bf16_f32 v19, v92, -v93
    ds_write_b64 v10, v[18:19] offset:17952
    v_pk_mul_f32 v[44:45], v[60:61], v[40:41] op_sel_hi:[1,0]
    v_pk_mul_f32 v[76:77], v[92:93], v[72:73] op_sel_hi:[1,0]
    v_pk_fma_f32 v[60:61], v[60:61], v[40:41], v[44:45] op_sel:[1,1,0] op_sel_hi:[0,1,1] neg_lo:[0,1,0]
    v_pk_fma_f32 v[92:93], v[92:93], v[72:73], v[76:77] op_sel:[1,1,0] op_sel_hi:[0,1,1] neg_lo:[0,1,0]
    v_cvt_pk_bf16_f32 v20, v60, -v61
    v_cvt_pk_bf16_f32 v21, v92, -v93
    ds_write_b64 v10, v[20:21] offset:18480
    v_pk_mul_f32 v[44:45], v[60:61], v[40:41] op_sel_hi:[1,0]
    v_pk_mul_f32 v[76:77], v[92:93], v[72:73] op_sel_hi:[1,0]
    v_pk_fma_f32 v[60:61], v[60:61], v[40:41], v[44:45] op_sel:[1,1,0] op_sel_hi:[0,1,1] neg_lo:[0,1,0]
    v_pk_fma_f32 v[92:93], v[92:93], v[72:73], v[76:77] op_sel:[1,1,0] op_sel_hi:[0,1,1] neg_lo:[0,1,0]
    v_cvt_pk_bf16_f32 v22, v60, -v61
    v_cvt_pk_bf16_f32 v23, v92, -v93
    ds_write_b64 v10, v[22:23] offset:19008
    v_pk_mul_f32 v[44:45], v[60:61], v[40:41] op_sel_hi:[1,0]
    v_pk_mul_f32 v[76:77], v[92:93], v[72:73] op_sel_hi:[1,0]
    v_pk_fma_f32 v[60:61], v[60:61], v[40:41], v[44:45] op_sel:[1,1,0] op_sel_hi:[0,1,1] neg_lo:[0,1,0]
    v_pk_fma_f32 v[92:93], v[92:93], v[72:73], v[76:77] op_sel:[1,1,0] op_sel_hi:[0,1,1] neg_lo:[0,1,0]
    v_cvt_pk_bf16_f32 v16, v60, -v61
    v_cvt_pk_bf16_f32 v17, v92, -v93
    ds_write_b64 v10, v[16:17] offset:19536
    s_mov_b32 s56, 0x3f803f80
    s_waitcnt vmcnt(0)
    s_barrier
    ds_read_b64 v[96:97], v240 offset:0
    ds_read_b64 v[98:99], v240 offset:1280
    ds_read_b64 v[100:101], v240 offset:256
    ds_read_b64 v[102:103], v240 offset:1536
    ds_read_b64 v[104:105], v240 offset:512
    ds_read_b64 v[106:107], v240 offset:1792
    ds_read_b64 v[108:109], v240 offset:768
    ds_read_b64 v[110:111], v240 offset:2048
    ds_read_b64 v[112:113], v240 offset:1024
    ds_read_b64 v[114:115], v240 offset:2304
    s_waitcnt lgkmcnt(8)
    buffer_store_dwordx4 v[96:99], v241, s[8:11], s57 offen sc1
    s_addk_i32 s57, 8192
    ds_read_b128 v[116:119], v242 offset:0
    s_waitcnt lgkmcnt(7)
    buffer_store_dwordx4 v[100:103], v241, s[8:11], s57 offen sc1
    s_addk_i32 s57, 8192
    ds_read_b128 v[120:123], v242 offset:256
    s_waitcnt lgkmcnt(6)
    buffer_store_dwordx4 v[104:107], v241, s[8:11], s57 offen sc1
    s_addk_i32 s57, 8192
    ds_read_b128 v[124:127], v242 offset:512
    s_waitcnt lgkmcnt(5)
    buffer_store_dwordx4 v[108:111], v241, s[8:11], s57 offen sc1
    s_addk_i32 s57, 8192
    ds_read_b128 v[128:131], v242 offset:768
    s_waitcnt lgkmcnt(4)
    buffer_store_dwordx4 v[112:115], v241, s[8:11], s57 offen sc1
    s_addk_i32 s57, 8192
    ds_read_b128 v[132:135], v242 offset:1024
    s_lshl_b32 s55, s48, 8
    v_mov_b32_e64 v26, s55
    buffer_load_dwordx4 v[28:31], v26, s[12:15], 0 offen sc1
    s_waitcnt lgkmcnt(4)
    v_dot2_f32_bf16 v136, v116, s56, 0
    v_dot2_f32_bf16 v138, v116, v116, 0
    v_dot2_f32_bf16 v137, v117, s56, 0
    v_dot2_f32_bf16 v139, v117, v117, 0
    v_dot2_f32_bf16 v136, v118, s56, v136
    v_dot2_f32_bf16 v138, v118, v118, v138
    v_dot2_f32_bf16 v137, v119, s56, v137
    v_dot2_f32_bf16 v139, v119, v119, v139
    v_pk_mul_f32 v[44:45], v[60:61], v[40:41] op_sel_hi:[1,0]
    v_pk_mul_f32 v[76:77], v[92:93], v[72:73] op_sel_hi:[1,0]
    v_pk_fma_f32 v[60:61], v[60:61], v[40:41], v[44:45] op_sel:[1,1,0] op_sel_hi:[0,1,1] neg_lo:[0,1,0]
    v_pk_fma_f32 v[92:93], v[92:93], v[72:73], v[76:77] op_sel:[1,1,0] op_sel_hi:[0,1,1] neg_lo:[0,1,0]
    v_cvt_pk_bf16_f32 v18, v60, -v61
    v_cvt_pk_bf16_f32 v19, v92, -v93
    ds_write_b64 v10, v[18:19] offset:20064
    s_nop 0
    s_waitcnt lgkmcnt(4)
    v_dot2_f32_bf16 v136, v120, s56, v136
    v_dot2_f32_bf16 v138, v120, v120, v138
    v_dot2_f32_bf16 v137, v121, s56, v137
    v_dot2_f32_bf16 v139, v121, v121, v139
    v_dot2_f32_bf16 v136, v122, s56, v136
    v_dot2_f32_bf16 v138, v122, v122, v138
    v_dot2_f32_bf16 v137, v123, s56, v137
    v_dot2_f32_bf16 v139, v123, v123, v139
    s_nop 0
    s_waitcnt lgkmcnt(3)
    v_dot2_f32_bf16 v136, v124, s56, v136
    v_dot2_f32_bf16 v138, v124, v124, v138
    v_dot2_f32_bf16 v137, v125, s56, v137
    v_dot2_f32_bf16 v139, v125, v125, v139
    v_dot2_f32_bf16 v136, v126, s56, v136
    v_dot2_f32_bf16 v138, v126, v126, v138
    v_dot2_f32_bf16 v137, v127, s56, v137
    v_dot2_f32_bf16 v139, v127, v127, v139
    s_nop 0
    s_waitcnt lgkmcnt(2)
    v_dot2_f32_bf16 v136, v128, s56, v136
    v_dot2_f32_bf16 v138, v128, v128, v138
    v_dot2_f32_bf16 v137, v129, s56, v137
    v_dot2_f32_bf16 v139, v129, v129, v139
    v_dot2_f32_bf16 v136, v130, s56, v136
    v_dot2_f32_bf16 v138, v130, v130, v138
    v_dot2_f32_bf16 v137, v131, s56, v137
    v_dot2_f32_bf16 v139, v131, v131, v139
    s_nop 0
    s_waitcnt lgkmcnt(1)
    v_dot2_f32_bf16 v136, v132, s56, v136
    v_dot2_f32_bf16 v138, v132, v132, v138
    v_dot2_f32_bf16 v137, v133, s56, v137
    v_dot2_f32_bf16 v139, v133, v133, v139
    v_dot2_f32_bf16 v136, v134, s56, v136
    v_dot2_f32_bf16 v138, v134, v134, v138
    v_dot2_f32_bf16 v137, v135, s56, v137
    v_dot2_f32_bf16 v139, v135, v135, v139
    s_nop 1
    v_add_f32 v136, v136, v137
    v_add_f32_e64 v138, v138, v139
    v_pk_mul_f32 v[44:45], v[60:61], v[40:41] op_sel_hi:[1,0]
    v_pk_mul_f32 v[76:77], v[92:93], v[72:73] op_sel_hi:[1,0]
    v_pk_fma_f32 v[60:61], v[60:61], v[40:41], v[44:45] op_sel:[1,1,0] op_sel_hi:[0,1,1] neg_lo:[0,1,0]
    v_pk_fma_f32 v[92:93], v[92:93], v[72:73], v[76:77] op_sel:[1,1,0] op_sel_hi:[0,1,1] neg_lo:[0,1,0]
    v_cvt_pk_bf16_f32 v20, v60, -v61
    v_cvt_pk_bf16_f32 v21, v92, -v93
    ds_write_b64 v10, v[20:21] offset:20592
    v_add_f32_dpp v136, v136, v136 quad_perm:[1,0,3,2] row_mask:0xf bank_mask:0xf
    v_add_f32_dpp v138, v138, v138 quad_perm:[1,0,3,2] row_mask:0xf bank_mask:0xf
    s_nop 0
    v_add_f32_dpp v136, v136, v136 quad_perm:[2,3,0,1] row_mask:0xf bank_mask:0xf
    v_add_f32_dpp v138, v138, v138 quad_perm:[2,3,0,1] row_mask:0xf bank_mask:0xf
    s_nop 0
    v_add_f32_dpp v136, v136, v136 row_half_mirror row_mask:0xf bank_mask:0xf
    v_add_f32_dpp v138, v138, v138 row_half_mirror row_mask:0xf bank_mask:0xf
    s_nop 0
    v_add_f32_dpp v136, v136, v136 row_mirror row_mask:0xf bank_mask:0xf
    v_add_f32_dpp v138, v138, v138 row_mirror row_mask:0xf bank_mask:0xf
    s_mov_b32 s3, 0x3acccccd
    v_mul_f32 v136, s3, v136
    v_mul_f32_e64 v138, s3, v138
    v_fma_f32 v138, -v136, v136, v138
    v_max_f32_e64 v138, 0, v138
    v_cvt_pk_bf16_f32 v138, v138, v138
    v_lshlrev_b32_e64 v138, 16, v138
    v_add_f32 v138, 0x3727c5ac, v138
    v_cvt_pk_bf16_f32 v138, v138, v138
    v_lshlrev_b32_e64 v138, 16, v138
    v_sqrt_f32 v138, v138
    s_nop 0
    v_cvt_pk_bf16_f32 v137, v136, v138
    s_mov_b32 exec_lo, 0x10001
    s_mov_b32 exec_hi, 0x10001
    ds_write_b32 v243, v137
    s_nop 0
    s_mov_b64 exec, -1
    v_pk_mul_f32 v[44:45], v[60:61], v[40:41] op_sel_hi:[1,0]
    v_pk_mul_f32 v[76:77], v[92:93], v[72:73] op_sel_hi:[1,0]
    v_pk_fma_f32 v[60:61], v[60:61], v[40:41], v[44:45] op_sel:[1,1,0] op_sel_hi:[0,1,1] neg_lo:[0,1,0]
    v_pk_fma_f32 v[92:93], v[92:93], v[72:73], v[76:77] op_sel:[1,1,0] op_sel_hi:[0,1,1] neg_lo:[0,1,0]
    v_cvt_pk_bf16_f32 v22, v60, -v61
    v_cvt_pk_bf16_f32 v23, v92, -v93
    ds_write_b64 v10, v[22:23] offset:21120
    v_pk_mul_f32 v[44:45], v[60:61], v[40:41] op_sel_hi:[1,0]
    v_pk_mul_f32 v[76:77], v[92:93], v[72:73] op_sel_hi:[1,0]
    v_pk_fma_f32 v[60:61], v[60:61], v[40:41], v[44:45] op_sel:[1,1,0] op_sel_hi:[0,1,1] neg_lo:[0,1,0]
    v_pk_fma_f32 v[92:93], v[92:93], v[72:73], v[76:77] op_sel:[1,1,0] op_sel_hi:[0,1,1] neg_lo:[0,1,0]
    v_cvt_pk_bf16_f32 v16, v60, -v61
    v_cvt_pk_bf16_f32 v17, v92, -v93
    ds_write_b64 v10, v[16:17] offset:21648
    v_pk_mul_f32 v[44:45], v[60:61], v[40:41] op_sel_hi:[1,0]
    v_pk_mul_f32 v[76:77], v[92:93], v[72:73] op_sel_hi:[1,0]
    v_pk_fma_f32 v[60:61], v[60:61], v[40:41], v[44:45] op_sel:[1,1,0] op_sel_hi:[0,1,1] neg_lo:[0,1,0]
    v_pk_fma_f32 v[92:93], v[92:93], v[72:73], v[76:77] op_sel:[1,1,0] op_sel_hi:[0,1,1] neg_lo:[0,1,0]
    v_cvt_pk_bf16_f32 v18, v60, -v61
    v_cvt_pk_bf16_f32 v19, v92, -v93
    ds_write_b64 v10, v[18:19] offset:22176
    v_pk_mul_f32 v[44:45], v[60:61], v[40:41] op_sel_hi:[1,0]
    v_pk_mul_f32 v[76:77], v[92:93], v[72:73] op_sel_hi:[1,0]
    v_pk_fma_f32 v[60:61], v[60:61], v[40:41], v[44:45] op_sel:[1,1,0] op_sel_hi:[0,1,1] neg_lo:[0,1,0]
    v_pk_fma_f32 v[92:93], v[92:93], v[72:73], v[76:77] op_sel:[1,1,0] op_sel_hi:[0,1,1] neg_lo:[0,1,0]
    v_cvt_pk_bf16_f32 v20, v60, -v61
    v_cvt_pk_bf16_f32 v21, v92, -v93
    ds_write_b64 v10, v[20:21] offset:22704
    v_pk_mul_f32 v[44:45], v[60:61], v[40:41] op_sel_hi:[1,0]
    v_pk_mul_f32 v[76:77], v[92:93], v[72:73] op_sel_hi:[1,0]
    v_pk_fma_f32 v[60:61], v[60:61], v[40:41], v[44:45] op_sel:[1,1,0] op_sel_hi:[0,1,1] neg_lo:[0,1,0]
    v_pk_fma_f32 v[92:93], v[92:93], v[72:73], v[76:77] op_sel:[1,1,0] op_sel_hi:[0,1,1] neg_lo:[0,1,0]
    v_cvt_pk_bf16_f32 v22, v60, -v61
    v_cvt_pk_bf16_f32 v23, v92, -v93
    ds_write_b64 v10, v[22:23] offset:23232
    v_pk_mul_f32 v[44:45], v[60:61], v[40:41] op_sel_hi:[1,0]
    v_pk_mul_f32 v[76:77], v[92:93], v[72:73] op_sel_hi:[1,0]
    v_pk_fma_f32 v[60:61], v[60:61], v[40:41], v[44:45] op_sel:[1,1,0] op_sel_hi:[0,1,1] neg_lo:[0,1,0]
    v_pk_fma_f32 v[92:93], v[92:93], v[72:73], v[76:77] op_sel:[1,1,0] op_sel_hi:[0,1,1] neg_lo:[0,1,0]
    v_cvt_pk_bf16_f32 v16, v60, -v61
    v_cvt_pk_bf16_f32 v17, v92, -v93
    ds_write_b64 v10, v[16:17] offset:23760
    v_pk_mul_f32 v[44:45], v[60:61], v[40:41] op_sel_hi:[1,0]
    v_pk_mul_f32 v[76:77], v[92:93], v[72:73] op_sel_hi:[1,0]
    v_pk_fma_f32 v[60:61], v[60:61], v[40:41], v[44:45] op_sel:[1,1,0] op_sel_hi:[0,1,1] neg_lo:[0,1,0]
    v_pk_fma_f32 v[92:93], v[92:93], v[72:73], v[76:77] op_sel:[1,1,0] op_sel_hi:[0,1,1] neg_lo:[0,1,0]
    v_cvt_pk_bf16_f32 v18, v60, -v61
    v_cvt_pk_bf16_f32 v19, v92, -v93
    ds_write_b64 v10, v[18:19] offset:24288
    v_pk_mul_f32 v[44:45], v[60:61], v[40:41] op_sel_hi:[1,0]
    v_pk_mul_f32 v[76:77], v[92:93], v[72:73] op_sel_hi:[1,0]
    v_pk_fma_f32 v[60:61], v[60:61], v[40:41], v[44:45] op_sel:[1,1,0] op_sel_hi:[0,1,1] neg_lo:[0,1,0]
    v_pk_fma_f32 v[92:93], v[92:93], v[72:73], v[76:77] op_sel:[1,1,0] op_sel_hi:[0,1,1] neg_lo:[0,1,0]
    v_cvt_pk_bf16_f32 v20, v60, -v61
    v_cvt_pk_bf16_f32 v21, v92, -v93
    ds_write_b64 v10, v[20:21] offset:24816
    s_waitcnt vmcnt(0) lgkmcnt(0)
    s_cmp_lg_u32 s48, 0
    s_cbranch_scc1 L_l09
    v_xor_b32 v26, v28, v30
    v_xor_b32 v27, v29, v31
    v_and_b32 v26, v26, v27
    v_cmp_ne_u32 vcc, -1, v26
    s_cbranch_vccz L_ok11
    s_mov_b32 s3, 0
L_poll10:
    s_lshl_b32 s55, s48, 8
    v_mov_b32_e64 v26, s55
    buffer_load_dwordx4 v[28:31], v26, s[12:15], 0 offen sc1
    s_waitcnt vmcnt(0)
    v_xor_b32 v26, v28, v30
    v_xor_b32 v27, v29, v31
    v_and_b32 v26, v26, v27
    v_cmp_ne_u32 vcc, -1, v26
    s_add_u32 s3, s3, 1
    s_cmp_gt_u32 s3, 1000000
    s_cbranch_scc1 L_ok11
    s_cbranch_vccnz L_poll10
L_ok11:
    v_mov_b32 v2, 143040
    ds_write_b64 v2, v[28:29]
    s_waitcnt lgkmcnt(0)
L_l09:
    s_barrier
    v_mov_b32 v2, 143040
    v_and_b32 v26, 7, v1
    v_lshlrev_b32 v26, 3, v26
    v_add_u32 v26, 142976, v26
    ds_read_b64 v[28:29], v2
    ds_read_b64 v[2:3], v26
    s_lshl_b32 s3, s48, 30
    s_or_b32 s3, s3, s60
    v_lshl_add_u32 v27, v1, 4, s3
    s_lshl_b32 s56, s50, 7
    s_waitcnt lgkmcnt(0)
    v_readfirstlane_b32 s0, v28
    v_readfirstlane_b32 s1, v29
    v_mov_b32 v31, v29
    v_mov_b32 v29, v28
    v_mov_b32 v28, v2
    v_mov_b32 v30, v3
    s_mov_b64 exec, 0xff
    buffer_store_dwordx4 v[28:31], v27, s[8:11], s56 offen sc1
    s_mov_b64 exec, -1
    s_movk_i32 s14, 12288
    v_pk_mul_f32 v[44:45], v[60:61], v[40:41] op_sel_hi:[1,0]
    v_pk_mul_f32 v[76:77], v[92:93], v[72:73] op_sel_hi:[1,0]
    v_pk_fma_f32 v[60:61], v[60:61], v[40:41], v[44:45] op_sel:[1,1,0] op_sel_hi:[0,1,1] neg_lo:[0,1,0]
    v_pk_fma_f32 v[92:93], v[92:93], v[72:73], v[76:77] op_sel:[1,1,0] op_sel_hi:[0,1,1] neg_lo:[0,1,0]
    v_cvt_pk_bf16_f32 v22, v60, -v61
    v_cvt_pk_bf16_f32 v23, v92, -v93
    ds_write_b64 v10, v[22:23] offset:25344
    v_pk_mul_f32 v[44:45], v[60:61], v[40:41] op_sel_hi:[1,0]
    v_pk_mul_f32 v[76:77], v[92:93], v[72:73] op_sel_hi:[1,0]
    v_pk_fma_f32 v[60:61], v[60:61], v[40:41], v[44:45] op_sel:[1,1,0] op_sel_hi:[0,1,1] neg_lo:[0,1,0]
    v_pk_fma_f32 v[92:93], v[92:93], v[72:73], v[76:77] op_sel:[1,1,0] op_sel_hi:[0,1,1] neg_lo:[0,1,0]
    v_cvt_pk_bf16_f32 v16, v60, -v61
    v_cvt_pk_bf16_f32 v17, v92, -v93
    ds_write_b64 v10, v[16:17] offset:25872
    v_pk_mul_f32 v[44:45], v[60:61], v[40:41] op_sel_hi:[1,0]
    v_pk_mul_f32 v[76:77], v[92:93], v[72:73] op_sel_hi:[1,0]
    v_pk_fma_f32 v[60:61], v[60:61], v[40:41], v[44:45] op_sel:[1,1,0] op_sel_hi:[0,1,1] neg_lo:[0,1,0]
    v_pk_fma_f32 v[92:93], v[92:93], v[72:73], v[76:77] op_sel:[1,1,0] op_sel_hi:[0,1,1] neg_lo:[0,1,0]
    v_cvt_pk_bf16_f32 v18, v60, -v61
    v_cvt_pk_bf16_f32 v19, v92, -v93
    ds_write_b64 v10, v[18:19] offset:26400
    v_pk_mul_f32 v[44:45], v[60:61], v[40:41] op_sel_hi:[1,0]
    v_pk_mul_f32 v[76:77], v[92:93], v[72:73] op_sel_hi:[1,0]
    v_pk_fma_f32 v[60:61], v[60:61], v[40:41], v[44:45] op_sel:[1,1,0] op_sel_hi:[0,1,1] neg_lo:[0,1,0]
    v_pk_fma_f32 v[92:93], v[92:93], v[72:73], v[76:77] op_sel:[1,1,0] op_sel_hi:[0,1,1] neg_lo:[0,1,0]
    v_cvt_pk_bf16_f32 v20, v60, -v61
    v_cvt_pk_bf16_f32 v21, v92, -v93
    ds_write_b64 v10, v[20:21] offset:26928
    v_pk_mul_f32 v[44:45], v[60:61], v[40:41] op_sel_hi:[1,0]
    v_pk_mul_f32 v[76:77], v[92:93], v[72:73] op_sel_hi:[1,0]
    v_pk_fma_f32 v[60:61], v[60:61], v[40:41], v[44:45] op_sel:[1,1,0] op_sel_hi:[0,1,1] neg_lo:[0,1,0]
    v_pk_fma_f32 v[92:93], v[92:93], v[72:73], v[76:77] op_sel:[1,1,0] op_sel_hi:[0,1,1] neg_lo:[0,1,0]
    v_cvt_pk_bf16_f32 v22, v60, -v61
    v_cvt_pk_bf16_f32 v23, v92, -v93
    ds_write_b64 v10, v[22:23] offset:27456
    v_pk_mul_f32 v[44:45], v[60:61], v[40:41] op_sel_hi:[1,0]
    v_pk_mul_f32 v[76:77], v[92:93], v[72:73] op_sel_hi:[1,0]
    v_pk_fma_f32 v[60:61], v[60:61], v[40:41], v[44:45] op_sel:[1,1,0] op_sel_hi:[0,1,1] neg_lo:[0,1,0]
    v_pk_fma_f32 v[92:93], v[92:93], v[72:73], v[76:77] op_sel:[1,1,0] op_sel_hi:[0,1,1] neg_lo:[0,1,0]
    v_cvt_pk_bf16_f32 v16, v60, -v61
    v_cvt_pk_bf16_f32 v17, v92, -v93
    ds_write_b64 v10, v[16:17] offset:27984
    v_pk_mul_f32 v[44:45], v[60:61], v[40:41] op_sel_hi:[1,0]
    v_pk_mul_f32 v[76:77], v[92:93], v[72:73] op_sel_hi:[1,0]
    v_pk_fma_f32 v[60:61], v[60:61], v[40:41], v[44:45] op_sel:[1,1,0] op_sel_hi:[0,1,1] neg_lo:[0,1,0]
    v_pk_fma_f32 v[92:93], v[92:93], v[72:73], v[76:77] op_sel:[1,1,0] op_sel_hi:[0,1,1] neg_lo:[0,1,0]
    v_cvt_pk_bf16_f32 v18, v60, -v61
    v_cvt_pk_bf16_f32 v19, v92, -v93
    ds_write_b64 v10, v[18:19] offset:28512
    v_pk_mul_f32 v[44:45], v[60:61], v[40:41] op_sel_hi:[1,0]
    v_pk_mul_f32 v[76:77], v[92:93], v[72:73] op_sel_hi:[1,0]
    v_pk_fma_f32 v[60:61], v[60:61], v[40:41], v[44:45] op_sel:[1,1,0] op_sel_hi:[0,1,1] neg_lo:[0,1,0]
    v_pk_fma_f32 v[92:93], v[92:93], v[72:73], v[76:77] op_sel:[1,1,0] op_sel_hi:[0,1,1] neg_lo:[0,1,0]
    v_cvt_pk_bf16_f32 v20, v60, -v61
    v_cvt_pk_bf16_f32 v21, v92, -v93
    ds_write_b64 v10, v[20:21] offset:29040
    v_pk_mul_f32 v[44:45], v[60:61], v[40:41] op_sel_hi:[1,0]
    v_pk_mul_f32 v[76:77], v[92:93], v[72:73] op_sel_hi:[1,0]
    v_pk_fma_f32 v[60:61], v[60:61], v[40:41], v[44:45] op_sel:[1,1,0] op_sel_hi:[0,1,1] neg_lo:[0,1,0]
    v_pk_fma_f32 v[92:93], v[92:93], v[72:73], v[76:77] op_sel:[1,1,0] op_sel_hi:[0,1,1] neg_lo:[0,1,0]
    v_cvt_pk_bf16_f32 v22, v60, -v61
    v_cvt_pk_bf16_f32 v23, v92, -v93
    ds_write_b64 v10, v[22:23] offset:29568
    v_pk_mul_f32 v[44:45], v[60:61], v[40:41] op_sel_hi:[1,0]
    v_pk_mul_f32 v[76:77], v[92:93], v[72:73] op_sel_hi:[1,0]
    v_pk_fma_f32 v[60:61], v[60:61], v[40:41], v[44:45] op_sel:[1,1,0] op_sel_hi:[0,1,1] neg_lo:[0,1,0]
    v_pk_fma_f32 v[92:93], v[92:93], v[72:73], v[76:77] op_sel:[1,1,0] op_sel_hi:[0,1,1] neg_lo:[0,1,0]
    v_cvt_pk_bf16_f32 v16, v60, -v61
    v_cvt_pk_bf16_f32 v17, v92, -v93
    ds_write_b64 v10, v[16:17] offset:30096
    v_pk_mul_f32 v[44:45], v[60:61], v[40:41] op_sel_hi:[1,0]
    v_pk_mul_f32 v[76:77], v[92:93], v[72:73] op_sel_hi:[1,0]
    v_pk_fma_f32 v[60:61], v[60:61], v[40:41], v[44:45] op_sel:[1,1,0] op_sel_hi:[0,1,1] neg_lo:[0,1,0]
    v_pk_fma_f32 v[92:93], v[92:93], v[72:73], v[76:77] op_sel:[1,1,0] op_sel_hi:[0,1,1] neg_lo:[0,1,0]
    v_cvt_pk_bf16_f32 v18, v60, -v61
    v_cvt_pk_bf16_f32 v19, v92, -v93
    ds_write_b64 v10, v[18:19] offset:30624
    v_pk_mul_f32 v[44:45], v[60:61], v[40:41] op_sel_hi:[1,0]
    v_pk_mul_f32 v[76:77], v[92:93], v[72:73] op_sel_hi:[1,0]
    v_pk_fma_f32 v[60:61], v[60:61], v[40:41], v[44:45] op_sel:[1,1,0] op_sel_hi:[0,1,1] neg_lo:[0,1,0]
    v_pk_fma_f32 v[92:93], v[92:93], v[72:73], v[76:77] op_sel:[1,1,0] op_sel_hi:[0,1,1] neg_lo:[0,1,0]
    v_cvt_pk_bf16_f32 v20, v60, -v61
    v_cvt_pk_bf16_f32 v21, v92, -v93
    ds_write_b64 v10, v[20:21] offset:31152
    v_pk_mul_f32 v[44:45], v[60:61], v[40:41] op_sel_hi:[1,0]
    v_pk_mul_f32 v[76:77], v[92:93], v[72:73] op_sel_hi:[1,0]
    v_pk_fma_f32 v[60:61], v[60:61], v[40:41], v[44:45] op_sel:[1,1,0] op_sel_hi:[0,1,1] neg_lo:[0,1,0]
    v_pk_fma_f32 v[92:93], v[92:93], v[72:73], v[76:77] op_sel:[1,1,0] op_sel_hi:[0,1,1] neg_lo:[0,1,0]
    v_cvt_pk_bf16_f32 v22, v60, -v61
    v_cvt_pk_bf16_f32 v23, v92, -v93
    ds_write_b64 v10, v[22:23] offset:31680
    v_pk_mul_f32 v[44:45], v[60:61], v[40:41] op_sel_hi:[1,0]
    v_pk_mul_f32 v[76:77], v[92:93], v[72:73] op_sel_hi:[1,0]
    v_pk_fma_f32 v[60:61], v[60:61], v[40:41], v[44:45] op_sel:[1,1,0] op_sel_hi:[0,1,1] neg_lo:[0,1,0]
    v_pk_fma_f32 v[92:93], v[92:93], v[72:73], v[76:77] op_sel:[1,1,0] op_sel_hi:[0,1,1] neg_lo:[0,1,0]
    v_cvt_pk_bf16_f32 v16, v60, -v61
    v_cvt_pk_bf16_f32 v17, v92, -v93
    ds_write_b64 v10, v[16:17] offset:32208
    v_pk_mul_f32 v[44:45], v[60:61], v[40:41] op_sel_hi:[1,0]
    v_pk_mul_f32 v[76:77], v[92:93], v[72:73] op_sel_hi:[1,0]
    v_pk_fma_f32 v[60:61], v[60:61], v[40:41], v[44:45] op_sel:[1,1,0] op_sel_hi:[0,1,1] neg_lo:[0,1,0]
    v_pk_fma_f32 v[92:93], v[92:93], v[72:73], v[76:77] op_sel:[1,1,0] op_sel_hi:[0,1,1] neg_lo:[0,1,0]
    v_cvt_pk_bf16_f32 v18, v60, -v61
    v_cvt_pk_bf16_f32 v19, v92, -v93
    ds_write_b64 v10, v[18:19] offset:32736
    v_pk_mul_f32 v[44:45], v[60:61], v[40:41] op_sel_hi:[1,0]
    v_pk_mul_f32 v[76:77], v[92:93], v[72:73] op_sel_hi:[1,0]
    v_pk_fma_f32 v[60:61], v[60:61], v[40:41], v[44:45] op_sel:[1,1,0] op_sel_hi:[0,1,1] neg_lo:[0,1,0]
    v_pk_fma_f32 v[92:93], v[92:93], v[72:73], v[76:77] op_sel:[1,1,0] op_sel_hi:[0,1,1] neg_lo:[0,1,0]
    v_cvt_pk_bf16_f32 v20, v60, -v61
    v_cvt_pk_bf16_f32 v21, v92, -v93
    ds_write_b64 v10, v[20:21] offset:33264
    v_cvt_pk_bf16_f32 v22, v48, v49
    v_cvt_pk_bf16_f32 v23, v80, v81
    ds_write_b64 v10, v[22:23] offset:0
    v_pk_mul_f32 v[44:45], v[48:49], v[38:39] op_sel_hi:[1,0]
    v_pk_mul_f32 v[76:77], v[80:81], v[70:71] op_sel_hi:[1,0]
    v_pk_fma_f32 v[60:61], v[48:49], v[38:39], v[44:45] op_sel:[1,1,0] op_sel_hi:[0,1,1] neg_lo:[0,1,0]
    v_pk_fma_f32 v[92:93], v[80:81], v[70:71], v[76:77] op_sel:[1,1,0] op_sel_hi:[0,1,1] neg_lo:[0,1,0]
    v_cvt_pk_bf16_f32 v16, v60, v61
    v_cvt_pk_bf16_f32 v17, v92, v93
    ds_write_b64 v10, v[16:17] offset:528
    v_pk_mul_f32 v[44:45], v[60:61], v[38:39] op_sel_hi:[1,0]
    v_pk_mul_f32 v[76:77], v[92:93], v[70:71] op_sel_hi:[1,0]
    v_pk_fma_f32 v[50:51], v[60:61], v[38:39], v[44:45] op_sel:[1,1,0] op_sel_hi:[0,1,1] neg_lo:[0,1,0]
    v_pk_fma_f32 v[82:83], v[92:93], v[70:71], v[76:77] op_sel:[1,1,0] op_sel_hi:[0,1,1] neg_lo:[0,1,0]
    v_cvt_pk_bf16_f32 v18, v50, v51
    v_cvt_pk_bf16_f32 v19, v82, v83
    ds_write_b64 v10, v[18:19] offset:1056
    v_pk_mul_f32 v[44:45], v[50:51], v[38:39] op_sel_hi:[1,0]
    v_pk_mul_f32 v[76:77], v[82:83], v[70:71] op_sel_hi:[1,0]
    v_pk_fma_f32 v[60:61], v[50:51], v[38:39], v[44:45] op_sel:[1,1,0] op_sel_hi:[0,1,1] neg_lo:[0,1,0]
    v_pk_fma_f32 v[92:93], v[82:83], v[70:71], v[76:77] op_sel:[1,1,0] op_sel_hi:[0,1,1] neg_lo:[0,1,0]
    v_cvt_pk_bf16_f32 v20, v60, v61
    v_cvt_pk_bf16_f32 v21, v92, v93
    ds_write_b64 v10, v[20:21] offset:1584
    v_pk_mul_f32 v[44:45], v[60:61], v[38:39] op_sel_hi:[1,0]
    v_pk_mul_f32 v[76:77], v[92:93], v[70:71] op_sel_hi:[1,0]
    v_pk_fma_f32 v[52:53], v[60:61], v[38:39], v[44:45] op_sel:[1,1,0] op_sel_hi:[0,1,1] neg_lo:[0,1,0]
    v_pk_fma_f32 v[84:85], v[92:93], v[70:71], v[76:77] op_sel:[1,1,0] op_sel_hi:[0,1,1] neg_lo:[0,1,0]
    v_cvt_pk_bf16_f32 v22, v52, v53
    v_cvt_pk_bf16_f32 v23, v84, v85
    ds_write_b64 v10, v[22:23] offset:2112
    v_pk_mul_f32 v[44:45], v[52:53], v[38:39] op_sel_hi:[1,0]
    v_pk_mul_f32 v[76:77], v[84:85], v[70:71] op_sel_hi:[1,0]
    v_pk_fma_f32 v[60:61], v[52:53], v[38:39], v[44:45] op_sel:[1,1,0] op_sel_hi:[0,1,1] neg_lo:[0,1,0]
    v_pk_fma_f32 v[92:93], v[84:85], v[70:71], v[76:77] op_sel:[1,1,0] op_sel_hi:[0,1,1] neg_lo:[0,1,0]
    v_cvt_pk_bf16_f32 v16, v60, v61
    v_cvt_pk_bf16_f32 v17, v92, v93
    ds_write_b64 v10, v[16:17] offset:2640
    v_pk_mul_f32 v[44:45], v[60:61], v[38:39] op_sel_hi:[1,0]
    v_pk_mul_f32 v[76:77], v[92:93], v[70:71] op_sel_hi:[1,0]
    v_pk_fma_f32 v[54:55], v[60:61], v[38:39], v[44:45] op_sel:[1,1,0] op_sel_hi:[0,1,1] neg_lo:[0,1,0]
    v_pk_fma_f32 v[86:87], v[92:93], v[70:71], v[76:77] op_sel:[1,1,0] op_sel_hi:[0,1,1] neg_lo:[0,1,0]
    v_cvt_pk_bf16_f32 v18, v54, v55
    v_cvt_pk_bf16_f32 v19, v86, v87
    ds_write_b64 v10, v[18:19] offset:3168
    v_pk_mul_f32 v[44:45], v[54:55], v[38:39] op_sel_hi:[1,0]
    v_pk_mul_f32 v[76:77], v[86:87], v[70:71] op_sel_hi:[1,0]
    v_pk_fma_f32 v[60:61], v[54:55], v[38:39], v[44:45] op_sel:[1,1,0] op_sel_hi:[0,1,1] neg_lo:[0,1,0]
    v_pk_fma_f32 v[92:93], v[86:87], v[70:71], v[76:77] op_sel:[1,1,0] op_sel_hi:[0,1,1] neg_lo:[0,1,0]
    v_cvt_pk_bf16_f32 v20, v60, v61
    v_cvt_pk_bf16_f32 v21, v92, v93
    ds_write_b64 v10, v[20:21] offset:3696
    v_pk_mul_f32 v[44:45], v[60:61], v[38:39] op_sel_hi:[1,0]
    v_pk_mul_f32 v[76:77], v[92:93], v[70:71] op_sel_hi:[1,0]
    v_pk_fma_f32 v[56:57], v[60:61], v[38:39], v[44:45] op_sel:[1,1,0] op_sel_hi:[0,1,1] neg_lo:[0,1,0]
    v_pk_fma_f32 v[88:89], v[92:93], v[70:71], v[76:77] op_sel:[1,1,0] op_sel_hi:[0,1,1] neg_lo:[0,1,0]
    v_cvt_pk_bf16_f32 v22, v56, v57
    v_cvt_pk_bf16_f32 v23, v88, v89
    ds_write_b64 v10, v[22:23] offset:4224
    v_pk_mul_f32 v[44:45], v[56:57], v[38:39] op_sel_hi:[1,0]
    v_pk_mul_f32 v[76:77], v[88:89], v[70:71] op_sel_hi:[1,0]
    v_pk_fma_f32 v[60:61], v[56:57], v[38:39], v[44:45] op_sel:[1,1,0] op_sel_hi:[0,1,1] neg_lo:[0,1,0]
    v_pk_fma_f32 v[92:93], v[88:89], v[70:71], v[76:77] op_sel:[1,1,0] op_sel_hi:[0,1,1] neg_lo:[0,1,0]
    v_cvt_pk_bf16_f32 v16, v60, v61
    v_cvt_pk_bf16_f32 v17, v92, v93
    ds_write_b64 v10, v[16:17] offset:4752
    v_pk_mul_f32 v[44:45], v[60:61], v[38:39] op_sel_hi:[1,0]
    v_pk_mul_f32 v[76:77], v[92:93], v[70:71] op_sel_hi:[1,0]
    v_pk_fma_f32 v[58:59], v[60:61], v[38:39], v[44:45] op_sel:[1,1,0] op_sel_hi:[0,1,1] neg_lo:[0,1,0]
    v_pk_fma_f32 v[90:91], v[92:93], v[70:71], v[76:77] op_sel:[1,1,0] op_sel_hi:[0,1,1] neg_lo:[0,1,0]
    v_cvt_pk_bf16_f32 v18, v58, v59
    v_cvt_pk_bf16_f32 v19, v90, v91
    ds_write_b64 v10, v[18:19] offset:5280
    v_pk_mul_f32 v[44:45], v[48:49], v[42:43] op_sel_hi:[1,0]
    v_pk_mul_f32 v[76:77], v[80:81], v[74:75] op_sel_hi:[1,0]
    v_pk_fma_f32 v[48:49], v[48:49], v[42:43], v[44:45] op_sel:[1,1,0] op_sel_hi:[0,1,1] neg_lo:[0,1,0]
    v_pk_fma_f32 v[80:81], v[80:81], v[74:75], v[76:77] op_sel:[1,1,0] op_sel_hi:[0,1,1] neg_lo:[0,1,0]
    v_cvt_pk_bf16_f32 v20, v48, v49
    v_cvt_pk_bf16_f32 v21, v80, v81
    ds_write_b64 v10, v[20:21] offset:8448
    v_pk_mul_f32 v[44:45], v[50:51], v[42:43] op_sel_hi:[1,0]
    v_pk_mul_f32 v[76:77], v[82:83], v[74:75] op_sel_hi:[1,0]
    v_pk_fma_f32 v[50:51], v[50:51], v[42:43], v[44:45] op_sel:[1,1,0] op_sel_hi:[0,1,1] neg_lo:[0,1,0]
    v_pk_fma_f32 v[82:83], v[82:83], v[74:75], v[76:77] op_sel:[1,1,0] op_sel_hi:[0,1,1] neg_lo:[0,1,0]
    v_cvt_pk_bf16_f32 v22, v50, v51
    v_cvt_pk_bf16_f32 v23, v82, v83
    ds_write_b64 v10, v[22:23] offset:9504
    v_pk_mul_f32 v[44:45], v[52:53], v[42:43] op_sel_hi:[1,0]
    v_pk_mul_f32 v[76:77], v[84:85], v[74:75] op_sel_hi:[1,0]
    v_pk_fma_f32 v[52:53], v[52:53], v[42:43], v[44:45] op_sel:[1,1,0] op_sel_hi:[0,1,1] neg_lo:[0,1,0]
    v_pk_fma_f32 v[84:85], v[84:85], v[74:75], v[76:77] op_sel:[1,1,0] op_sel_hi:[0,1,1] neg_lo:[0,1,0]
    v_cvt_pk_bf16_f32 v16, v52, v53
    v_cvt_pk_bf16_f32 v17, v84, v85
    ds_write_b64 v10, v[16:17] offset:10560
    v_pk_mul_f32 v[44:45], v[54:55], v[42:43] op_sel_hi:[1,0]
    v_pk_mul_f32 v[76:77], v[86:87], v[74:75] op_sel_hi:[1,0]
    v_pk_fma_f32 v[54:55], v[54:55], v[42:43], v[44:45] op_sel:[1,1,0] op_sel_hi:[0,1,1] neg_lo:[0,1,0]
    v_pk_fma_f32 v[86:87], v[86:87], v[74:75], v[76:77] op_sel:[1,1,0] op_sel_hi:[0,1,1] neg_lo:[0,1,0]
    v_cvt_pk_bf16_f32 v18, v54, v55
    v_cvt_pk_bf16_f32 v19, v86, v87
    ds_write_b64 v10, v[18:19] offset:11616
    v_pk_mul_f32 v[44:45], v[56:57], v[42:43] op_sel_hi:[1,0]
    v_pk_mul_f32 v[76:77], v[88:89], v[74:75] op_sel_hi:[1,0]
    v_pk_fma_f32 v[56:57], v[56:57], v[42:43], v[44:45] op_sel:[1,1,0] op_sel_hi:[0,1,1] neg_lo:[0,1,0]
    v_pk_fma_f32 v[88:89], v[88:89], v[74:75], v[76:77] op_sel:[1,1,0] op_sel_hi:[0,1,1] neg_lo:[0,1,0]
    v_cvt_pk_bf16_f32 v20, v56, v57
    v_cvt_pk_bf16_f32 v21, v88, v89
    ds_write_b64 v10, v[20:21] offset:12672
    v_pk_mul_f32 v[44:45], v[58:59], v[42:43] op_sel_hi:[1,0]
    v_pk_mul_f32 v[76:77], v[90:91], v[74:75] op_sel_hi:[1,0]
    v_pk_fma_f32 v[58:59], v[58:59], v[42:43], v[44:45] op_sel:[1,1,0] op_sel_hi:[0,1,1] neg_lo:[0,1,0]
    v_pk_fma_f32 v[90:91], v[90:91], v[74:75], v[76:77] op_sel:[1,1,0] op_sel_hi:[0,1,1] neg_lo:[0,1,0]
    v_cvt_pk_bf16_f32 v22, v58, v59
    v_cvt_pk_bf16_f32 v23, v90, v91
    ds_write_b64 v10, v[22:23] offset:13728
    v_pk_mul_f32 v[44:45], v[48:49], v[42:43] op_sel_hi:[1,0]
    v_pk_mul_f32 v[76:77], v[80:81], v[74:75] op_sel_hi:[1,0]
    v_pk_fma_f32 v[48:49], v[48:49], v[42:43], v[44:45] op_sel:[1,1,0] op_sel_hi:[0,1,1] neg_lo:[0,1,0]
    v_pk_fma_f32 v[80:81], v[80:81], v[74:75], v[76:77] op_sel:[1,1,0] op_sel_hi:[0,1,1] neg_lo:[0,1,0]
    v_cvt_pk_bf16_f32 v16, v48, v49
    v_cvt_pk_bf16_f32 v17, v80, v81
    ds_write_b64 v10, v[16:17] offset:5808
    v_pk_mul_f32 v[44:45], v[52:53], v[42:43] op_sel_hi:[1,0]
    v_pk_mul_f32 v[76:77], v[84:85], v[74:75] op_sel_hi:[1,0]
    v_pk_fma_f32 v[52:53], v[52:53], v[42:43], v[44:45] op_sel:[1,1,0] op_sel_hi:[0,1,1] neg_lo:[0,1,0]
    v_pk_fma_f32 v[84:85], v[84:85], v[74:75], v[76:77] op_sel:[1,1,0] op_sel_hi:[0,1,1] neg_lo:[0,1,0]
    v_cvt_pk_bf16_f32 v18, v52, v53
    v_cvt_pk_bf16_f32 v19, v84, v85
    ds_write_b64 v10, v[18:19] offset:6336
    v_pk_mul_f32 v[44:45], v[56:57], v[42:43] op_sel_hi:[1,0]
    v_pk_mul_f32 v[76:77], v[88:89], v[74:75] op_sel_hi:[1,0]
    v_pk_fma_f32 v[56:57], v[56:57], v[42:43], v[44:45] op_sel:[1,1,0] op_sel_hi:[0,1,1] neg_lo:[0,1,0]
    v_pk_fma_f32 v[88:89], v[88:89], v[74:75], v[76:77] op_sel:[1,1,0] op_sel_hi:[0,1,1] neg_lo:[0,1,0]
    v_cvt_pk_bf16_f32 v20, v56, v57
    v_cvt_pk_bf16_f32 v21, v88, v89
    ds_write_b64 v10, v[20:21] offset:6864
    v_pk_mul_f32 v[44:45], v[48:49], v[42:43] op_sel_hi:[1,0]
    v_pk_mul_f32 v[76:77], v[80:81], v[74:75] op_sel_hi:[1,0]
    v_pk_fma_f32 v[48:49], v[48:49], v[42:43], v[44:45] op_sel:[1,1,0] op_sel_hi:[0,1,1] neg_lo:[0,1,0]
    v_pk_fma_f32 v[80:81], v[80:81], v[74:75], v[76:77] op_sel:[1,1,0] op_sel_hi:[0,1,1] neg_lo:[0,1,0]
    v_cvt_pk_bf16_f32 v22, v48, v49
    v_cvt_pk_bf16_f32 v23, v80, v81
    ds_write_b64 v10, v[22:23] offset:14256
    v_pk_mul_f32 v[44:45], v[52:53], v[42:43] op_sel_hi:[1,0]
    v_pk_mul_f32 v[76:77], v[84:85], v[74:75] op_sel_hi:[1,0]
    v_pk_fma_f32 v[52:53], v[52:53], v[42:43], v[44:45] op_sel:[1,1,0] op_sel_hi:[0,1,1] neg_lo:[0,1,0]
    v_pk_fma_f32 v[84:85], v[84:85], v[74:75], v[76:77] op_sel:[1,1,0] op_sel_hi:[0,1,1] neg_lo:[0,1,0]
    v_cvt_pk_bf16_f32 v16, v52, v53
    v_cvt_pk_bf16_f32 v17, v84, v85
    ds_write_b64 v10, v[16:17] offset:14784
    v_pk_mul_f32 v[44:45], v[56:57], v[42:43] op_sel_hi:[1,0]
    v_pk_mul_f32 v[76:77], v[88:89], v[74:75] op_sel_hi:[1,0]
    v_pk_fma_f32 v[56:57], v[56:57], v[42:43], v[44:45] op_sel:[1,1,0] op_sel_hi:[0,1,1] neg_lo:[0,1,0]
    v_pk_fma_f32 v[88:89], v[88:89], v[74:75], v[76:77] op_sel:[1,1,0] op_sel_hi:[0,1,1] neg_lo:[0,1,0]
    v_cvt_pk_bf16_f32 v18, v56, v57
    v_cvt_pk_bf16_f32 v19, v88, v89
    ds_write_b64 v10, v[18:19] offset:15312
    v_pk_mul_f32 v[44:45], v[48:49], v[42:43] op_sel_hi:[1,0]
    v_pk_mul_f32 v[76:77], v[80:81], v[74:75] op_sel_hi:[1,0]
    v_pk_fma_f32 v[48:49], v[48:49], v[42:43], v[44:45] op_sel:[1,1,0] op_sel_hi:[0,1,1] neg_lo:[0,1,0]
    v_pk_fma_f32 v[80:81], v[80:81], v[74:75], v[76:77] op_sel:[1,1,0] op_sel_hi:[0,1,1] neg_lo:[0,1,0]
    v_cvt_pk_bf16_f32 v20, v48, v49
    v_cvt_pk_bf16_f32 v21, v80, v81
    ds_write_b64 v10, v[20:21] offset:7392
    v_pk_mul_f32 v[44:45], v[48:49], v[42:43] op_sel_hi:[1,0]
    v_pk_mul_f32 v[76:77], v[80:81], v[74:75] op_sel_hi:[1,0]
    v_pk_fma_f32 v[48:49], v[48:49], v[42:43], v[44:45] op_sel:[1,1,0] op_sel_hi:[0,1,1] neg_lo:[0,1,0]
    v_pk_fma_f32 v[80:81], v[80:81], v[74:75], v[76:77] op_sel:[1,1,0] op_sel_hi:[0,1,1] neg_lo:[0,1,0]
    v_cvt_pk_bf16_f32 v22, v48, v49
    v_cvt_pk_bf16_f32 v23, v80, v81
    ds_write_b64 v10, v[22:23] offset:15840
    v_pk_mul_f32 v[44:45], v[48:49], v[42:43] op_sel_hi:[1,0]
    v_pk_mul_f32 v[76:77], v[80:81], v[74:75] op_sel_hi:[1,0]
    v_pk_fma_f32 v[48:49], v[48:49], v[42:43], v[44:45] op_sel:[1,1,0] op_sel_hi:[0,1,1] neg_lo:[0,1,0]
    v_pk_fma_f32 v[80:81], v[80:81], v[74:75], v[76:77] op_sel:[1,1,0] op_sel_hi:[0,1,1] neg_lo:[0,1,0]
    v_cvt_pk_bf16_f32 v16, v48, v49
    v_cvt_pk_bf16_f32 v17, v80, v81
    ds_write_b64 v10, v[16:17] offset:7920
    v_pk_mul_f32 v[44:45], v[48:49], v[42:43] op_sel_hi:[1,0]
    v_pk_mul_f32 v[76:77], v[80:81], v[74:75] op_sel_hi:[1,0]
    v_pk_fma_f32 v[48:49], v[48:49], v[42:43], v[44:45] op_sel:[1,1,0] op_sel_hi:[0,1,1] neg_lo:[0,1,0]
    v_pk_fma_f32 v[80:81], v[80:81], v[74:75], v[76:77] op_sel:[1,1,0] op_sel_hi:[0,1,1] neg_lo:[0,1,0]
    v_cvt_pk_bf16_f32 v18, v48, v49
    v_cvt_pk_bf16_f32 v19, v80, v81
    ds_write_b64 v10, v[18:19] offset:16368
    buffer_load_dwordx4 v[196:199], v193, s[8:11], 0 offen sc1
    buffer_load_dwordx4 v[200:203], v193, s[8:11], s72 offen sc1
    buffer_load_dwordx4 v[204:207], v193, s[8:11], s73 offen sc1
    buffer_load_dwordx4 v[208:211], v193, s[8:11], s14 offen sc1
    v_pk_mul_f32 v[44:45], v[48:49], v[42:43] op_sel_hi:[1,0]
    v_pk_mul_f32 v[76:77], v[80:81], v[74:75] op_sel_hi:[1,0]
    v_pk_fma_f32 v[48:49], v[48:49], v[42:43], v[44:45] op_sel:[1,1,0] op_sel_hi:[0,1,1] neg_lo:[0,1,0]
    v_pk_fma_f32 v[80:81], v[80:81], v[74:75], v[76:77] op_sel:[1,1,0] op_sel_hi:[0,1,1] neg_lo:[0,1,0]
    s_waitcnt lgkmcnt(0)
    ds_read_b128 v[112:115], v11 offset:0
    ds_read_b128 v[116:119], v13 offset:0
    ds_read_b128 v[120:123], v11 offset:32
    ds_read_b128 v[124:127], v13 offset:32
    ds_read_b128 v[128:131], v11 offset:64
    ds_read_b128 v[132:135], v13 offset:64
    s_waitcnt lgkmcnt(4)
    v_mfma_f32_32x32x16_bf16 v[96:111], v[112:115], v[116:119], 0
    ds_read_b128 v[136:139], v11 offset:96
    ds_read_b128 v[140:143], v13 offset:96
    v_add_f32 v14, v48, v80
    s_waitcnt lgkmcnt(4)
    v_mfma_f32_32x32x16_bf16 v[96:111], v[120:123], v[124:127], v[96:111]
    ds_read_b128 v[112:115], v11 offset:128
    ds_read_b128 v[116:119], v13 offset:128
    v_add_f32_dpp v14, v14, v14 quad_perm:[1,0,3,2] row_mask:0xf bank_mask:0xf
    s_waitcnt lgkmcnt(4)
    v_mfma_f32_32x32x16_bf16 v[96:111], v[128:131], v[132:135], v[96:111]
    ds_read_b128 v[120:123], v11 offset:160
    ds_read_b128 v[124:127], v13 offset:160
    v_add_f32_dpp v14, v14, v14 quad_perm:[2,3,0,1] row_mask:0xf bank_mask:0xf
    s_waitcnt lgkmcnt(4)
    v_mfma_f32_32x32x16_bf16 v[96:111], v[136:139], v[140:143], v[96:111]
    ds_read_b128 v[128:131], v11 offset:192
    ds_read_b128 v[132:135], v13 offset:192
    v_add_f32_dpp v14, v14, v14 row_half_mirror row_mask:0xf bank_mask:0xf
    s_waitcnt lgkmcnt(4)
    v_mfma_f32_32x32x16_bf16 v[96:111], v[112:115], v[116:119], v[96:111]
    ds_read_b128 v[136:139], v11 offset:224
    ds_read_b128 v[140:143], v13 offset:224
    v_add_f32_dpp v14, v14, v14 row_mirror row_mask:0xf bank_mask:0xf
    s_waitcnt lgkmcnt(4)
    v_mfma_f32_32x32x16_bf16 v[96:111], v[120:123], v[124:127], v[96:111]
    ds_read_b128 v[112:115], v11 offset:256
    ds_read_b128 v[116:119], v13 offset:256
    v_add_f32_dpp v14, v14, v14 row_bcast:15 row_mask:0xa bank_mask:0xf
    s_waitcnt lgkmcnt(4)
    v_mfma_f32_32x32x16_bf16 v[96:111], v[128:131], v[132:135], v[96:111]
    ds_read_b128 v[120:123], v11 offset:288
    ds_read_b128 v[124:127], v13 offset:288
    v_add_f32_dpp v14, v14, v14 row_bcast:31 row_mask:0xc bank_mask:0xf
    s_waitcnt lgkmcnt(4)
    v_mfma_f32_32x32x16_bf16 v[96:111], v[136:139], v[140:143], v[96:111]
    ds_read_b128 v[128:131], v11 offset:320
    ds_read_b128 v[132:135], v13 offset:320
    v_readlane_b32 s56, v14, 63
    s_waitcnt lgkmcnt(4)
    v_mfma_f32_32x32x16_bf16 v[96:111], v[112:115], v[116:119], v[96:111]
    ds_read_b128 v[136:139], v11 offset:352
    ds_read_b128 v[140:143], v13 offset:352
    v_mov_b32 v20, 0
    v_mov_b32 v21, 0
    s_waitcnt lgkmcnt(4)
    v_mfma_f32_32x32x16_bf16 v[96:111], v[120:123], v[124:127], v[96:111]
    ds_read_b128 v[112:115], v11 offset:384
    ds_read_b128 v[116:119], v13 offset:384
    v_mov_b32 v22, 0
    v_mov_b32 v23, 0
    s_waitcnt lgkmcnt(4)
    v_mfma_f32_32x32x16_bf16 v[96:111], v[128:131], v[132:135], v[96:111]
    ds_read_b128 v[120:123], v11 offset:416
    ds_read_b128 v[124:127], v13 offset:416
    s_waitcnt lgkmcnt(4)
    v_mfma_f32_32x32x16_bf16 v[96:111], v[136:139], v[140:143], v[96:111]
    ds_read_b128 v[128:131], v11 offset:448
    ds_read_b128 v[132:135], v13 offset:448
    s_waitcnt vmcnt(0)
    v_xor_b32 v2, s0, v197
    v_xor_b32 v3, s1, v199
    v_or_b32 v15, v2, v3
    v_xor_b32 v2, s0, v201
    v_xor_b32 v3, s1, v203
    v_or3_b32 v15, v2, v3, v15
    v_xor_b32 v2, s0, v205
    v_xor_b32 v3, s1, v207
    v_or3_b32 v15, v2, v3, v15
    v_xor_b32 v2, s0, v209
    v_xor_b32 v3, s1, v211
    v_or3_b32 v15, v2, v3, v15
    v_cmp_ne_u32_e64 vcc, 0, v15
    s_cbranch_vccz L_ok13
    s_mov_b32 s3, 0
L_poll12:
    buffer_load_dwordx4 v[196:199], v193, s[8:11], 0 offen sc1
    buffer_load_dwordx4 v[200:203], v193, s[8:11], s72 offen sc1
    buffer_load_dwordx4 v[204:207], v193, s[8:11], s73 offen sc1
    buffer_load_dwordx4 v[208:211], v193, s[8:11], s14 offen sc1
    s_waitcnt vmcnt(0)
    v_xor_b32 v2, s0, v197
    v_xor_b32 v3, s1, v199
    v_or_b32 v15, v2, v3
    v_xor_b32 v2, s0, v201
    v_xor_b32 v3, s1, v203
    v_or3_b32 v15, v2, v3, v15
    v_xor_b32 v2, s0, v205
    v_xor_b32 v3, s1, v207
    v_or3_b32 v15, v2, v3, v15
    v_xor_b32 v2, s0, v209
    v_xor_b32 v3, s1, v211
    v_or3_b32 v15, v2, v3, v15
    v_cmp_ne_u32 vcc, 0, v15
    s_add_u32 s3, s3, 1
    s_cmp_gt_u32 s3, 1000000
    s_cbranch_scc1 L_ok13
    s_cbranch_vccnz L_poll12
L_ok13:
    v_and_b32 v228, 0xffff0000, v196
    v_lshlrev_b32_e64 v229, 16, v196
    v_rcp_f32 v228, v228
    s_waitcnt lgkmcnt(4)
    v_mfma_f32_32x32x16_bf16 v[96:111], v[112:115], v[116:119], v[96:111]
    ds_read_b128 v[136:139], v11 offset:480
    ds_read_b128 v[140:143], v13 offset:480
    buffer_load_dwordx4 v[212:215], v192, s[8:11], s75 offen sc1
    s_add_u32 s75, s75, 655360
    v_and_b32 v230, 0xffff0000, v198
    v_lshlrev_b32_e64 v231, 16, v198
    v_rcp_f32 v230, v230
    v_mul_f32 v229, -v229, v228
    s_waitcnt lgkmcnt(4)
    v_mfma_f32_32x32x16_bf16 v[96:111], v[120:123], v[124:127], v[96:111]
    buffer_load_dwordx4 v[216:219], v192, s[8:11], s75 offen sc1
    s_add_u32 s75, s75, 655360
    v_and_b32 v232, 0xffff0000, v200
    v_lshlrev_b32_e64 v233, 16, v200
    v_rcp_f32 v232, v232
    v_mul_f32 v231, -v231, v230
    s_waitcnt lgkmcnt(2)
    v_mfma_f32_32x32x16_bf16 v[96:111], v[128:131], v[132:135], v[96:111]
    buffer_load_dwordx4 v[220:223], v192, s[8:11], s75 offen sc1
    s_add_u32 s75, s75, 655360
    v_and_b32 v234, 0xffff0000, v202
    v_lshlrev_b32_e64 v235, 16, v202
    v_rcp_f32 v234, v234
    v_mul_f32 v233, -v233, v232
    s_waitcnt lgkmcnt(0)
    v_mfma_f32_32x32x16_bf16 v[96:111], v[136:139], v[140:143], v[96:111]
    buffer_load_dwordx4 v[224:227], v192, s[8:11], s75 offen sc1
    s_add_u32 s75, s75, 655360
    v_and_b32 v236, 0xffff0000, v204
    v_lshlrev_b32 v237, 16, v204
    v_rcp_f32 v236, v236
    v_mul_f32 v235, -v235, v234
    v_and_b32 v238, 0xffff0000, v206
    v_lshlrev_b32 v239, 16, v206
    v_rcp_f32 v238, v238
    v_mul_f32 v237, -v237, v236
    v_and_b32 v240, 0xffff0000, v208
    v_lshlrev_b32 v241, 16, v208
    v_rcp_f32 v240, v240
    v_mul_f32 v239, -v239, v238
    v_and_b32 v242, 0xffff0000, v210
    v_lshlrev_b32 v243, 16, v210
    v_rcp_f32 v242, v242
    v_mul_f32 v241, -v241, v240
    v_mul_f32 v243, -v243, v242
    s_mul_i32 s55, s48, 3072
    s_add_u32 s55, s55, 22151168
    v_min_u32 v26, 23, v1
    v_lshlrev_b32 v26, 7, v26
    buffer_load_dwordx2 v[28:29], v26, s[8:11], s55 offen sc1
    ds_write_b128 v253, v[20:23] offset:9472
    ds_write_b128 v253, v[20:23] offset:10496
    s_barrier
    v_cmp_eq_u32 vcc, 31, v1
    v_cndmask_b32 v24, 0, v96, s[70:71]
    v_cndmask_b32 v25, 0, v97, s[70:71]
    v_cndmask_b32 v18, 0, v98, s[70:71]
    v_cndmask_b32 v105, v105, v104, vcc
    v_cmp_eq_u32 vcc, 63, v1
    v_cndmask_b32 v19, 0, v110, s[70:71]
    v_writelane_b32 v110, s56, 0
    v_cndmask_b32_e64 v106, v106, v104, vcc
    v_mov_b32_dpp v24, v24 row_shr:1 row_mask:0xf bank_mask:0xf bound_ctrl:1
    v_mov_b32_dpp v25, v25 row_shr:1 row_mask:0xf bank_mask:0xf bound_ctrl:1
    v_mov_b32_dpp v18, v18 row_shr:1 row_mask:0xf bank_mask:0xf bound_ctrl:1
    v_cvt_pk_bf16_f32 v14, v110, v111
    v_cvt_pk_bf16_f32 v32, v106, v105
    v_cvt_pk_bf16_f32 v33, v104, v103
    v_cvt_pk_bf16_f32 v34, v102, v101
    v_cvt_pk_bf16_f32 v35, v100, v99
    ds_write_b128 v12, v[32:35] offset:1088
    v_cvt_pk_bf16_f32 v36, v105, v104
    v_cvt_pk_bf16_f32 v37, v103, v102
    v_cvt_pk_bf16_f32 v38, v101, v100
    v_cvt_pk_bf16_f32 v39, v99, v98
    ds_write_b128 v12, v[36:39] offset:3456
    v_cvt_pk_bf16_f32 v40, v104, v103
    v_cvt_pk_bf16_f32 v41, v102, v101
    v_cvt_pk_bf16_f32 v42, v100, v99
    v_cvt_pk_bf16_f32 v43, v98, v97
    ds_write_b128 v12, v[40:43] offset:5824
    v_cvt_pk_bf16_f32 v44, v103, v102
    v_cvt_pk_bf16_f32 v45, v101, v100
    v_cvt_pk_bf16_f32 v46, v99, v98
    v_cvt_pk_bf16_f32 v47, v97, v96
    ds_write_b128 v12, v[44:47] offset:8192
    ds_write_b16 v254, v14 offset:0
    ds_write_b16 v254, v14 offset:190
    ds_write_b16 v254, v14 offset:380
    ds_write_b16 v254, v14 offset:570
    v_cvt_pk_bf16_f32 v48, v109, v109
    v_cvt_pk_bf16_f32 v49, v109, v109
    v_cvt_pk_bf16_f32 v50, v109, v108
    v_cvt_pk_bf16_f32 v51, v108, v108
    ds_write_b128 v12, v[48:51] offset:64
    v_cvt_pk_bf16_f32 v52, v109, v109
    v_cvt_pk_bf16_f32 v53, v109, v109
    v_cvt_pk_bf16_f32 v54, v108, v108
    v_cvt_pk_bf16_f32 v55, v108, v107
    ds_write_b128 v12, v[52:55] offset:2432
    v_cvt_pk_bf16_f32 v56, v109, v109
    v_cvt_pk_bf16_f32 v57, v109, v108
    v_cvt_pk_bf16_f32 v58, v108, v108
    v_cvt_pk_bf16_f32 v59, v107, v107
    ds_write_b128 v12, v[56:59] offset:4800
    v_cvt_pk_bf16_f32 v60, v109, v109
    v_cvt_pk_bf16_f32 v61, v108, v108
    v_cvt_pk_bf16_f32 v62, v108, v107
    v_cvt_pk_bf16_f32 v63, v107, v107
    ds_write_b128 v12, v[60:63] offset:7168
    ds_write_b16_d16_hi v255, v14 offset:0
    ds_write_b16_d16_hi v255, v14 offset:190
    ds_write_b16_d16_hi v255, v14 offset:380
    ds_write_b16_d16_hi v255, v14 offset:570
    v_cvt_pk_bf16_f32 v32, v18, v25
    v_cvt_pk_bf16_f32 v33, v24, v20
    v_cvt_pk_bf16_f32 v34, v20, v20
    v_cvt_pk_bf16_f32 v35, v19, v19
    v_cvt_pk_bf16_f32 v36, v25, v24
    v_cvt_pk_bf16_f32 v37, v20, v20
    v_cvt_pk_bf16_f32 v38, v20, v19
    v_cvt_pk_bf16_f32 v39, v19, v19
    v_cvt_pk_bf16_f32 v40, v24, v20
    v_cvt_pk_bf16_f32 v41, v20, v20
    v_cvt_pk_bf16_f32 v42, v19, v19
    v_cvt_pk_bf16_f32 v43, v19, v19
    v_cvt_pk_bf16_f32 v44, v20, v20
    v_cvt_pk_bf16_f32 v45, v20, v19
    v_cvt_pk_bf16_f32 v46, v19, v19
    v_cvt_pk_bf16_f32 v47, v19, v19
    s_nop 0
    s_mov_b64 exec, 63
    ds_write_b128 v252, v[32:35] offset:0
    ds_write_b128 v252, v[36:39] offset:2368
    ds_write_b128 v252, v[40:43] offset:4736
    ds_write_b128 v252, v[44:47] offset:7104
    s_mov_b64 exec, -1
L_stage2:
    s_waitcnt vmcnt(4)
    v_lshlrev_b32_e64 v128, 16, v212
    v_and_b32 v129, 0xffff0000, v212
    v_lshlrev_b32_e64 v130, 16, v213
    v_and_b32 v131, 0xffff0000, v213
    v_lshlrev_b32_e64 v132, 16, v214
    v_and_b32 v133, 0xffff0000, v214
    v_lshlrev_b32_e64 v134, 16, v215
    v_and_b32 v135, 0xffff0000, v215
    v_pk_fma_f32 v[160:161], v[128:129], v[228:229], v[228:229] op_sel:[0,0,1] op_sel_hi:[1,0,1]
    v_pk_fma_f32 v[162:163], v[130:131], v[228:229], v[228:229] op_sel:[0,0,1] op_sel_hi:[1,0,1]
    v_pk_fma_f32 v[164:165], v[132:133], v[230:231], v[230:231] op_sel:[0,0,1] op_sel_hi:[1,0,1]
    v_pk_fma_f32 v[166:167], v[134:135], v[230:231], v[230:231] op_sel:[0,0,1] op_sel_hi:[1,0,1]
    v_cvt_pk_bf16_f32 v196, v160, v164
    v_cvt_pk_bf16_f32 v197, v161, v165
    v_cvt_pk_bf16_f32 v198, v162, v166
    v_cvt_pk_bf16_f32 v199, v163, v167
    ds_write_b32 v194, v196 offset:0
    ds_write_b32 v194, v197 offset:33856
    ds_write_b32 v195, v198 offset:0
    ds_write_b32 v195, v199 offset:33856
    s_waitcnt vmcnt(3)
    v_lshlrev_b32 v136, 16, v216
    v_and_b32 v137, 0xffff0000, v216
    v_lshlrev_b32_e64 v138, 16, v217
    v_and_b32 v139, 0xffff0000, v217
    v_lshlrev_b32_e64 v140, 16, v218
    v_and_b32 v141, 0xffff0000, v218
    v_lshlrev_b32_e64 v142, 16, v219
    v_and_b32 v143, 0xffff0000, v219
    v_pk_fma_f32 v[168:169], v[136:137], v[232:233], v[232:233] op_sel:[0,0,1] op_sel_hi:[1,0,1]
    v_pk_fma_f32 v[170:171], v[138:139], v[232:233], v[232:233] op_sel:[0,0,1] op_sel_hi:[1,0,1]
    v_pk_fma_f32 v[172:173], v[140:141], v[234:235], v[234:235] op_sel:[0,0,1] op_sel_hi:[1,0,1]
    v_pk_fma_f32 v[174:175], v[142:143], v[234:235], v[234:235] op_sel:[0,0,1] op_sel_hi:[1,0,1]
    v_cvt_pk_bf16_f32 v200, v168, v172
    v_cvt_pk_bf16_f32 v201, v169, v173
    v_cvt_pk_bf16_f32 v202, v170, v174
    v_cvt_pk_bf16_f32 v203, v171, v175
    ds_write_b32 v194, v200 offset:1024
    ds_write_b32 v194, v201 offset:34880
    ds_write_b32 v195, v202 offset:1024
    ds_write_b32 v195, v203 offset:34880
    s_waitcnt vmcnt(2)
    v_lshlrev_b32 v144, 16, v220
    v_and_b32 v145, 0xffff0000, v220
    v_lshlrev_b32_e64 v146, 16, v221
    v_and_b32 v147, 0xffff0000, v221
    v_lshlrev_b32_e64 v148, 16, v222
    v_and_b32 v149, 0xffff0000, v222
    v_lshlrev_b32_e64 v150, 16, v223
    v_and_b32 v151, 0xffff0000, v223
    v_pk_fma_f32 v[176:177], v[144:145], v[236:237], v[236:237] op_sel:[0,0,1] op_sel_hi:[1,0,1]
    v_pk_fma_f32 v[178:179], v[146:147], v[236:237], v[236:237] op_sel:[0,0,1] op_sel_hi:[1,0,1]
    v_pk_fma_f32 v[180:181], v[148:149], v[238:239], v[238:239] op_sel:[0,0,1] op_sel_hi:[1,0,1]
    v_pk_fma_f32 v[182:183], v[150:151], v[238:239], v[238:239] op_sel:[0,0,1] op_sel_hi:[1,0,1]
    v_cvt_pk_bf16_f32 v204, v176, v180
    v_cvt_pk_bf16_f32 v205, v177, v181
    v_cvt_pk_bf16_f32 v206, v178, v182
    v_cvt_pk_bf16_f32 v207, v179, v183
    ds_write_b32 v194, v204 offset:2048
    ds_write_b32 v194, v205 offset:35904
    ds_write_b32 v195, v206 offset:2048
    ds_write_b32 v195, v207 offset:35904
    s_waitcnt vmcnt(1)
    v_lshlrev_b32 v152, 16, v224
    v_and_b32 v153, 0xffff0000, v224
    v_lshlrev_b32_e64 v154, 16, v225
    v_and_b32 v155, 0xffff0000, v225
    v_lshlrev_b32_e64 v156, 16, v226
    v_and_b32 v157, 0xffff0000, v226
    v_lshlrev_b32_e64 v158, 16, v227
    v_and_b32 v159, 0xffff0000, v227
    v_pk_fma_f32 v[184:185], v[152:153], v[240:241], v[240:241] op_sel:[0,0,1] op_sel_hi:[1,0,1]
    v_pk_fma_f32 v[186:187], v[154:155], v[240:241], v[240:241] op_sel:[0,0,1] op_sel_hi:[1,0,1]
    v_pk_fma_f32 v[188:189], v[156:157], v[242:243], v[242:243] op_sel:[0,0,1] op_sel_hi:[1,0,1]
    v_pk_fma_f32 v[190:191], v[158:159], v[242:243], v[242:243] op_sel:[0,0,1] op_sel_hi:[1,0,1]
    v_cvt_pk_bf16_f32 v208, v184, v188
    v_cvt_pk_bf16_f32 v209, v185, v189
    v_cvt_pk_bf16_f32 v210, v186, v190
    v_cvt_pk_bf16_f32 v211, v187, v191
    ds_write_b32 v194, v208 offset:3072
    ds_write_b32 v194, v209 offset:36928
    ds_write_b32 v195, v210 offset:3072
    ds_write_b32 v195, v211 offset:36928
    ds_read_b64 a[0:1], v6 offset:2048
    ds_read_b64 a[2:3], v6 offset:2056
    ds_read_b64 a[4:5], v6 offset:1536
    ds_read_b64 a[6:7], v6 offset:1544
    ds_read_b64 a[8:9], v6 offset:1024
    ds_read_b64 a[10:11], v6 offset:1032
    ds_read_b64 a[12:13], v6 offset:512
    ds_read_b64 a[14:15], v6 offset:520
    ds_read_b64 a[32:33], v6 offset:0
    ds_read_b64 a[34:35], v6 offset:8
    s_waitcnt vmcnt(0)
    v_xor_b32 v28, s0, v28
    v_xor_b32 v29, s1, v29
    v_or_b32 v26, v28, v29
    v_cmp_ne_u32_e64 vcc, 0, v26
    s_cbranch_vccz L_ok15
    s_mov_b32 s3, 0
L_poll14:
    s_mul_i32 s55, s48, 3072
    s_add_u32 s55, s55, 22151168
    v_min_u32 v26, 23, v1
    v_lshlrev_b32 v26, 7, v26
    buffer_load_dwordx2 v[28:29], v26, s[8:11], s55 offen sc1
    s_waitcnt vmcnt(0)
    v_xor_b32 v28, s0, v28
    v_xor_b32 v29, s1, v29
    v_or_b32 v26, v28, v29
    v_cmp_ne_u32 vcc, 0, v26
    s_add_u32 s3, s3, 1
    s_cmp_gt_u32 s3, 1000000
    s_cbranch_scc1 L_ok15
    s_cbranch_vccnz L_poll14
L_ok15:
    s_waitcnt lgkmcnt(10)
    s_barrier
    ds_read_b128 v[64:67], v7 offset:480
    ds_read_b128 v[68:71], v7 offset:992
    ds_read_b128 v[72:75], v7 offset:1504
    ds_read_b128 v[76:79], v7 offset:2016
    ds_read_b128 v[80:83], v7 offset:2528
    ds_read_b128 v[84:87], v7 offset:3040
    ds_read_b128 v[88:91], v7 offset:3552
    ds_read_b128 v[92:95], v7 offset:4064
    s_waitcnt lgkmcnt(7)
    v_mfma_f32_16x16x32_bf16 v[32:35], a[0:3], v[64:67], 0
    buffer_load_dwordx4 a[80:83], v4, s[8:11], s63 offen offset:0 sc1
    s_waitcnt lgkmcnt(6)
    v_mfma_f32_16x16x32_bf16 v[36:39], a[0:3], v[68:71], 0
    ds_read_b64 a[16:17], v6 offset:1984
    ds_read_b64 a[18:19], v6 offset:1992
    s_waitcnt lgkmcnt(7)
    v_mfma_f32_16x16x32_bf16 v[40:43], a[0:3], v[72:75], 0
    ds_read_b128 v[96:99], v7 offset:416
    s_waitcnt lgkmcnt(7)
    v_mfma_f32_16x16x32_bf16 v[44:47], a[0:3], v[76:79], 0
    ds_read_b64 a[20:21], v6 offset:1472
    ds_read_b64 a[22:23], v6 offset:1480
    s_waitcnt lgkmcnt(8)
    v_mfma_f32_16x16x32_bf16 v[48:51], a[0:3], v[80:83], 0
    ds_read_b128 v[100:103], v7 offset:928
    s_waitcnt lgkmcnt(8)
    v_mfma_f32_16x16x32_bf16 v[52:55], a[0:3], v[84:87], 0
    ds_read_b64 a[24:25], v6 offset:960
    ds_read_b64 a[26:27], v6 offset:968
    s_waitcnt lgkmcnt(9)
    v_mfma_f32_16x16x32_bf16 v[56:59], a[0:3], v[88:91], 0
    buffer_load_dwordx4 a[84:87], v4, s[8:11], s63 offen offset:1024 sc1
    s_waitcnt lgkmcnt(8)
    v_mfma_f32_16x16x32_bf16 v[60:63], a[0:3], v[92:95], 0
    ds_read_b128 v[104:107], v7 offset:1440
    v_mfma_f32_16x16x32_bf16 v[36:39], a[4:7], v[64:67], v[36:39]
    ds_read_b64 a[28:29], v6 offset:448
    ds_read_b64 a[30:31], v6 offset:456
    v_mfma_f32_16x16x32_bf16 v[40:43], a[4:7], v[68:71], v[40:43]
    ds_read_b128 v[108:111], v7 offset:1952
    ds_read_b128 v[112:115], v7 offset:2464
    v_mfma_f32_16x16x32_bf16 v[44:47], a[4:7], v[72:75], v[44:47]
    ds_read_b128 v[116:119], v7 offset:2976
    ds_read_b128 v[120:123], v7 offset:3488
    v_mfma_f32_16x16x32_bf16 v[48:51], a[4:7], v[76:79], v[48:51]
    ds_read_b128 v[124:127], v7 offset:4000
    v_mfma_f32_16x16x32_bf16 v[52:55], a[4:7], v[80:83], v[52:55]
    buffer_load_dwordx4 a[88:91], v4, s[8:11], s63 offen offset:2048 sc1
    v_mfma_f32_16x16x32_bf16 v[56:59], a[4:7], v[84:87], v[56:59]
    v_lshlrev_b32 v16, 3, v251
    v_sub_u32 v16, v250, v16
    v_mfma_f32_16x16x32_bf16 v[60:63], a[4:7], v[88:91], v[60:63]
    v_add_u32_e64 v18, 36, v16
    s_mov_b32 s72, 0x1ff
    v_mfma_f32_16x16x32_bf16 v[40:43], a[8:11], v[64:67], v[40:43]
    s_mov_b32 s73, 0
    v_add_u32 v19, 37, v16
    v_mfma_f32_16x16x32_bf16 v[44:47], a[8:11], v[68:71], v[44:47]
    v_lshlrev_b64 v[20:21], v18, s[72:73]
    s_mov_b32 s72, 0x7f
    v_mfma_f32_16x16x32_bf16 v[48:51], a[8:11], v[72:75], v[48:51]
    v_lshlrev_b64 v[22:23], v19, s[72:73]
    s_movk_i32 s73, 0x3f80
    v_mfma_f32_16x16x32_bf16 v[52:55], a[8:11], v[76:79], v[52:55]
    buffer_load_dwordx4 a[92:95], v4, s[8:11], s63 offen offset:3072 sc1
    v_mfma_f32_16x16x32_bf16 v[56:59], a[8:11], v[80:83], v[56:59]
    v_mov_b32 v14, v250
    v_mov_b32_e64 v15, v251
    v_mfma_f32_16x16x32_bf16 v[60:63], a[8:11], v[84:87], v[60:63]
    v_bfe_u32 v244, v21, 0, 2
    v_lshl_or_b32 v244, v244, 15, v244
    v_mfma_f32_16x16x32_bf16 v[44:47], a[12:15], v[64:67], v[44:47]
    v_mfma_f32_16x16x32_bf16 v[48:51], a[12:15], v[68:71], v[48:51]
    v_mfma_f32_16x16x32_bf16 v[52:55], a[12:15], v[72:75], v[52:55]
    v_mfma_f32_16x16x32_bf16 v[56:59], a[12:15], v[76:79], v[56:59]
    s_addk_i32 s63, 4096
    buffer_load_dwordx4 a[96:99], v4, s[8:11], s63 offen offset:0 sc1
    v_mfma_f32_16x16x32_bf16 v[60:63], a[12:15], v[80:83], v[60:63]
    v_mfma_f32_16x16x32_bf16 v[48:51], a[32:35], v[64:67], v[48:51]
    v_mfma_f32_16x16x32_bf16 v[52:55], a[32:35], v[68:71], v[52:55]
    v_mfma_f32_16x16x32_bf16 v[56:59], a[32:35], v[72:75], v[56:59]
    v_mfma_f32_16x16x32_bf16 v[60:63], a[32:35], v[76:79], v[60:63]
    s_waitcnt lgkmcnt(0)
    v_mfma_f32_16x16x32_bf16 v[32:35], a[16:19], v[96:99], v[32:35]
    buffer_load_dwordx4 a[100:103], v4, s[8:11], s63 offen offset:1024 sc1
    v_mfma_f32_16x16x32_bf16 v[36:39], a[16:19], v[100:103], v[36:39]
    ds_read_b64 a[0:1], v6 offset:1920
    ds_read_b64 a[2:3], v6 offset:1928
    v_mfma_f32_16x16x32_bf16 v[40:43], a[16:19], v[104:107], v[40:43]
    ds_read_b128 v[64:67], v7 offset:352
    v_mfma_f32_16x16x32_bf16 v[44:47], a[16:19], v[108:111], v[44:47]
    ds_read_b64 a[4:5], v6 offset:1408
    ds_read_b64 a[6:7], v6 offset:1416
    v_mfma_f32_16x16x32_bf16 v[48:51], a[16:19], v[112:115], v[48:51]
    ds_read_b128 v[68:71], v7 offset:864
    v_mfma_f32_16x16x32_bf16 v[52:55], a[16:19], v[116:119], v[52:55]
    buffer_load_dwordx4 a[104:107], v4, s[8:11], s63 offen offset:2048 sc1
    v_mfma_f32_16x16x32_bf16 v[56:59], a[16:19], v[120:123], v[56:59]
    ds_read_b64 a[8:9], v6 offset:896
    ds_read_b64 a[10:11], v6 offset:904
    v_mfma_f32_16x16x32_bf16 v[60:63], a[16:19], v[124:127], v[60:63]
    ds_read_b128 v[72:75], v7 offset:1376
    v_mfma_f32_16x16x32_bf16 v[36:39], a[20:23], v[96:99], v[36:39]
    ds_read_b64 a[12:13], v6 offset:384
    ds_read_b64 a[14:15], v6 offset:392
    v_mfma_f32_16x16x32_bf16 v[40:43], a[20:23], v[100:103], v[40:43]
    ds_read_b128 v[76:79], v7 offset:1888
    ds_read_b128 v[80:83], v7 offset:2400
    v_mfma_f32_16x16x32_bf16 v[44:47], a[20:23], v[104:107], v[44:47]
    buffer_load_dwordx4 a[108:111], v4, s[8:11], s63 offen offset:3072 sc1
    v_mfma_f32_16x16x32_bf16 v[48:51], a[20:23], v[108:111], v[48:51]
    ds_read_b128 v[84:87], v7 offset:2912
    ds_read_b128 v[88:91], v7 offset:3424
    v_mfma_f32_16x16x32_bf16 v[52:55], a[20:23], v[112:115], v[52:55]
    ds_read_b128 v[92:95], v7 offset:3936
    v_mfma_f32_16x16x32_bf16 v[56:59], a[20:23], v[116:119], v[56:59]
    v_and_b32 v244, 0x10001, v244
    v_mul_u32_u24_e64 v244, s73, v244
    v_mfma_f32_16x16x32_bf16 v[60:63], a[20:23], v[120:123], v[60:63]
    v_bfe_u32 v245, v21, 2, 2
    v_lshl_or_b32 v245, v245, 15, v245
    v_mfma_f32_16x16x32_bf16 v[40:43], a[24:27], v[96:99], v[40:43]
    s_add_u32 s63, s63, 4096
    buffer_load_dwordx4 a[112:115], v4, s[8:11], s63 offen offset:0 sc1
    v_mfma_f32_16x16x32_bf16 v[44:47], a[24:27], v[100:103], v[44:47]
    v_and_b32 v245, 0x10001, v245
    v_mul_u32_u24_e64 v245, s73, v245
    v_mfma_f32_16x16x32_bf16 v[48:51], a[24:27], v[104:107], v[48:51]
    v_bfe_u32 v246, v21, 4, 2
    v_lshl_or_b32 v246, v246, 15, v246
    v_mfma_f32_16x16x32_bf16 v[52:55], a[24:27], v[108:111], v[52:55]
    v_and_b32 v246, 0x10001, v246
    v_mul_u32_u24_e64 v246, s73, v246
    v_mfma_f32_16x16x32_bf16 v[56:59], a[24:27], v[112:115], v[56:59]
    v_bfe_u32 v247, v21, 6, 2
    v_lshl_or_b32 v247, v247, 15, v247
    v_mfma_f32_16x16x32_bf16 v[60:63], a[24:27], v[116:119], v[60:63]
    buffer_load_dwordx4 a[116:119], v4, s[8:11], s63 offen offset:1024 sc1
    v_mfma_f32_16x16x32_bf16 v[44:47], a[28:31], v[96:99], v[44:47]
    v_and_b32 v247, 0x10001, v247
    v_mul_u32_u24 v247, s73, v247
    v_mfma_f32_16x16x32_bf16 v[48:51], a[28:31], v[100:103], v[48:51]
    v_bfe_u32 v248, v23, 0, 2
    v_lshl_or_b32 v248, v248, 15, v248
    v_mfma_f32_16x16x32_bf16 v[52:55], a[28:31], v[104:107], v[52:55]
    ds_read_b128 a[36:39], v7 offset:464
    ds_read_b128 a[40:43], v7 offset:976
    v_mfma_f32_16x16x32_bf16 v[56:59], a[28:31], v[108:111], v[56:59]
    ds_read_b128 a[44:47], v7 offset:1488
    ds_read_b128 a[48:51], v7 offset:2000
    v_mfma_f32_16x16x32_bf16 v[60:63], a[28:31], v[112:115], v[60:63]
    ds_read_b128 a[52:55], v7 offset:480
    ds_read_b128 a[56:59], v7 offset:992
    ds_read_b128 a[60:63], v7 offset:1504
    ds_read_b128 a[64:67], v7 offset:2016
    s_waitcnt lgkmcnt(0)
    v_mfma_f32_16x16x32_bf16 v[32:35], a[0:3], v[64:67], v[32:35]
    buffer_load_dwordx4 a[120:123], v4, s[8:11], s63 offen offset:2048 sc1
    v_mfma_f32_16x16x32_bf16 v[36:39], a[0:3], v[68:71], v[36:39]
    ds_read_b64 a[16:17], v6 offset:1856
    ds_read_b64 a[18:19], v6 offset:1864
    v_mfma_f32_16x16x32_bf16 v[40:43], a[0:3], v[72:75], v[40:43]
    ds_read_b128 v[96:99], v7 offset:288
    v_mfma_f32_16x16x32_bf16 v[44:47], a[0:3], v[76:79], v[44:47]
    ds_read_b64 a[20:21], v6 offset:1344
    ds_read_b64 a[22:23], v6 offset:1352
    v_mfma_f32_16x16x32_bf16 v[48:51], a[0:3], v[80:83], v[48:51]
    ds_read_b128 v[100:103], v7 offset:800
    v_mfma_f32_16x16x32_bf16 v[52:55], a[0:3], v[84:87], v[52:55]
    ds_read_b64 a[24:25], v6 offset:832
    ds_read_b64 a[26:27], v6 offset:840
    v_mfma_f32_16x16x32_bf16 v[56:59], a[0:3], v[88:91], v[56:59]
    buffer_load_dwordx4 a[124:127], v4, s[8:11], s63 offen offset:3072 sc1
    v_mfma_f32_16x16x32_bf16 v[60:63], a[0:3], v[92:95], v[60:63]
    ds_read_b128 v[104:107], v7 offset:1312
    v_mfma_f32_16x16x32_bf16 v[36:39], a[4:7], v[64:67], v[36:39]
    ds_read_b64 a[28:29], v6 offset:320
    ds_read_b64 a[30:31], v6 offset:328
    v_mfma_f32_16x16x32_bf16 v[40:43], a[4:7], v[68:71], v[40:43]
    ds_read_b128 v[108:111], v7 offset:1824
    ds_read_b128 v[112:115], v7 offset:2336
    v_mfma_f32_16x16x32_bf16 v[44:47], a[4:7], v[72:75], v[44:47]
    ds_read_b128 v[116:119], v7 offset:2848
    ds_read_b128 v[120:123], v7 offset:3360
    v_mfma_f32_16x16x32_bf16 v[48:51], a[4:7], v[76:79], v[48:51]
    ds_read_b128 v[124:127], v7 offset:3872
    v_mfma_f32_16x16x32_bf16 v[52:55], a[4:7], v[80:83], v[52:55]
    v_and_b32 v248, 0x10001, v248
    v_mul_u32_u24_e64 v248, s73, v248
    v_mfma_f32_16x16x32_bf16 v[56:59], a[4:7], v[84:87], v[56:59]
    s_add_u32 s63, s63, 4096
    buffer_load_dwordx4 a[128:131], v4, s[8:11], s63 offen offset:0 sc1
    v_mfma_f32_16x16x32_bf16 v[60:63], a[4:7], v[88:91], v[60:63]
    v_bfe_u32 v249, v23, 2, 2
    v_lshl_or_b32 v249, v249, 15, v249
    v_mfma_f32_16x16x32_bf16 v[40:43], a[8:11], v[64:67], v[40:43]
    v_and_b32 v249, 0x10001, v249
    v_mul_u32_u24_e64 v249, s73, v249
    v_mfma_f32_16x16x32_bf16 v[44:47], a[8:11], v[68:71], v[44:47]
    v_bfe_u32 v250, v23, 4, 2
    v_lshl_or_b32 v250, v250, 15, v250
    v_mfma_f32_16x16x32_bf16 v[48:51], a[8:11], v[72:75], v[48:51]
    v_and_b32 v250, 0x10001, v250
    v_mul_u32_u24_e64 v250, s73, v250
    v_mfma_f32_16x16x32_bf16 v[52:55], a[8:11], v[76:79], v[52:55]
    v_bfe_u32 v251, v23, 6, 2
    v_lshl_or_b32 v251, v251, 15, v251
    v_mfma_f32_16x16x32_bf16 v[56:59], a[8:11], v[80:83], v[56:59]
    v_and_b32 v251, 0x10001, v251
    v_mul_u32_u24_e64 v251, s73, v251
    v_mfma_f32_16x16x32_bf16 v[60:63], a[8:11], v[84:87], v[60:63]
    buffer_load_dwordx4 a[132:135], v4, s[8:11], s63 offen offset:1024 sc1
    v_mfma_f32_16x16x32_bf16 v[44:47], a[12:15], v[64:67], v[44:47]
    v_sub_u32 v16, 3, v14
    v_and_b32 v16, 3, v16
    v_mfma_f32_16x16x32_bf16 v[48:51], a[12:15], v[68:71], v[48:51]
    v_add_u32 v17, v14, v16
    v_sub_u32 v17, 15, v17
    v_mfma_f32_16x16x32_bf16 v[52:55], a[12:15], v[72:75], v[52:55]
    v_lshl_add_u32 v17, v15, 2, v17
    v_lshlrev_b32_e64 v17, 1, v17
    v_mfma_f32_16x16x32_bf16 v[56:59], a[12:15], v[76:79], v[56:59]
    v_mul_u32_u24 v16, 192, v16
    s_add_u32 s72, s76, 9472
    v_mfma_f32_16x16x32_bf16 v[60:63], a[12:15], v[80:83], v[60:63]
    v_add3_u32 v5, v17, v16, s72
    v_mfma_f32_16x16x32_bf16 v[196:199], a[36:39], v[244:247], 0
    v_mfma_f32_16x16x32_bf16 v[200:203], a[40:43], v[244:247], 0
    buffer_load_dwordx4 a[136:139], v4, s[8:11], s63 offen offset:2048 sc1
    v_mfma_f32_16x16x32_bf16 v[204:207], a[44:47], v[244:247], 0
    v_mfma_f32_16x16x32_bf16 v[208:211], a[48:51], v[244:247], 0
    v_mfma_f32_16x16x32_bf16 v[212:215], a[52:55], v[248:251], 0
    v_mfma_f32_16x16x32_bf16 v[216:219], a[56:59], v[248:251], 0
    v_mfma_f32_16x16x32_bf16 v[220:223], a[60:63], v[248:251], 0
    v_mfma_f32_16x16x32_bf16 v[224:227], a[64:67], v[248:251], 0
    s_waitcnt lgkmcnt(0)
    v_mfma_f32_16x16x32_bf16 v[32:35], a[16:19], v[96:99], v[32:35]
    buffer_load_dwordx4 a[140:143], v4, s[8:11], s63 offen offset:3072 sc1
    v_mfma_f32_16x16x32_bf16 v[36:39], a[16:19], v[100:103], v[36:39]
    ds_read_b64 a[0:1], v6 offset:1792
    ds_read_b64 a[2:3], v6 offset:1800
    v_mfma_f32_16x16x32_bf16 v[40:43], a[16:19], v[104:107], v[40:43]
    ds_read_b128 v[64:67], v7 offset:224
    v_mfma_f32_16x16x32_bf16 v[44:47], a[16:19], v[108:111], v[44:47]
    ds_read_b64 a[4:5], v6 offset:1280
    ds_read_b64 a[6:7], v6 offset:1288
    v_mfma_f32_16x16x32_bf16 v[48:51], a[16:19], v[112:115], v[48:51]
    ds_read_b128 v[68:71], v7 offset:736
    v_mfma_f32_16x16x32_bf16 v[52:55], a[16:19], v[116:119], v[52:55]
    s_addk_i32 s63, 4096
    buffer_load_dwordx4 a[144:147], v4, s[8:11], s63 offen offset:0 sc1
    v_mfma_f32_16x16x32_bf16 v[56:59], a[16:19], v[120:123], v[56:59]
    ds_read_b64 a[8:9], v6 offset:768
    ds_read_b64 a[10:11], v6 offset:776
    v_mfma_f32_16x16x32_bf16 v[60:63], a[16:19], v[124:127], v[60:63]
    ds_read_b128 v[72:75], v7 offset:1248
    v_mfma_f32_16x16x32_bf16 v[36:39], a[20:23], v[96:99], v[36:39]
    ds_read_b64 a[12:13], v6 offset:256
    ds_read_b64 a[14:15], v6 offset:264
    v_mfma_f32_16x16x32_bf16 v[40:43], a[20:23], v[100:103], v[40:43]
    ds_read_b128 v[76:79], v7 offset:1760
    ds_read_b128 v[80:83], v7 offset:2272
    v_mfma_f32_16x16x32_bf16 v[44:47], a[20:23], v[104:107], v[44:47]
    buffer_load_dwordx4 a[148:151], v4, s[8:11], s63 offen offset:1024 sc1
    v_mfma_f32_16x16x32_bf16 v[48:51], a[20:23], v[108:111], v[48:51]
    ds_read_b128 v[84:87], v7 offset:2784
    ds_read_b128 v[88:91], v7 offset:3296
    v_mfma_f32_16x16x32_bf16 v[52:55], a[20:23], v[112:115], v[52:55]
    ds_read_b128 v[92:95], v7 offset:3808
    ds_read_b64 a[36:37], v5 offset:0
    v_mfma_f32_16x16x32_bf16 v[56:59], a[20:23], v[116:119], v[56:59]
    ds_read_b64 a[38:39], v5 offset:32
    ds_read_b64 a[40:41], v5 offset:64
    v_mfma_f32_16x16x32_bf16 v[60:63], a[20:23], v[120:123], v[60:63]
    ds_read_b64 a[42:43], v5 offset:96
    v_mfma_f32_16x16x32_bf16 v[40:43], a[24:27], v[96:99], v[40:43]
    buffer_load_dwordx4 a[152:155], v4, s[8:11], s63 offen offset:2048 sc1
    v_mfma_f32_16x16x32_bf16 v[44:47], a[24:27], v[100:103], v[44:47]
    v_accvgpr_write_b32 a44, 0
    v_accvgpr_write_b32 a45, 0
    v_mfma_f32_16x16x32_bf16 v[48:51], a[24:27], v[104:107], v[48:51]
    ds_read_b64 a[46:47], v5 offset:768
    ds_read_b64 a[48:49], v5 offset:800
    v_mfma_f32_16x16x32_bf16 v[52:55], a[24:27], v[108:111], v[52:55]
    ds_read_b64 a[50:51], v5 offset:832
    ds_read_b64 a[52:53], v5 offset:864
    v_mfma_f32_16x16x32_bf16 v[56:59], a[24:27], v[112:115], v[56:59]
    v_accvgpr_write_b32 a54, 0
    v_accvgpr_write_b32 a55, 0
    v_mfma_f32_16x16x32_bf16 v[60:63], a[24:27], v[116:119], v[60:63]
    buffer_load_dwordx4 a[156:159], v4, s[8:11], s63 offen offset:3072 sc1
    v_mfma_f32_16x16x32_bf16 v[44:47], a[28:31], v[96:99], v[44:47]
    v_cvt_pk_bf16_f32 v228, v196, v197
    v_cvt_pk_bf16_f32 v229, v198, v199
    v_mfma_f32_16x16x32_bf16 v[48:51], a[28:31], v[100:103], v[48:51]
    v_cvt_pk_bf16_f32 v230, v200, v201
    v_cvt_pk_bf16_f32 v231, v202, v203
    v_mfma_f32_16x16x32_bf16 v[52:55], a[28:31], v[104:107], v[52:55]
    v_cvt_pk_bf16_f32 v232, v204, v205
    v_cvt_pk_bf16_f32 v233, v206, v207
    v_mfma_f32_16x16x32_bf16 v[56:59], a[28:31], v[108:111], v[56:59]
    v_cvt_pk_bf16_f32 v234, v208, v209
    v_cvt_pk_bf16_f32 v235, v210, v211
    v_mfma_f32_16x16x32_bf16 v[60:63], a[28:31], v[112:115], v[60:63]
    v_cvt_pk_bf16_f32 v236, v212, v213
    v_cvt_pk_bf16_f32 v237, v214, v215
    v_cvt_pk_bf16_f32 v238, v216, v217
    v_cvt_pk_bf16_f32 v239, v218, v219
    v_cvt_pk_bf16_f32 v240, v220, v221
    v_cvt_pk_bf16_f32 v241, v222, v223
    v_cvt_pk_bf16_f32 v242, v224, v225
    v_cvt_pk_bf16_f32 v243, v226, v227
    s_waitcnt lgkmcnt(0)
    v_mfma_f32_16x16x32_bf16 v[32:35], a[0:3], v[64:67], v[32:35]
    s_addk_i32 s63, 4096
    buffer_load_dwordx4 a[160:163], v4, s[8:11], s63 offen offset:0 sc1
    v_mfma_f32_16x16x32_bf16 v[36:39], a[0:3], v[68:71], v[36:39]
    ds_read_b64 a[16:17], v6 offset:1728
    ds_read_b64 a[18:19], v6 offset:1736
    v_mfma_f32_16x16x32_bf16 v[40:43], a[0:3], v[72:75], v[40:43]
    ds_read_b128 v[96:99], v7 offset:160
    v_mfma_f32_16x16x32_bf16 v[44:47], a[0:3], v[76:79], v[44:47]
    ds_read_b64 a[20:21], v6 offset:1216
    ds_read_b64 a[22:23], v6 offset:1224
    v_mfma_f32_16x16x32_bf16 v[48:51], a[0:3], v[80:83], v[48:51]
    ds_read_b128 v[100:103], v7 offset:672
    v_mfma_f32_16x16x32_bf16 v[52:55], a[0:3], v[84:87], v[52:55]
    ds_read_b64 a[24:25], v6 offset:704
    ds_read_b64 a[26:27], v6 offset:712
    v_mfma_f32_16x16x32_bf16 v[56:59], a[0:3], v[88:91], v[56:59]
    buffer_load_dwordx4 a[164:167], v4, s[8:11], s63 offen offset:1024 sc1
    v_mfma_f32_16x16x32_bf16 v[60:63], a[0:3], v[92:95], v[60:63]
    ds_read_b128 v[104:107], v7 offset:1184
    v_mfma_f32_16x16x32_bf16 v[36:39], a[4:7], v[64:67], v[36:39]
    ds_read_b64 a[28:29], v6 offset:192
    ds_read_b64 a[30:31], v6 offset:200
    v_mfma_f32_16x16x32_bf16 v[40:43], a[4:7], v[68:71], v[40:43]
    ds_read_b128 v[108:111], v7 offset:1696
    ds_read_b128 v[112:115], v7 offset:2208
    v_mfma_f32_16x16x32_bf16 v[44:47], a[4:7], v[72:75], v[44:47]
    ds_read_b128 v[116:119], v7 offset:2720
    ds_read_b128 v[120:123], v7 offset:3232
    v_mfma_f32_16x16x32_bf16 v[48:51], a[4:7], v[76:79], v[48:51]
    ds_read_b128 v[124:127], v7 offset:3744
    v_fma_f32 v128, v160, s66, v128
    v_mfma_f32_16x16x32_bf16 v[52:55], a[4:7], v[80:83], v[52:55]
    buffer_load_dwordx4 a[168:171], v4, s[8:11], s63 offen offset:2048 sc1
    v_mfma_f32_16x16x32_bf16 v[56:59], a[4:7], v[84:87], v[56:59]
    v_fma_f32 v129, v161, s67, v129
    v_fma_f32 v130, v162, s68, v130
    v_mfma_f32_16x16x32_bf16 v[60:63], a[4:7], v[88:91], v[60:63]
    v_fma_f32 v131, v163, s69, v131
    v_fma_f32 v132, v164, s66, v132
    v_mfma_f32_16x16x32_bf16 v[40:43], a[8:11], v[64:67], v[40:43]
    v_fma_f32 v133, v165, s67, v133
    v_fma_f32 v134, v166, s68, v134
    v_mfma_f32_16x16x32_bf16 v[44:47], a[8:11], v[68:71], v[44:47]
    v_fma_f32 v135, v167, s69, v135
    v_mfma_f32_16x16x32_bf16 v[48:51], a[8:11], v[72:75], v[48:51]
    v_mfma_f32_16x16x32_bf16 v[52:55], a[8:11], v[76:79], v[52:55]
    v_mfma_f32_16x16x32_bf16 v[56:59], a[8:11], v[80:83], v[56:59]
    buffer_load_dwordx4 a[172:175], v4, s[8:11], s63 offen offset:3072 sc1
    v_mfma_f32_16x16x32_bf16 v[60:63], a[8:11], v[84:87], v[60:63]
    v_mfma_f32_16x16x32_bf16 v[44:47], a[12:15], v[64:67], v[44:47]
    v_mfma_f32_16x16x32_bf16 v[48:51], a[12:15], v[68:71], v[48:51]
    v_mfma_f32_16x16x32_bf16 v[52:55], a[12:15], v[72:75], v[52:55]
    v_mfma_f32_16x16x32_bf16 v[56:59], a[12:15], v[76:79], v[56:59]
    v_mfma_f32_16x16x32_bf16 v[60:63], a[12:15], v[80:83], v[60:63]
    s_addk_i32 s63, 4096
    buffer_load_dwordx4 a[176:179], v4, s[8:11], s63 offen offset:0 sc1
    v_mfma_f32_16x16x32_bf16 v[48:51], v[228:231], a[42:45], v[48:51]
    v_mfma_f32_16x16x32_bf16 v[52:55], v[228:231], a[40:43], v[52:55]
    v_mfma_f32_16x16x32_bf16 v[56:59], v[228:231], a[38:41], v[56:59]
    v_mfma_f32_16x16x32_bf16 v[60:63], v[228:231], a[36:39], v[60:63]
    v_mfma_f32_16x16x32_bf16 v[56:59], v[232:235], a[42:45], v[56:59]
    v_mfma_f32_16x16x32_bf16 v[60:63], v[232:235], a[40:43], v[60:63]
    s_waitcnt lgkmcnt(0)
    v_mfma_f32_16x16x32_bf16 v[32:35], a[16:19], v[96:99], v[32:35]
    buffer_load_dwordx4 a[180:183], v4, s[8:11], s63 offen offset:1024 sc1
    v_mfma_f32_16x16x32_bf16 v[36:39], a[16:19], v[100:103], v[36:39]
    ds_read_b64 a[0:1], v6 offset:1664
    ds_read_b64 a[2:3], v6 offset:1672
    v_mfma_f32_16x16x32_bf16 v[40:43], a[16:19], v[104:107], v[40:43]
    ds_read_b128 v[64:67], v7 offset:96
    v_mfma_f32_16x16x32_bf16 v[44:47], a[16:19], v[108:111], v[44:47]
    ds_read_b64 a[4:5], v6 offset:1152
    ds_read_b64 a[6:7], v6 offset:1160
    v_mfma_f32_16x16x32_bf16 v[48:51], a[16:19], v[112:115], v[48:51]
    ds_read_b128 v[68:71], v7 offset:608
    v_mfma_f32_16x16x32_bf16 v[52:55], a[16:19], v[116:119], v[52:55]
    ds_read_b64 a[8:9], v6 offset:640
    ds_read_b64 a[10:11], v6 offset:648
    v_mfma_f32_16x16x32_bf16 v[56:59], a[16:19], v[120:123], v[56:59]
    buffer_load_dwordx4 a[184:187], v4, s[8:11], s63 offen offset:2048 sc1
    v_mfma_f32_16x16x32_bf16 v[60:63], a[16:19], v[124:127], v[60:63]
    ds_read_b128 v[72:75], v7 offset:1120
    v_mfma_f32_16x16x32_bf16 v[36:39], a[20:23], v[96:99], v[36:39]
    ds_read_b64 a[12:13], v6 offset:128
    ds_read_b64 a[14:15], v6 offset:136
    v_mfma_f32_16x16x32_bf16 v[40:43], a[20:23], v[100:103], v[40:43]
    ds_read_b128 v[76:79], v7 offset:1632
    ds_read_b128 v[80:83], v7 offset:2144
    v_mfma_f32_16x16x32_bf16 v[44:47], a[20:23], v[104:107], v[44:47]
    ds_read_b128 v[84:87], v7 offset:2656
    ds_read_b128 v[88:91], v7 offset:3168
    v_mfma_f32_16x16x32_bf16 v[48:51], a[20:23], v[108:111], v[48:51]
    ds_read_b128 v[92:95], v7 offset:3680
    v_lshlrev_b32_e64 v17, 4, v14
    v_mfma_f32_16x16x32_bf16 v[52:55], a[20:23], v[112:115], v[52:55]
    buffer_load_dwordx4 a[188:191], v4, s[8:11], s63 offen offset:3072 sc1
    v_mfma_f32_16x16x32_bf16 v[56:59], a[20:23], v[116:119], v[56:59]
    v_lshl_add_u32 v17, v15, 2, v17
    v_add_u32_e64 v8, s76, v17
    v_mfma_f32_16x16x32_bf16 v[60:63], a[20:23], v[120:123], v[60:63]
    v_lshrrev_b32_e64 v17, 2, v14
    v_mul_u32_u24 v17, 33856, v17
    v_mfma_f32_16x16x32_bf16 v[40:43], a[24:27], v[96:99], v[40:43]
    v_lshl_add_u32 v17, v15, 5, v17
    v_and_b32 v16, 3, v14
    v_mfma_f32_16x16x32_bf16 v[44:47], a[24:27], v[100:103], v[44:47]
    v_lshl_add_u32 v17, v16, 3, v17
    s_lshl_b32 s72, s48, 7
    v_mfma_f32_16x16x32_bf16 v[48:51], a[24:27], v[104:107], v[48:51]
    v_add_u32 v9, s72, v17
    s_lshr_b32 s76, s50, 3
    v_mfma_f32_16x16x32_bf16 v[52:55], a[24:27], v[108:111], v[52:55]
    s_mul_i32 s52, s76, 52
    s_lshr_b32 s52, s52, 8
    v_mfma_f32_16x16x32_bf16 v[56:59], a[24:27], v[112:115], v[56:59]
    s_addk_i32 s63, 4096
    buffer_load_dwordx4 a[192:195], v4, s[8:11], s63 offen offset:0 sc1
    v_mfma_f32_16x16x32_bf16 v[60:63], a[24:27], v[116:119], v[60:63]
    s_mul_i32 s58, s52, 5
    s_sub_u32 s77, s76, s58
    v_mfma_f32_16x16x32_bf16 v[44:47], a[28:31], v[96:99], v[44:47]
    s_and_b32 s58, s49, 1
    s_mul_i32 s58, s58, 5
    v_mfma_f32_16x16x32_bf16 v[48:51], a[28:31], v[100:103], v[48:51]
    s_add_u32 s58, s58, s77
    v_fma_f32 v136, v168, s66, v136
    v_mfma_f32_16x16x32_bf16 v[52:55], a[28:31], v[104:107], v[52:55]
    v_fma_f32 v137, v169, s67, v137
    v_fma_f32 v138, v170, s68, v138
    v_mfma_f32_16x16x32_bf16 v[56:59], a[28:31], v[108:111], v[56:59]
    v_fma_f32 v139, v171, s69, v139
    v_fma_f32 v140, v172, s66, v140
    v_mfma_f32_16x16x32_bf16 v[60:63], a[28:31], v[112:115], v[60:63]
    buffer_load_dwordx4 a[196:199], v4, s[8:11], s63 offen offset:1024 sc1
    v_mfma_f32_16x16x32_bf16 v[48:51], v[236:239], a[52:55], v[48:51]
    v_fma_f32 v141, v173, s67, v141
    v_fma_f32 v142, v174, s68, v142
    v_mfma_f32_16x16x32_bf16 v[52:55], v[236:239], a[50:53], v[52:55]
    v_fma_f32 v143, v175, s69, v143
    v_mfma_f32_16x16x32_bf16 v[56:59], v[236:239], a[48:51], v[56:59]
    v_mfma_f32_16x16x32_bf16 v[60:63], v[236:239], a[46:49], v[60:63]
    v_mfma_f32_16x16x32_bf16 v[56:59], v[240:243], a[52:55], v[56:59]
    v_mfma_f32_16x16x32_bf16 v[60:63], v[240:243], a[50:53], v[60:63]
    s_waitcnt lgkmcnt(0)
    v_mfma_f32_16x16x32_bf16 v[32:35], a[0:3], v[64:67], v[32:35]
    buffer_load_dwordx4 a[200:203], v4, s[8:11], s63 offen offset:2048 sc1
    v_mfma_f32_16x16x32_bf16 v[36:39], a[0:3], v[68:71], v[36:39]
    s_mul_i32 s55, s48, 3072
    s_add_u32 s55, s55, 22167552
    v_min_u32 v26, 23, v1
    v_lshlrev_b32_e64 v26, 7, v26
    buffer_load_dwordx2 v[28:29], v26, s[8:11], s55 offen sc1
    v_mfma_f32_16x16x32_bf16 v[40:43], a[0:3], v[72:75], v[40:43]
    ds_read_b64 a[16:17], v6 offset:1600
    ds_read_b64 a[18:19], v6 offset:1608
    v_mfma_f32_16x16x32_bf16 v[44:47], a[0:3], v[76:79], v[44:47]
    ds_read_b128 v[96:99], v7 offset:32
    v_mfma_f32_16x16x32_bf16 v[48:51], a[0:3], v[80:83], v[48:51]
    ds_read_b64 a[20:21], v6 offset:1088
    ds_read_b64 a[22:23], v6 offset:1096
    v_mfma_f32_16x16x32_bf16 v[52:55], a[0:3], v[84:87], v[52:55]
    buffer_load_dwordx4 a[204:207], v4, s[8:11], s63 offen offset:3072 sc1
    v_mfma_f32_16x16x32_bf16 v[56:59], a[0:3], v[88:91], v[56:59]
    ds_read_b128 v[100:103], v7 offset:544
    v_mfma_f32_16x16x32_bf16 v[60:63], a[0:3], v[92:95], v[60:63]
    ds_read_b64 a[24:25], v6 offset:576
    ds_read_b64 a[26:27], v6 offset:584
    v_mfma_f32_16x16x32_bf16 v[36:39], a[4:7], v[64:67], v[36:39]
    ds_read_b128 v[104:107], v7 offset:1056
    v_mfma_f32_16x16x32_bf16 v[40:43], a[4:7], v[68:71], v[40:43]
    ds_read_b64 a[28:29], v6 offset:64
    ds_read_b64 a[30:31], v6 offset:72
    v_mfma_f32_16x16x32_bf16 v[44:47], a[4:7], v[72:75], v[44:47]
    s_addk_i32 s63, 4096
    buffer_load_dwordx4 a[208:211], v4, s[8:11], s63 offen offset:0 sc1
    v_mfma_f32_16x16x32_bf16 v[48:51], a[4:7], v[76:79], v[48:51]
    ds_read_b128 v[108:111], v7 offset:1568
    ds_read_b128 v[112:115], v7 offset:2080
    v_mfma_f32_16x16x32_bf16 v[52:55], a[4:7], v[80:83], v[52:55]
    ds_read_b128 v[116:119], v7 offset:2592
    ds_read_b128 v[120:123], v7 offset:3104
    v_mfma_f32_16x16x32_bf16 v[56:59], a[4:7], v[84:87], v[56:59]
    ds_read_b128 v[124:127], v7 offset:3616
    s_add_u32 s51, s58, 6
    v_mfma_f32_16x16x32_bf16 v[60:63], a[4:7], v[88:91], v[60:63]
    s_mov_b32 s59, 0
    s_lshr_b32 s54, s76, 2
    v_mfma_f32_16x16x32_bf16 v[40:43], a[8:11], v[64:67], v[40:43]
    buffer_load_dwordx4 a[212:215], v4, s[8:11], s63 offen offset:1024 sc1
    v_mfma_f32_16x16x32_bf16 v[44:47], a[8:11], v[68:71], v[44:47]
    s_add_u32 s54, s54, 3
    s_lshr_b32 s58, s49, 1
    v_mfma_f32_16x16x32_bf16 v[48:51], a[8:11], v[72:75], v[48:51]
    s_lshl_b32 s58, s58, 2
    s_add_u32 s52, s52, s58
    v_mfma_f32_16x16x32_bf16 v[52:55], a[8:11], v[76:79], v[52:55]
    s_and_b32 s76, s76, 3
    s_lshl_b32 s53, s49, 2
    v_mfma_f32_16x16x32_bf16 v[56:59], a[8:11], v[80:83], v[56:59]
    s_add_u32 s53, s53, s76
    s_lshl_b32 s62, s48, 12
    v_mfma_f32_16x16x32_bf16 v[60:63], a[8:11], v[84:87], v[60:63]
    buffer_load_dwordx4 a[216:219], v4, s[8:11], s63 offen offset:2048 sc1
    v_mfma_f32_16x16x32_bf16 v[44:47], a[12:15], v[64:67], v[44:47]
    s_mul_i32 s61, s52, 286720
    s_add_u32 s61, s61, s62
    v_mfma_f32_16x16x32_bf16 v[48:51], a[12:15], v[68:71], v[48:51]
    s_add_u32 s61, s61, 6291456
    v_fma_f32 v144, v176, s66, v144
    v_mfma_f32_16x16x32_bf16 v[52:55], a[12:15], v[72:75], v[52:55]
    v_fma_f32 v145, v177, s67, v145
    v_fma_f32 v146, v178, s68, v146
    v_mfma_f32_16x16x32_bf16 v[56:59], a[12:15], v[76:79], v[56:59]
    v_fma_f32 v147, v179, s69, v147
    v_fma_f32 v148, v180, s66, v148
    v_mfma_f32_16x16x32_bf16 v[60:63], a[12:15], v[80:83], v[60:63]
    v_fma_f32 v149, v181, s67, v149
    v_fma_f32 v150, v182, s68, v150
    v_fma_f32 v151, v183, s69, v151
    s_waitcnt lgkmcnt(0)
    v_mfma_f32_16x16x32_bf16 v[32:35], a[16:19], v[96:99], v[32:35]
    buffer_load_dwordx4 a[220:223], v4, s[8:11], s63 offen offset:3072 sc1
    v_mfma_f32_16x16x32_bf16 v[36:39], a[16:19], v[100:103], v[36:39]
    v_fma_f32 v152, v184, s66, v152
    v_fma_f32 v153, v185, s67, v153
    v_mfma_f32_16x16x32_bf16 v[36:39], a[20:23], v[96:99], v[36:39]
    v_fma_f32 v154, v186, s68, v154
    v_fma_f32 v155, v187, s69, v155
    v_mfma_f32_16x16x32_bf16 v[40:43], a[16:19], v[104:107], v[40:43]
    v_fma_f32 v156, v188, s66, v156
    v_fma_f32 v157, v189, s67, v157
    v_mfma_f32_16x16x32_bf16 v[40:43], a[20:23], v[100:103], v[40:43]
    v_fma_f32 v158, v190, s68, v158
    v_fma_f32 v159, v191, s69, v159
    v_mfma_f32_16x16x32_bf16 v[40:43], a[24:27], v[96:99], v[40:43]
    s_add_u32 s63, s63, 4096
    buffer_load_dwordx4 a[224:227], v4, s[8:11], s63 offen offset:0 sc1
    v_mfma_f32_16x16x32_bf16 v[44:47], a[16:19], v[108:111], v[44:47]
    v_cvt_pk_bf16_f32 v64, v32, v34
    v_cvt_pk_bf16_f32 v65, v33, v35
    v_mfma_f32_16x16x32_bf16 v[44:47], a[20:23], v[104:107], v[44:47]
    ds_write2st64_b32 v8, v64, v65 offset0:0 offset1:8
    v_mfma_f32_16x16x32_bf16 v[44:47], a[24:27], v[100:103], v[44:47]
    v_cvt_pk_bf16_f32 v66, v36, v38
    v_cvt_pk_bf16_f32 v67, v37, v39
    v_mfma_f32_16x16x32_bf16 v[44:47], a[28:31], v[96:99], v[44:47]
    ds_write2st64_b32 v8, v66, v67 offset0:1 offset1:9
    v_mfma_f32_16x16x32_bf16 v[48:51], a[16:19], v[112:115], v[48:51]
    buffer_load_dwordx4 a[228:231], v4, s[8:11], s63 offen offset:1024 sc1
    v_mfma_f32_16x16x32_bf16 v[48:51], a[20:23], v[108:111], v[48:51]
    v_cvt_pk_bf16_f32 v68, v40, v42
    v_cvt_pk_bf16_f32 v69, v41, v43
    v_mfma_f32_16x16x32_bf16 v[48:51], a[24:27], v[104:107], v[48:51]
    ds_write2st64_b32 v8, v68, v69 offset0:2 offset1:10
    v_mfma_f32_16x16x32_bf16 v[48:51], a[28:31], v[100:103], v[48:51]
    v_cvt_pk_bf16_f32 v70, v44, v46
    v_cvt_pk_bf16_f32 v71, v45, v47
    v_mfma_f32_16x16x32_bf16 v[52:55], a[16:19], v[116:119], v[52:55]
    ds_write2st64_b32 v8, v70, v71 offset0:3 offset1:11
    v_mfma_f32_16x16x32_bf16 v[52:55], a[20:23], v[112:115], v[52:55]
    buffer_load_dwordx4 a[232:235], v4, s[8:11], s63 offen offset:2048 sc1
    v_mfma_f32_16x16x32_bf16 v[52:55], a[24:27], v[108:111], v[52:55]
    v_mfma_f32_16x16x32_bf16 v[52:55], a[28:31], v[104:107], v[52:55]
    v_cvt_pk_bf16_f32 v72, v48, v50
    v_cvt_pk_bf16_f32 v73, v49, v51
    v_mfma_f32_16x16x32_bf16 v[56:59], a[16:19], v[120:123], v[56:59]
    ds_write2st64_b32 v8, v72, v73 offset0:4 offset1:12
    v_mfma_f32_16x16x32_bf16 v[56:59], a[20:23], v[116:119], v[56:59]
    v_mfma_f32_16x16x32_bf16 v[56:59], a[24:27], v[112:115], v[56:59]
    buffer_load_dwordx4 a[236:239], v4, s[8:11], s63 offen offset:3072 sc1
    v_mfma_f32_16x16x32_bf16 v[56:59], a[28:31], v[108:111], v[56:59]
    v_cvt_pk_bf16_f32 v74, v52, v54
    v_cvt_pk_bf16_f32 v75, v53, v55
    v_mfma_f32_16x16x32_bf16 v[60:63], a[16:19], v[124:127], v[60:63]
    ds_write2st64_b32 v8, v74, v75 offset0:5 offset1:13
    v_mfma_f32_16x16x32_bf16 v[60:63], a[20:23], v[120:123], v[60:63]
    v_mfma_f32_16x16x32_bf16 v[60:63], a[24:27], v[116:119], v[60:63]
    v_mfma_f32_16x16x32_bf16 v[60:63], a[28:31], v[112:115], v[60:63]
    s_nop 0
    v_cvt_pk_bf16_f32 v76, v56, v58
    v_cvt_pk_bf16_f32 v77, v57, v59
    s_waitcnt vmcnt(9)
    v_xor_b32 v28, s0, v28
    v_xor_b32 v29, s1, v29
    v_or_b32 v26, v28, v29
    v_cmp_ne_u32 vcc, 0, v26
    s_cbranch_vccz L_ok17
    s_mov_b32 s3, 0
L_poll16:
    s_mul_i32 s55, s48, 3072
    s_add_u32 s55, s55, 22167552
    v_min_u32 v26, 23, v1
    v_lshlrev_b32 v26, 7, v26
    buffer_load_dwordx2 v[28:29], v26, s[8:11], s55 offen sc1
    s_waitcnt vmcnt(0)
    v_xor_b32 v28, s0, v28
    v_xor_b32 v29, s1, v29
    v_or_b32 v26, v28, v29
    v_cmp_ne_u32 vcc, 0, v26
    s_add_u32 s3, s3, 1
    s_cmp_gt_u32 s3, 1000000
    s_cbranch_scc1 L_ok17
    s_cbranch_vccnz L_poll16
L_ok17:
    ds_write2st64_b32 v8, v76, v77 offset0:6 offset1:14
    v_cvt_pk_bf16_f32 v78, v60, v62
    v_cvt_pk_bf16_f32 v79, v61, v63
    ds_write2st64_b32 v8, v78, v79 offset0:7 offset1:15
    s_mov_b32 s56, 0x3f80
    s_mov_b32 s57, 0x3f800000
    s_waitcnt lgkmcnt(0)
    s_nop 0
    s_barrier
    ds_read_b64_tr_b16 v[80:81], v9 offset:0
    ds_read_b64_tr_b16 v[82:83], v9 offset:2048
    ds_read_b64_tr_b16 v[84:85], v9 offset:512
    ds_read_b64_tr_b16 v[86:87], v9 offset:2560
    ds_read_b64_tr_b16 v[88:89], v9 offset:1024
    ds_read_b64_tr_b16 v[90:91], v9 offset:3072
    ds_read_b64_tr_b16 v[92:93], v9 offset:1536
    ds_read_b64_tr_b16 v[94:95], v9 offset:3584
    s_nop 0
    s_waitcnt lgkmcnt(6)
    v_dot2_f32_bf16 v128, v80, s56, v128
    v_dot2_f32_bf16 v129, v80, s57, v129
    v_dot2_f32_bf16 v130, v81, s56, v130
    v_dot2_f32_bf16 v131, v81, s57, v131
    v_dot2_f32_bf16 v132, v82, s56, v132
    v_dot2_f32_bf16 v133, v82, s57, v133
    v_dot2_f32_bf16 v134, v83, s56, v134
    v_dot2_f32_bf16 v135, v83, s57, v135
    s_nop 0
    s_waitcnt lgkmcnt(4)
    v_dot2_f32_bf16 v136, v84, s56, v136
    v_dot2_f32_bf16 v137, v84, s57, v137
    v_dot2_f32_bf16 v138, v85, s56, v138
    v_dot2_f32_bf16 v139, v85, s57, v139
    v_dot2_f32_bf16 v140, v86, s56, v140
    v_dot2_f32_bf16 v141, v86, s57, v141
    v_dot2_f32_bf16 v142, v87, s56, v142
    v_dot2_f32_bf16 v143, v87, s57, v143
    v_cvt_pk_bf16_f32 v96, v128, v129
    v_cvt_pk_bf16_f32 v97, v130, v131
    v_cvt_pk_bf16_f32 v98, v132, v133
    v_cvt_pk_bf16_f32 v99, v134, v135
    buffer_store_dwordx4 v[96:99], v192, s[8:11], s74 offen sc1
    s_add_u32 s74, s74, 655360
    s_nop 0
    s_waitcnt lgkmcnt(2)
    v_dot2_f32_bf16 v144, v88, s56, v144
    v_dot2_f32_bf16 v145, v88, s57, v145
    v_dot2_f32_bf16 v146, v89, s56, v146
    v_dot2_f32_bf16 v147, v89, s57, v147
    v_dot2_f32_bf16 v148, v90, s56, v148
    v_dot2_f32_bf16 v149, v90, s57, v149
    v_dot2_f32_bf16 v150, v91, s56, v150
    v_dot2_f32_bf16 v151, v91, s57, v151
    v_cvt_pk_bf16_f32 v100, v136, v137
    v_cvt_pk_bf16_f32 v101, v138, v139
    v_cvt_pk_bf16_f32 v102, v140, v141
    v_cvt_pk_bf16_f32 v103, v142, v143
    buffer_store_dwordx4 v[100:103], v192, s[8:11], s74 offen sc1
    s_add_u32 s74, s74, 655360
    s_nop 0
    s_waitcnt lgkmcnt(0)
    v_dot2_f32_bf16 v152, v92, s56, v152
    v_dot2_f32_bf16 v153, v92, s57, v153
    v_dot2_f32_bf16 v154, v93, s56, v154
    v_dot2_f32_bf16 v155, v93, s57, v155
    v_dot2_f32_bf16 v156, v94, s56, v156
    v_dot2_f32_bf16 v157, v94, s57, v157
    v_dot2_f32_bf16 v158, v95, s56, v158
    v_dot2_f32_bf16 v159, v95, s57, v159
    v_cvt_pk_bf16_f32 v104, v144, v145
    v_cvt_pk_bf16_f32 v105, v146, v147
    v_cvt_pk_bf16_f32 v106, v148, v149
    v_cvt_pk_bf16_f32 v107, v150, v151
    buffer_store_dwordx4 v[104:107], v192, s[8:11], s74 offen sc1
    s_add_u32 s74, s74, 655360
    v_cvt_pk_bf16_f32 v108, v152, v153
    v_cvt_pk_bf16_f32 v109, v154, v155
    v_cvt_pk_bf16_f32 v110, v156, v157
    v_cvt_pk_bf16_f32 v111, v158, v159
    buffer_store_dwordx4 v[108:111], v192, s[8:11], s74 offen sc1
    s_add_u32 s74, s74, 655360
    s_add_u32 m0, s62, 16384
    s_add_u32 s58, s61, 16384
    buffer_load_dwordx4 v4, s[8:11], s58 offen offset:0 sc1 lds
    buffer_load_dwordx4 v4, s[8:11], s58 offen offset:1024 sc1 lds
    buffer_load_dwordx4 v4, s[8:11], s58 offen offset:2048 sc1 lds
    buffer_load_dwordx4 v4, s[8:11], s58 offen offset:3072 sc1 lds
    s_add_u32 m0, s62, 49152
    s_add_u32 s58, s61, 49152
    buffer_load_dwordx4 v4, s[8:11], s58 offen offset:0 sc1 lds
    buffer_load_dwordx4 v4, s[8:11], s58 offen offset:1024 sc1 lds
    buffer_load_dwordx4 v4, s[8:11], s58 offen offset:2048 sc1 lds
    buffer_load_dwordx4 v4, s[8:11], s58 offen offset:3072 sc1 lds
    s_add_u32 m0, s62, 81920
    s_add_u32 s58, s61, 81920
    buffer_load_dwordx4 v4, s[8:11], s58 offen offset:0 sc1 lds
    buffer_load_dwordx4 v4, s[8:11], s58 offen offset:1024 sc1 lds
    buffer_load_dwordx4 v4, s[8:11], s58 offen offset:2048 sc1 lds
    buffer_load_dwordx4 v4, s[8:11], s58 offen offset:3072 sc1 lds
    s_waitcnt vmcnt(12)
    s_barrier
    s_lshl_b32 s3, s50, 7
    s_add_u32 s3, s3, 22183936
    s_lshl_b32 s55, s48, 30
    v_lshl_add_u32 v26, v1, 3, s55
    v_mov_b32_e64 v28, s0
    v_mov_b32 v29, s1
    s_mov_b64 exec, 0xffff
    buffer_store_dwordx2 v[28:29], v26, s[8:11], s3 offen sc1
    s_mov_b64 exec, -1
    s_add_u32 m0, s62, 114688
    s_add_u32 s58, s61, 114688
    buffer_load_dwordx4 v4, s[8:11], s58 offen offset:0 sc1 lds
    buffer_load_dwordx4 v4, s[8:11], s58 offen offset:1024 sc1 lds
    buffer_load_dwordx4 v4, s[8:11], s58 offen offset:2048 sc1 lds
    buffer_load_dwordx4 v4, s[8:11], s58 offen offset:3072 sc1 lds
    s_add_u32 m0, s62, 131072
    s_add_u32 s58, s61, 131072
    buffer_load_dwordx4 v4, s[8:11], s58 offen offset:0 sc1 lds
    buffer_load_dwordx4 v4, s[8:11], s58 offen offset:1024 sc1 lds
    buffer_load_dwordx4 v4, s[8:11], s58 offen offset:2048 sc1 lds
    buffer_load_dwordx4 v4, s[8:11], s58 offen offset:3072 sc1 lds
    s_add_u32 m0, s62, 0
    s_add_u32 s58, s61, 0
    buffer_load_dwordx4 v4, s[8:11], s58 offen offset:0 sc1 lds
    buffer_load_dwordx4 v4, s[8:11], s58 offen offset:1024 sc1 lds
    buffer_load_dwordx4 v4, s[8:11], s58 offen offset:2048 sc1 lds
    buffer_load_dwordx4 v4, s[8:11], s58 offen offset:3072 sc1 lds
    s_add_u32 m0, s62, 32768
    s_add_u32 s58, s61, 32768
    buffer_load_dwordx4 v4, s[8:11], s58 offen offset:0 sc1 lds
    buffer_load_dwordx4 v4, s[8:11], s58 offen offset:1024 sc1 lds
    buffer_load_dwordx4 v4, s[8:11], s58 offen offset:2048 sc1 lds
    buffer_load_dwordx4 v4, s[8:11], s58 offen offset:3072 sc1 lds
    s_add_u32 m0, s62, 65536
    s_add_u32 s58, s61, 65536
    buffer_load_dwordx4 v4, s[8:11], s58 offen offset:0 sc1 lds
    buffer_load_dwordx4 v4, s[8:11], s58 offen offset:1024 sc1 lds
    buffer_load_dwordx4 v4, s[8:11], s58 offen offset:2048 sc1 lds
    buffer_load_dwordx4 v4, s[8:11], s58 offen offset:3072 sc1 lds
    s_add_u32 m0, s62, 98304
    s_add_u32 s58, s61, 98304
    buffer_load_dwordx4 v4, s[8:11], s58 offen offset:0 sc1 lds
    buffer_load_dwordx4 v4, s[8:11], s58 offen offset:1024 sc1 lds
    buffer_load_dwordx4 v4, s[8:11], s58 offen offset:2048 sc1 lds
    buffer_load_dwordx4 v4, s[8:11], s58 offen offset:3072 sc1 lds
    s_add_u32 s61, s61, 131072
    v_cmp_lt_u32 vcc, 111, v0
    v_mov_b32_e64 v2, 0
    v_mov_b32 v3, 6720
    v_cndmask_b32_e64 v2, v2, v3, vcc
    v_lshl_add_u32 v2, v0, 2, v2
    s_mul_i32 s56, s52, 448
    s_add_u32 s56, s56, 22020096
    buffer_load_dword v16, v2, s[8:11], s56 offen sc1
    s_add_u32 s56, s56, 14336
    buffer_load_dword v17, v2, s[8:11], s56 offen sc1
    s_add_u32 s56, s56, 14336
    buffer_load_dword v18, v2, s[8:11], s56 offen sc1
    s_add_u32 s56, s56, 14336
    buffer_load_dword v19, v2, s[8:11], s56 offen sc1
    s_add_u32 s56, s56, 14336
    buffer_load_dword v20, v2, s[8:11], s56 offen sc1
    s_add_u32 s56, s56, 14336
    buffer_load_dword v21, v2, s[8:11], s56 offen sc1
    s_add_u32 s56, s56, 14336
    buffer_load_dword v22, v2, s[8:11], s56 offen sc1
    s_addk_i32 s56, 14336
    s_add_u32 s77, s77, 3
L_g1:
    v_add_u32 v5, 0x10000, v4
    v_add_u32 v6, 0x20000, v4
    v_and_b32 v2, 15, v1
    v_lshrrev_b32 v3, 4, v1
    v_lshlrev_b32_e64 v7, 4, v2
    v_lshl_add_u32 v7, v3, 9, v7
    v_lshlrev_b32_e64 v8, 4, v3
    v_add_u32 v8, 162816, v8
    v_lshlrev_b32_e64 v9, 4, v2
    s_lshl_b32 s56, s51, 2
    s_add_u32 s56, s56, s48
    s_mul_i32 s60, s56, 40960
    s_add_u32 s74, s60, 3145728
    s_add_u32 s75, s74, 40960
    s_and_b32 s57, s52, 3
    s_mul_i32 s57, s57, 0
    s_lshr_b32 s57, s57, 1
    s_lshl_b32 s57, s57, 12
    s_add_u32 s60, s74, s57
    s_lshl_b32 s72, s56, 8
    s_add_u32 s72, s72, 16384
    s_mul_i32 s56, s56, 114688
    s_add_u32 s56, s56, 14680064
    s_lshl_b32 s57, s52, 1
    s_add_u32 s57, s57, 0
    s_and_b32 s58, s57, 3
    s_mul_i32 s58, s58, 14
    s_lshr_b32 s57, s57, 2
    s_add_u32 s57, s57, s58
    s_lshl_b32 s57, s57, 10
    s_add_u32 s68, s56, s57
    s_lshl_b32 s57, s52, 1
    s_add_u32 s57, s57, 1
    s_and_b32 s58, s57, 3
    s_mul_i32 s58, s58, 14
    s_lshr_b32 s57, s57, 2
    s_add_u32 s57, s57, s58
    s_lshl_b32 s57, s57, 10
    s_add_u32 s69, s56, s57
    s_mov_b32 s57, s52
    s_and_b32 s58, s57, 3
    s_mul_i32 s58, s58, 14
    s_lshr_b32 s57, s57, 2
    s_add_u32 s57, s57, s58
    s_add_u32 s57, s57, 8
    s_lshl_b32 s57, s57, 10
    s_add_u32 s70, s56, s57
    s_lshr_b32 s57, s52, 1
    s_and_b32 s58, s57, 3
    s_mul_i32 s58, s58, 14
    s_lshr_b32 s57, s57, 2
    s_add_u32 s57, s57, s58
    s_add_u32 s57, s57, 12
    s_lshl_b32 s57, s57, 10
    s_add_u32 s71, s56, s57
    s_and_b32 s57, s52, 1
    s_mul_i32 s57, s57, 57344
    s_add_u32 s71, s71, s57
    s_xor_b32 s57, s48, 0
    s_lshl_b32 s58, s53, 2
    s_add_u32 s57, s57, s58
    s_mul_i32 s57, s57, 56
    s_mul_i32 s58, s48, 14
    s_add_u32 s57, s57, s58
    s_lshl_b32 s57, s57, 10
    s_add_u32 s64, s57, 14680064
    s_xor_b32 s57, s48, 1
    s_lshl_b32 s58, s53, 2
    s_add_u32 s57, s57, s58
    s_mul_i32 s57, s57, 56
    s_mul_i32 s58, s48, 14
    s_add_u32 s57, s57, s58
    s_lshl_b32 s57, s57, 10
    s_add_u32 s65, s57, 14680064
    s_xor_b32 s57, s48, 2
    s_lshl_b32 s58, s53, 2
    s_add_u32 s57, s57, s58
    s_mul_i32 s57, s57, 56
    s_mul_i32 s58, s48, 14
    s_add_u32 s57, s57, s58
    s_lshl_b32 s57, s57, 10
    s_add_u32 s66, s57, 14680064
    s_xor_b32 s57, s48, 3
    s_lshl_b32 s58, s53, 2
    s_add_u32 s57, s57, s58
    s_mul_i32 s57, s57, 56
    s_mul_i32 s58, s48, 14
    s_add_u32 s57, s57, s58
    s_lshl_b32 s57, s57, 10
    s_add_u32 s67, s57, 14680064
    s_cmp_lg_u32 s48, 0
    s_cbranch_scc1 L_np18
    s_mov_b32 s55, 22183936
    v_lshlrev_b32_e64 v26, 7, v1
    v_add_u32 v27, 8192, v26
    v_min_u32 v28, 31, v1
    v_lshlrev_b32 v28, 7, v28
    v_add_u32 v28, 16384, v28
    buffer_load_dwordx2 v[10:11], v26, s[8:11], s55 offen sc1
    buffer_load_dwordx2 v[12:13], v27, s[8:11], s55 offen sc1
    buffer_load_dwordx2 v[14:15], v28, s[8:11], s55 offen sc1
    s_waitcnt vmcnt(0)
    v_cmp_ne_u64 s[18:19], s[0:1], v[10:11]
    v_cmp_ne_u64 s[20:21], s[0:1], v[12:13]
    v_cmp_ne_u64 s[22:23], s[0:1], v[14:15]
    s_mov_b64 vcc, s[18:19]
    s_or_b64 vcc, vcc, s[20:21]
    s_or_b64 vcc, vcc, s[22:23]
    s_cbranch_vccz L_mok20
    s_mov_b32 s3, 0
L_mp19:
    s_mov_b64 exec, s[18:19]
    s_cbranch_execz L_mp19_0
    buffer_load_dwordx2 v[10:11], v26, s[8:11], s55 offen sc1
L_mp19_0:
    s_mov_b64 exec, s[20:21]
    s_cbranch_execz L_mp19_1
    buffer_load_dwordx2 v[12:13], v27, s[8:11], s55 offen sc1
L_mp19_1:
    s_mov_b64 exec, s[22:23]
    s_cbranch_execz L_mp19_2
    buffer_load_dwordx2 v[14:15], v28, s[8:11], s55 offen sc1
L_mp19_2:
    s_mov_b64 exec, -1
    s_waitcnt vmcnt(0)
    v_cmp_ne_u64 s[18:19], s[0:1], v[10:11]
    v_cmp_ne_u64 s[20:21], s[0:1], v[12:13]
    v_cmp_ne_u64 s[22:23], s[0:1], v[14:15]
    s_mov_b64 vcc, s[18:19]
    s_or_b64 vcc, vcc, s[20:21]
    s_or_b64 vcc, vcc, s[22:23]
    s_add_u32 s3, s3, 1
    s_cmp_gt_u32 s3, 1000000
    s_cbranch_scc1 L_mok20
    s_cbranch_vccnz L_mp19
L_mok20:
L_np18:
    s_waitcnt vmcnt(0) lgkmcnt(0)
    s_cmp_eq_u32 s52, 15
    s_barrier
    s_cbranch_scc1 L_j15
    buffer_load_dwordx4 v[144:147], v7, s[8:11], s60 offen offset:0 sc1
    buffer_load_dwordx4 v[148:151], v7, s[8:11], s60 offen offset:256 sc1
    buffer_load_dwordx4 v[152:155], v7, s[8:11], s60 offen offset:2048 sc1
    buffer_load_dwordx4 v[156:159], v7, s[8:11], s60 offen offset:2304 sc1
    s_add_u32 s60, s60, 4096
    buffer_load_dwordx4 v[160:163], v7, s[8:11], s60 offen offset:0 sc1
    buffer_load_dwordx4 v[164:167], v7, s[8:11], s60 offen offset:256 sc1
    buffer_load_dwordx4 v[168:171], v7, s[8:11], s60 offen offset:2048 sc1
    buffer_load_dwordx4 v[172:175], v7, s[8:11], s60 offen offset:2304 sc1
    s_add_u32 s60, s60, 4096
    buffer_load_dwordx4 v[176:179], v7, s[8:11], s60 offen offset:0 sc1
    buffer_load_dwordx4 v[180:183], v7, s[8:11], s60 offen offset:256 sc1
    v_add_u32 v24, 57344, v4
    s_cmp_lg_u32 s2, 255
    s_cbranch_scc1 L_dz21
    s_mov_b32 s14, 128
    v_mov_b32 v23, 0
    v_lshlrev_b32_e64 v3, 2, v0
    buffer_store_dword v23, v3, s[12:15], 0 offen sc1
L_dz21:
    s_mov_b32 s12, s42
    s_mov_b32 s13, s43
    s_mov_b32 s14, 2621440
    s_mov_b32 s15, 0x20000
    ds_read_b128 a[48:51], v4 offset:0
    ds_read_b128 a[52:55], v4 offset:1024
    ds_read_b128 a[56:59], v4 offset:2048
    ds_read_b128 a[60:63], v4 offset:3072
    ds_read_b128 a[64:67], v4 offset:4096
    ds_read_b128 a[68:71], v4 offset:5120
    ds_read_b128 a[72:75], v4 offset:6144
    s_waitcnt vmcnt(8)
    v_swap_b32 v146, v148
    v_swap_b32 v147, v149
    s_waitcnt lgkmcnt(3)
    s_nop 0
    v_mfma_f32_16x16x32_bf16 v[32:35], a[48:51], v[144:147], 0
    ds_read_b128 a[76:79], v4 offset:7168
    s_waitcnt vmcnt(6)
    v_mfma_f32_16x16x32_bf16 v[36:39], a[48:51], v[148:151], 0
    buffer_load_dwordx4 v[184:187], v7, s[8:11], s60 offen offset:2048 sc1
    v_mfma_f32_16x16x32_bf16 v[40:43], a[52:55], v[144:147], 0
    ds_read_b128 a[48:51], v4 offset:8192
    v_mfma_f32_16x16x32_bf16 v[44:47], a[52:55], v[148:151], 0
    v_swap_b32 v154, v156
    v_mfma_f32_16x16x32_bf16 v[48:51], a[56:59], v[144:147], 0
    ds_read_b128 a[52:55], v4 offset:9216
    v_mfma_f32_16x16x32_bf16 v[52:55], a[56:59], v[148:151], 0
    v_swap_b32 v155, v157
    v_mfma_f32_16x16x32_bf16 v[56:59], a[60:63], v[144:147], 0
    ds_read_b128 a[56:59], v4 offset:10240
    v_mfma_f32_16x16x32_bf16 v[60:63], a[60:63], v[148:151], 0
    s_waitcnt lgkmcnt(3)
    v_mfma_f32_16x16x32_bf16 v[64:67], a[64:67], v[144:147], 0
    ds_read_b128 a[60:63], v4 offset:11264
    v_mfma_f32_16x16x32_bf16 v[68:71], a[64:67], v[148:151], 0
    buffer_load_dwordx4 v[188:191], v7, s[8:11], s60 offen offset:2304 sc1
    v_mfma_f32_16x16x32_bf16 v[72:75], a[68:71], v[144:147], 0
    ds_read_b128 a[64:67], v4 offset:12288
    v_mfma_f32_16x16x32_bf16 v[76:79], a[68:71], v[148:151], 0
    v_mfma_f32_16x16x32_bf16 v[80:83], a[72:75], v[144:147], 0
    ds_read_b128 a[68:71], v4 offset:13312
    v_mfma_f32_16x16x32_bf16 v[84:87], a[72:75], v[148:151], 0
    v_mfma_f32_16x16x32_bf16 v[88:91], a[76:79], v[144:147], 0
    ds_read_b128 a[72:75], v4 offset:14336
    v_mfma_f32_16x16x32_bf16 v[92:95], a[76:79], v[148:151], 0
    s_waitcnt lgkmcnt(3)
    v_mfma_f32_16x16x32_bf16 v[32:35], a[48:51], v[152:155], v[32:35]
    ds_read_b128 a[76:79], v4 offset:15360
    s_add_u32 s60, s60, 4096
    v_mfma_f32_16x16x32_bf16 v[36:39], a[48:51], v[156:159], v[36:39]
    buffer_load_dwordx4 v[192:195], v7, s[8:11], s60 offen offset:0 sc1
    v_mfma_f32_16x16x32_bf16 v[40:43], a[52:55], v[152:155], v[40:43]
    ds_read_b128 a[48:51], v4 offset:16384
    s_waitcnt vmcnt(7)
    v_mfma_f32_16x16x32_bf16 v[44:47], a[52:55], v[156:159], v[44:47]
    v_swap_b32 v162, v164
    v_mfma_f32_16x16x32_bf16 v[48:51], a[56:59], v[152:155], v[48:51]
    ds_read_b128 a[52:55], v4 offset:17408
    v_mfma_f32_16x16x32_bf16 v[52:55], a[56:59], v[156:159], v[52:55]
    v_swap_b32 v163, v165
    v_mfma_f32_16x16x32_bf16 v[56:59], a[60:63], v[152:155], v[56:59]
    ds_read_b128 a[56:59], v4 offset:18432
    v_mfma_f32_16x16x32_bf16 v[60:63], a[60:63], v[156:159], v[60:63]
    s_waitcnt lgkmcnt(3)
    v_mfma_f32_16x16x32_bf16 v[64:67], a[64:67], v[152:155], v[64:67]
    ds_read_b128 a[60:63], v4 offset:19456
    v_mfma_f32_16x16x32_bf16 v[68:71], a[64:67], v[156:159], v[68:71]
    buffer_load_dwordx4 v[196:199], v7, s[8:11], s60 offen offset:256 sc1
    v_mfma_f32_16x16x32_bf16 v[72:75], a[68:71], v[152:155], v[72:75]
    ds_read_b128 a[64:67], v4 offset:20480
    v_mfma_f32_16x16x32_bf16 v[76:79], a[68:71], v[156:159], v[76:79]
    v_add_f32 v16, v16, v17
    v_add_f32 v18, v18, v19
    v_mfma_f32_16x16x32_bf16 v[80:83], a[72:75], v[152:155], v[80:83]
    ds_read_b128 a[68:71], v4 offset:21504
    v_mfma_f32_16x16x32_bf16 v[84:87], a[72:75], v[156:159], v[84:87]
    v_add_f32 v20, v20, v21
    v_add_f32 v16, v16, v22
    v_mfma_f32_16x16x32_bf16 v[88:91], a[76:79], v[152:155], v[88:91]
    ds_read_b128 a[72:75], v4 offset:22528
    v_mfma_f32_16x16x32_bf16 v[92:95], a[76:79], v[156:159], v[92:95]
    v_add_f32 v18, v18, v20
    v_lshlrev_b32 v2, 2, v0
    v_add_u32 v2, 162816, v2
    v_add_f32 v16, v16, v18
    ds_write_b32 v2, v16
    s_waitcnt lgkmcnt(4)
    v_mfma_f32_16x16x32_bf16 v[32:35], a[48:51], v[160:163], v[32:35]
    ds_read_b128 a[76:79], v4 offset:23552
    s_waitcnt vmcnt(6)
    v_mfma_f32_16x16x32_bf16 v[36:39], a[48:51], v[164:167], v[36:39]
    buffer_load_dwordx4 v[200:203], v7, s[8:11], s60 offen offset:2048 sc1
    v_mfma_f32_16x16x32_bf16 v[40:43], a[52:55], v[160:163], v[40:43]
    ds_read_b128 a[48:51], v4 offset:24576
    v_mfma_f32_16x16x32_bf16 v[44:47], a[52:55], v[164:167], v[44:47]
    v_swap_b32 v170, v172
    v_mfma_f32_16x16x32_bf16 v[48:51], a[56:59], v[160:163], v[48:51]
    ds_read_b128 a[52:55], v4 offset:25600
    v_mfma_f32_16x16x32_bf16 v[52:55], a[56:59], v[164:167], v[52:55]
    v_swap_b32 v171, v173
    v_mfma_f32_16x16x32_bf16 v[56:59], a[60:63], v[160:163], v[56:59]
    ds_read_b128 a[56:59], v4 offset:26624
    v_mfma_f32_16x16x32_bf16 v[60:63], a[60:63], v[164:167], v[60:63]
    s_waitcnt lgkmcnt(3)
    v_mfma_f32_16x16x32_bf16 v[64:67], a[64:67], v[160:163], v[64:67]
    ds_read_b128 a[60:63], v4 offset:27648
    v_mfma_f32_16x16x32_bf16 v[68:71], a[64:67], v[164:167], v[68:71]
    buffer_load_dwordx4 v[204:207], v7, s[8:11], s60 offen offset:2304 sc1
    v_mfma_f32_16x16x32_bf16 v[72:75], a[68:71], v[160:163], v[72:75]
    ds_read_b128 a[64:67], v4 offset:28672
    v_mfma_f32_16x16x32_bf16 v[76:79], a[68:71], v[164:167], v[76:79]
    v_mfma_f32_16x16x32_bf16 v[80:83], a[72:75], v[160:163], v[80:83]
    ds_read_b128 a[68:71], v4 offset:29696
    v_mfma_f32_16x16x32_bf16 v[84:87], a[72:75], v[164:167], v[84:87]
    v_mfma_f32_16x16x32_bf16 v[88:91], a[76:79], v[160:163], v[88:91]
    ds_read_b128 a[72:75], v4 offset:30720
    v_mfma_f32_16x16x32_bf16 v[92:95], a[76:79], v[164:167], v[92:95]
    s_waitcnt lgkmcnt(3)
    v_mfma_f32_16x16x32_bf16 v[32:35], a[48:51], v[168:171], v[32:35]
    ds_read_b128 a[76:79], v4 offset:31744
    s_addk_i32 s60, 4096
    v_mfma_f32_16x16x32_bf16 v[36:39], a[48:51], v[172:175], v[36:39]
    buffer_load_dwordx4 v[208:211], v7, s[8:11], s60 offen offset:0 sc1
    v_mfma_f32_16x16x32_bf16 v[40:43], a[52:55], v[168:171], v[40:43]
    ds_read_b128 a[48:51], v4 offset:32768
    s_waitcnt vmcnt(7)
    v_mfma_f32_16x16x32_bf16 v[44:47], a[52:55], v[172:175], v[44:47]
    v_swap_b32 v178, v180
    v_mfma_f32_16x16x32_bf16 v[48:51], a[56:59], v[168:171], v[48:51]
    ds_read_b128 a[52:55], v4 offset:33792
    v_mfma_f32_16x16x32_bf16 v[52:55], a[56:59], v[172:175], v[52:55]
    v_swap_b32 v179, v181
    v_mfma_f32_16x16x32_bf16 v[56:59], a[60:63], v[168:171], v[56:59]
    ds_read_b128 a[56:59], v4 offset:34816
    v_mfma_f32_16x16x32_bf16 v[60:63], a[60:63], v[172:175], v[60:63]
    s_waitcnt lgkmcnt(3)
    v_mfma_f32_16x16x32_bf16 v[64:67], a[64:67], v[168:171], v[64:67]
    ds_read_b128 a[60:63], v4 offset:35840
    v_mfma_f32_16x16x32_bf16 v[68:71], a[64:67], v[172:175], v[68:71]
    buffer_load_dwordx4 v[212:215], v7, s[8:11], s60 offen offset:256 sc1
    v_mfma_f32_16x16x32_bf16 v[72:75], a[68:71], v[168:171], v[72:75]
    ds_read_b128 a[64:67], v4 offset:36864
    v_mfma_f32_16x16x32_bf16 v[76:79], a[68:71], v[172:175], v[76:79]
    v_mfma_f32_16x16x32_bf16 v[80:83], a[72:75], v[168:171], v[80:83]
    ds_read_b128 a[68:71], v4 offset:37888
    v_mfma_f32_16x16x32_bf16 v[84:87], a[72:75], v[172:175], v[84:87]
    v_mfma_f32_16x16x32_bf16 v[88:91], a[76:79], v[168:171], v[88:91]
    ds_read_b128 a[72:75], v4 offset:38912
    v_mfma_f32_16x16x32_bf16 v[92:95], a[76:79], v[172:175], v[92:95]
    s_barrier
    s_waitcnt lgkmcnt(3)
    v_mfma_f32_16x16x32_bf16 v[32:35], a[48:51], v[176:179], v[32:35]
    ds_read_b128 a[76:79], v4 offset:39936
    s_waitcnt vmcnt(6)
    v_mfma_f32_16x16x32_bf16 v[36:39], a[48:51], v[180:183], v[36:39]
    buffer_load_dwordx4 v[216:219], v7, s[8:11], s60 offen offset:2048 sc1
    v_mfma_f32_16x16x32_bf16 v[40:43], a[52:55], v[176:179], v[40:43]
    ds_read_b128 a[48:51], v4 offset:40960
    v_mfma_f32_16x16x32_bf16 v[44:47], a[52:55], v[180:183], v[44:47]
    v_swap_b32 v186, v188
    v_mfma_f32_16x16x32_bf16 v[48:51], a[56:59], v[176:179], v[48:51]
    ds_read_b128 a[52:55], v4 offset:41984
    v_mfma_f32_16x16x32_bf16 v[52:55], a[56:59], v[180:183], v[52:55]
    buffer_load_dwordx4 v[220:223], v7, s[8:11], s60 offen offset:2304 sc1
    v_mfma_f32_16x16x32_bf16 v[56:59], a[60:63], v[176:179], v[56:59]
    ds_read_b128 a[56:59], v4 offset:43008
    v_mfma_f32_16x16x32_bf16 v[60:63], a[60:63], v[180:183], v[60:63]
    s_waitcnt lgkmcnt(3)
    v_mfma_f32_16x16x32_bf16 v[64:67], a[64:67], v[176:179], v[64:67]
    ds_read_b128 a[60:63], v4 offset:44032
    v_mfma_f32_16x16x32_bf16 v[68:71], a[64:67], v[180:183], v[68:71]
    s_add_u32 m0, s62, 0
    s_add_u32 s61, s61, 16384
    v_mfma_f32_16x16x32_bf16 v[72:75], a[68:71], v[176:179], v[72:75]
    ds_read_b128 a[64:67], v4 offset:45056
    v_mfma_f32_16x16x32_bf16 v[76:79], a[68:71], v[180:183], v[76:79]
    buffer_load_dwordx4 v4, s[8:11], s61 offen offset:0 sc1 lds
    v_mfma_f32_16x16x32_bf16 v[80:83], a[72:75], v[176:179], v[80:83]
    ds_read_b128 a[68:71], v4 offset:46080
    v_mfma_f32_16x16x32_bf16 v[84:87], a[72:75], v[180:183], v[84:87]
    v_swap_b32 v187, v189
    v_mfma_f32_16x16x32_bf16 v[88:91], a[76:79], v[176:179], v[88:91]
    ds_read_b128 a[72:75], v4 offset:47104
    v_mfma_f32_16x16x32_bf16 v[92:95], a[76:79], v[180:183], v[92:95]
    s_waitcnt lgkmcnt(3)
    v_mfma_f32_16x16x32_bf16 v[32:35], a[48:51], v[184:187], v[32:35]
    ds_read_b128 a[76:79], v4 offset:48128
    s_add_u32 s60, s60, 4096
    v_mfma_f32_16x16x32_bf16 v[36:39], a[48:51], v[188:191], v[36:39]
    buffer_load_dwordx4 v[224:227], v7, s[8:11], s60 offen offset:0 sc1
    v_mfma_f32_16x16x32_bf16 v[40:43], a[52:55], v[184:187], v[40:43]
    ds_read_b128 a[48:51], v4 offset:49152
    s_waitcnt vmcnt(8)
    v_mfma_f32_16x16x32_bf16 v[44:47], a[52:55], v[188:191], v[44:47]
    v_swap_b32 v194, v196
    v_mfma_f32_16x16x32_bf16 v[48:51], a[56:59], v[184:187], v[48:51]
    ds_read_b128 a[52:55], v4 offset:50176
    v_mfma_f32_16x16x32_bf16 v[52:55], a[56:59], v[188:191], v[52:55]
    buffer_load_dwordx4 v[228:231], v7, s[8:11], s60 offen offset:256 sc1
    v_mfma_f32_16x16x32_bf16 v[56:59], a[60:63], v[184:187], v[56:59]
    ds_read_b128 a[56:59], v4 offset:51200
    v_mfma_f32_16x16x32_bf16 v[60:63], a[60:63], v[188:191], v[60:63]
    s_waitcnt lgkmcnt(3)
    v_mfma_f32_16x16x32_bf16 v[64:67], a[64:67], v[184:187], v[64:67]
    ds_read_b128 a[60:63], v4 offset:52224
    v_mfma_f32_16x16x32_bf16 v[68:71], a[64:67], v[188:191], v[68:71]
    buffer_load_dwordx4 v4, s[8:11], s61 offen offset:1024 sc1 lds
    v_mfma_f32_16x16x32_bf16 v[72:75], a[68:71], v[184:187], v[72:75]
    ds_read_b128 a[64:67], v4 offset:53248
    v_mfma_f32_16x16x32_bf16 v[76:79], a[68:71], v[188:191], v[76:79]
    v_swap_b32 v195, v197
    v_mfma_f32_16x16x32_bf16 v[80:83], a[72:75], v[184:187], v[80:83]
    ds_read_b128 a[68:71], v4 offset:54272
    v_mfma_f32_16x16x32_bf16 v[84:87], a[72:75], v[188:191], v[84:87]
    buffer_load_dwordx4 v4, s[8:11], s61 offen offset:2048 sc1 lds
    v_mfma_f32_16x16x32_bf16 v[88:91], a[76:79], v[184:187], v[88:91]
    ds_read_b128 a[72:75], v4 offset:55296
    v_mfma_f32_16x16x32_bf16 v[92:95], a[76:79], v[188:191], v[92:95]
    s_waitcnt lgkmcnt(3)
    v_mfma_f32_16x16x32_bf16 v[32:35], a[48:51], v[192:195], v[32:35]
    ds_read_b128 a[76:79], v4 offset:56320
    s_waitcnt vmcnt(9)
    v_mfma_f32_16x16x32_bf16 v[36:39], a[48:51], v[196:199], v[36:39]
    buffer_load_dwordx4 v[232:235], v7, s[8:11], s60 offen offset:2048 sc1
    v_mfma_f32_16x16x32_bf16 v[40:43], a[52:55], v[192:195], v[40:43]
    ds_read_b128 a[48:51], v4 offset:57344
    v_mfma_f32_16x16x32_bf16 v[44:47], a[52:55], v[196:199], v[44:47]
    v_swap_b32 v202, v204
    v_mfma_f32_16x16x32_bf16 v[48:51], a[56:59], v[192:195], v[48:51]
    ds_read_b128 a[52:55], v4 offset:58368
    v_mfma_f32_16x16x32_bf16 v[52:55], a[56:59], v[196:199], v[52:55]
    buffer_load_dwordx4 v[236:239], v7, s[8:11], s60 offen offset:2304 sc1
    v_mfma_f32_16x16x32_bf16 v[56:59], a[60:63], v[192:195], v[56:59]
    ds_read_b128 a[56:59], v4 offset:59392
    v_mfma_f32_16x16x32_bf16 v[60:63], a[60:63], v[196:199], v[60:63]
    s_waitcnt lgkmcnt(3)
    v_mfma_f32_16x16x32_bf16 v[64:67], a[64:67], v[192:195], v[64:67]
    ds_read_b128 a[60:63], v4 offset:60416
    v_mfma_f32_16x16x32_bf16 v[68:71], a[64:67], v[196:199], v[68:71]
    v_swap_b32 v203, v205
    v_mfma_f32_16x16x32_bf16 v[72:75], a[68:71], v[192:195], v[72:75]
    ds_read_b128 a[64:67], v4 offset:61440
    v_mfma_f32_16x16x32_bf16 v[76:79], a[68:71], v[196:199], v[76:79]
    buffer_load_dwordx4 v4, s[8:11], s61 offen offset:3072 sc1 lds
    v_mfma_f32_16x16x32_bf16 v[80:83], a[72:75], v[192:195], v[80:83]
    ds_read_b128 a[68:71], v4 offset:62464
    v_mfma_f32_16x16x32_bf16 v[84:87], a[72:75], v[196:199], v[84:87]
    v_mfma_f32_16x16x32_bf16 v[88:91], a[76:79], v[192:195], v[88:91]
    ds_read_b128 a[72:75], v4 offset:63488
    v_mfma_f32_16x16x32_bf16 v[92:95], a[76:79], v[196:199], v[92:95]
    s_waitcnt lgkmcnt(3)
    v_mfma_f32_16x16x32_bf16 v[32:35], a[48:51], v[200:203], v[32:35]
    ds_read_b128 a[76:79], v4 offset:64512
    s_add_u32 s60, s60, 4096
    v_mfma_f32_16x16x32_bf16 v[36:39], a[48:51], v[204:207], v[36:39]
    buffer_load_dwordx4 v[240:243], v7, s[8:11], s60 offen offset:0 sc1
    v_mfma_f32_16x16x32_bf16 v[40:43], a[52:55], v[200:203], v[40:43]
    ds_read_b128 a[48:51], v5 offset:0
    s_waitcnt vmcnt(11)
    v_mfma_f32_16x16x32_bf16 v[44:47], a[52:55], v[204:207], v[44:47]
    v_swap_b32 v210, v212
    v_mfma_f32_16x16x32_bf16 v[48:51], a[56:59], v[200:203], v[48:51]
    ds_read_b128 a[52:55], v5 offset:1024
    v_mfma_f32_16x16x32_bf16 v[52:55], a[56:59], v[204:207], v[52:55]
    buffer_load_dwordx4 v[244:247], v7, s[8:11], s60 offen offset:256 sc1
    v_mfma_f32_16x16x32_bf16 v[56:59], a[60:63], v[200:203], v[56:59]
    ds_read_b128 a[56:59], v5 offset:2048
    v_mfma_f32_16x16x32_bf16 v[60:63], a[60:63], v[204:207], v[60:63]
    s_waitcnt lgkmcnt(3)
    v_mfma_f32_16x16x32_bf16 v[64:67], a[64:67], v[200:203], v[64:67]
    ds_read_b128 a[60:63], v5 offset:3072
    v_mfma_f32_16x16x32_bf16 v[68:71], a[64:67], v[204:207], v[68:71]
    s_add_u32 m0, s62, 16384
    s_addk_i32 s61, 16384
    v_mfma_f32_16x16x32_bf16 v[72:75], a[68:71], v[200:203], v[72:75]
    ds_read_b128 a[64:67], v5 offset:4096
    v_mfma_f32_16x16x32_bf16 v[76:79], a[68:71], v[204:207], v[76:79]
    buffer_load_dwordx4 v4, s[8:11], s61 offen offset:0 sc1 lds
    v_mfma_f32_16x16x32_bf16 v[80:83], a[72:75], v[200:203], v[80:83]
    ds_read_b128 a[68:71], v5 offset:5120
    v_mfma_f32_16x16x32_bf16 v[84:87], a[72:75], v[204:207], v[84:87]
    buffer_load_dwordx4 v4, s[8:11], s61 offen offset:1024 sc1 lds
    v_mfma_f32_16x16x32_bf16 v[88:91], a[76:79], v[200:203], v[88:91]
    ds_read_b128 a[72:75], v5 offset:6144
    v_mfma_f32_16x16x32_bf16 v[92:95], a[76:79], v[204:207], v[92:95]
    v_swap_b32 v211, v213
    s_barrier
    s_waitcnt lgkmcnt(3)
    v_mfma_f32_16x16x32_bf16 v[32:35], a[48:51], v[208:211], v[32:35]
    ds_read_b128 a[76:79], v5 offset:7168
    s_waitcnt vmcnt(12)
    v_mfma_f32_16x16x32_bf16 v[36:39], a[48:51], v[212:215], v[36:39]
    buffer_load_dwordx4 v[248:251], v7, s[8:11], s60 offen offset:2048 sc1
    v_mfma_f32_16x16x32_bf16 v[40:43], a[52:55], v[208:211], v[40:43]
    ds_read_b128 a[48:51], v5 offset:8192
    v_mfma_f32_16x16x32_bf16 v[44:47], a[52:55], v[212:215], v[44:47]
    v_swap_b32 v218, v220
    v_mfma_f32_16x16x32_bf16 v[48:51], a[56:59], v[208:211], v[48:51]
    ds_read_b128 a[52:55], v5 offset:9216
    v_mfma_f32_16x16x32_bf16 v[52:55], a[56:59], v[212:215], v[52:55]
    buffer_load_dwordx4 v[252:255], v7, s[8:11], s60 offen offset:2304 sc1
    v_mfma_f32_16x16x32_bf16 v[56:59], a[60:63], v[208:211], v[56:59]
    ds_read_b128 a[56:59], v5 offset:10240
    v_mfma_f32_16x16x32_bf16 v[60:63], a[60:63], v[212:215], v[60:63]
    s_waitcnt lgkmcnt(3)
    v_mfma_f32_16x16x32_bf16 v[64:67], a[64:67], v[208:211], v[64:67]
    ds_read_b128 a[60:63], v5 offset:11264
    v_mfma_f32_16x16x32_bf16 v[68:71], a[64:67], v[212:215], v[68:71]
    v_swap_b32 v219, v221
    v_mfma_f32_16x16x32_bf16 v[72:75], a[68:71], v[208:211], v[72:75]
    ds_read_b128 a[64:67], v5 offset:12288
    v_mfma_f32_16x16x32_bf16 v[76:79], a[68:71], v[212:215], v[76:79]
    buffer_load_dwordx4 v4, s[8:11], s61 offen offset:2048 sc1 lds
    v_mfma_f32_16x16x32_bf16 v[80:83], a[72:75], v[208:211], v[80:83]
    ds_read_b128 a[68:71], v5 offset:13312
    v_mfma_f32_16x16x32_bf16 v[84:87], a[72:75], v[212:215], v[84:87]
    v_mfma_f32_16x16x32_bf16 v[88:91], a[76:79], v[208:211], v[88:91]
    ds_read_b128 a[72:75], v5 offset:14336
    v_mfma_f32_16x16x32_bf16 v[92:95], a[76:79], v[212:215], v[92:95]
    s_waitcnt lgkmcnt(3)
    v_mfma_f32_16x16x32_bf16 v[32:35], a[48:51], v[216:219], v[32:35]
    ds_read_b128 a[76:79], v5 offset:15360
    s_add_u32 s60, s60, 4096
    v_mfma_f32_16x16x32_bf16 v[36:39], a[48:51], v[220:223], v[36:39]
    buffer_load_dwordx4 v[96:99], v7, s[8:11], s60 offen offset:0 sc1
    v_mfma_f32_16x16x32_bf16 v[40:43], a[52:55], v[216:219], v[40:43]
    ds_read_b128 a[48:51], v5 offset:16384
    s_waitcnt vmcnt(13)
    v_mfma_f32_16x16x32_bf16 v[44:47], a[52:55], v[220:223], v[44:47]
    v_swap_b32 v226, v228
    v_mfma_f32_16x16x32_bf16 v[48:51], a[56:59], v[216:219], v[48:51]
    ds_read_b128 a[52:55], v5 offset:17408
    v_mfma_f32_16x16x32_bf16 v[52:55], a[56:59], v[220:223], v[52:55]
    buffer_load_dwordx4 v[100:103], v7, s[8:11], s60 offen offset:256 sc1
    v_mfma_f32_16x16x32_bf16 v[56:59], a[60:63], v[216:219], v[56:59]
    ds_read_b128 a[56:59], v5 offset:18432
    v_mfma_f32_16x16x32_bf16 v[60:63], a[60:63], v[220:223], v[60:63]
    s_waitcnt lgkmcnt(3)
    v_mfma_f32_16x16x32_bf16 v[64:67], a[64:67], v[216:219], v[64:67]
    ds_read_b128 a[60:63], v5 offset:19456
    v_mfma_f32_16x16x32_bf16 v[68:71], a[64:67], v[220:223], v[68:71]
    buffer_load_dwordx4 v4, s[8:11], s61 offen offset:3072 sc1 lds
    v_mfma_f32_16x16x32_bf16 v[72:75], a[68:71], v[216:219], v[72:75]
    ds_read_b128 a[64:67], v5 offset:20480
    v_mfma_f32_16x16x32_bf16 v[76:79], a[68:71], v[220:223], v[76:79]
    s_add_u32 m0, s62, 32768
    s_add_u32 s61, s61, 16384
    v_mfma_f32_16x16x32_bf16 v[80:83], a[72:75], v[216:219], v[80:83]
    ds_read_b128 a[68:71], v5 offset:21504
    v_mfma_f32_16x16x32_bf16 v[84:87], a[72:75], v[220:223], v[84:87]
    buffer_load_dwordx4 v4, s[8:11], s61 offen offset:0 sc1 lds
    v_mfma_f32_16x16x32_bf16 v[88:91], a[76:79], v[216:219], v[88:91]
    ds_read_b128 a[72:75], v5 offset:22528
    v_mfma_f32_16x16x32_bf16 v[92:95], a[76:79], v[220:223], v[92:95]
    v_swap_b32 v227, v229
    s_waitcnt lgkmcnt(3)
    s_nop 0
    v_mfma_f32_16x16x32_bf16 v[32:35], a[48:51], v[224:227], v[32:35]
    ds_read_b128 a[76:79], v5 offset:23552
    s_waitcnt vmcnt(12)
    v_mfma_f32_16x16x32_bf16 v[36:39], a[48:51], v[228:231], v[36:39]
    buffer_load_dwordx4 v[104:107], v7, s[8:11], s60 offen offset:2048 sc1
    v_mfma_f32_16x16x32_bf16 v[40:43], a[52:55], v[224:227], v[40:43]
    ds_read_b128 a[48:51], v5 offset:24576
    v_mfma_f32_16x16x32_bf16 v[44:47], a[52:55], v[228:231], v[44:47]
    v_swap_b32 v234, v236
    v_mfma_f32_16x16x32_bf16 v[48:51], a[56:59], v[224:227], v[48:51]
    ds_read_b128 a[52:55], v5 offset:25600
    v_mfma_f32_16x16x32_bf16 v[52:55], a[56:59], v[228:231], v[52:55]
    buffer_load_dwordx4 v[108:111], v7, s[8:11], s60 offen offset:2304 sc1
    v_mfma_f32_16x16x32_bf16 v[56:59], a[60:63], v[224:227], v[56:59]
    ds_read_b128 a[56:59], v5 offset:26624
    v_mfma_f32_16x16x32_bf16 v[60:63], a[60:63], v[228:231], v[60:63]
    s_waitcnt lgkmcnt(3)
    v_mfma_f32_16x16x32_bf16 v[64:67], a[64:67], v[224:227], v[64:67]
    ds_read_b128 a[60:63], v5 offset:27648
    v_mfma_f32_16x16x32_bf16 v[68:71], a[64:67], v[228:231], v[68:71]
    v_swap_b32 v235, v237
    v_mfma_f32_16x16x32_bf16 v[72:75], a[68:71], v[224:227], v[72:75]
    ds_read_b128 a[64:67], v5 offset:28672
    v_mfma_f32_16x16x32_bf16 v[76:79], a[68:71], v[228:231], v[76:79]
    buffer_load_dwordx4 v4, s[8:11], s61 offen offset:1024 sc1 lds
    v_mfma_f32_16x16x32_bf16 v[80:83], a[72:75], v[224:227], v[80:83]
    ds_read_b128 a[68:71], v5 offset:29696
    v_mfma_f32_16x16x32_bf16 v[84:87], a[72:75], v[228:231], v[84:87]
    v_mfma_f32_16x16x32_bf16 v[88:91], a[76:79], v[224:227], v[88:91]
    ds_read_b128 a[72:75], v5 offset:30720
    v_mfma_f32_16x16x32_bf16 v[92:95], a[76:79], v[228:231], v[92:95]
    s_waitcnt lgkmcnt(3)
    v_mfma_f32_16x16x32_bf16 v[32:35], a[48:51], v[232:235], v[32:35]
    ds_read_b128 a[76:79], v5 offset:31744
    s_addk_i32 s60, 4096
    v_mfma_f32_16x16x32_bf16 v[36:39], a[48:51], v[236:239], v[36:39]
    buffer_load_dwordx4 v[112:115], v7, s[8:11], s60 offen offset:0 sc1
    v_mfma_f32_16x16x32_bf16 v[40:43], a[52:55], v[232:235], v[40:43]
    ds_read_b128 a[48:51], v5 offset:32768
    s_waitcnt vmcnt(13)
    v_mfma_f32_16x16x32_bf16 v[44:47], a[52:55], v[236:239], v[44:47]
    v_swap_b32 v242, v244
    v_mfma_f32_16x16x32_bf16 v[48:51], a[56:59], v[232:235], v[48:51]
    ds_read_b128 a[52:55], v5 offset:33792
    v_mfma_f32_16x16x32_bf16 v[52:55], a[56:59], v[236:239], v[52:55]
    buffer_load_dwordx4 v[116:119], v7, s[8:11], s60 offen offset:256 sc1
    v_mfma_f32_16x16x32_bf16 v[56:59], a[60:63], v[232:235], v[56:59]
    ds_read_b128 a[56:59], v5 offset:34816
    v_mfma_f32_16x16x32_bf16 v[60:63], a[60:63], v[236:239], v[60:63]
    s_waitcnt lgkmcnt(3)
    v_mfma_f32_16x16x32_bf16 v[64:67], a[64:67], v[232:235], v[64:67]
    ds_read_b128 a[60:63], v5 offset:35840
    v_mfma_f32_16x16x32_bf16 v[68:71], a[64:67], v[236:239], v[68:71]
    buffer_load_dwordx4 v4, s[8:11], s61 offen offset:2048 sc1 lds
    v_mfma_f32_16x16x32_bf16 v[72:75], a[68:71], v[232:235], v[72:75]
    ds_read_b128 a[64:67], v5 offset:36864
    v_mfma_f32_16x16x32_bf16 v[76:79], a[68:71], v[236:239], v[76:79]
    v_swap_b32 v243, v245
    v_mfma_f32_16x16x32_bf16 v[80:83], a[72:75], v[232:235], v[80:83]
    ds_read_b128 a[68:71], v5 offset:37888
    v_mfma_f32_16x16x32_bf16 v[84:87], a[72:75], v[236:239], v[84:87]
    buffer_load_dwordx4 v4, s[8:11], s61 offen offset:3072 sc1 lds
    v_mfma_f32_16x16x32_bf16 v[88:91], a[76:79], v[232:235], v[88:91]
    ds_read_b128 a[72:75], v5 offset:38912
    v_mfma_f32_16x16x32_bf16 v[92:95], a[76:79], v[236:239], v[92:95]
    s_waitcnt vmcnt(8)
    s_barrier
    s_waitcnt lgkmcnt(3)
    v_mfma_f32_16x16x32_bf16 v[32:35], a[48:51], v[240:243], v[32:35]
    ds_read_b128 a[76:79], v5 offset:39936
    v_mfma_f32_16x16x32_bf16 v[36:39], a[48:51], v[244:247], v[36:39]
    buffer_load_dwordx4 v[120:123], v7, s[8:11], s60 offen offset:2048 sc1
    v_mfma_f32_16x16x32_bf16 v[40:43], a[52:55], v[240:243], v[40:43]
    ds_read_b128 a[48:51], v5 offset:40960
    v_mfma_f32_16x16x32_bf16 v[44:47], a[52:55], v[244:247], v[44:47]
    v_swap_b32 v250, v252
    v_mfma_f32_16x16x32_bf16 v[48:51], a[56:59], v[240:243], v[48:51]
    ds_read_b128 a[52:55], v5 offset:41984
    v_mfma_f32_16x16x32_bf16 v[52:55], a[56:59], v[244:247], v[52:55]
    buffer_load_dwordx4 v[124:127], v7, s[8:11], s60 offen offset:2304 sc1
    v_mfma_f32_16x16x32_bf16 v[56:59], a[60:63], v[240:243], v[56:59]
    ds_read_b128 a[56:59], v5 offset:43008
    v_mfma_f32_16x16x32_bf16 v[60:63], a[60:63], v[244:247], v[60:63]
    s_waitcnt lgkmcnt(3)
    v_mfma_f32_16x16x32_bf16 v[64:67], a[64:67], v[240:243], v[64:67]
    ds_read_b128 a[60:63], v5 offset:44032
    v_mfma_f32_16x16x32_bf16 v[68:71], a[64:67], v[244:247], v[68:71]
    s_add_u32 m0, s62, 49152
    s_addk_i32 s61, 16384
    v_mfma_f32_16x16x32_bf16 v[72:75], a[68:71], v[240:243], v[72:75]
    ds_read_b128 a[64:67], v5 offset:45056
    v_mfma_f32_16x16x32_bf16 v[76:79], a[68:71], v[244:247], v[76:79]
    buffer_load_dwordx4 v4, s[8:11], s61 offen offset:0 sc1 lds
    v_mfma_f32_16x16x32_bf16 v[80:83], a[72:75], v[240:243], v[80:83]
    ds_read_b128 a[68:71], v5 offset:46080
    v_mfma_f32_16x16x32_bf16 v[84:87], a[72:75], v[244:247], v[84:87]
    v_swap_b32 v251, v253
    v_mfma_f32_16x16x32_bf16 v[88:91], a[76:79], v[240:243], v[88:91]
    ds_read_b128 a[72:75], v5 offset:47104
    v_mfma_f32_16x16x32_bf16 v[92:95], a[76:79], v[244:247], v[92:95]
    s_waitcnt lgkmcnt(3)
    v_mfma_f32_16x16x32_bf16 v[32:35], a[48:51], v[248:251], v[32:35]
    ds_read_b128 a[76:79], v5 offset:48128
    s_add_u32 s60, s60, 4096
    v_mfma_f32_16x16x32_bf16 v[36:39], a[48:51], v[252:255], v[36:39]
    buffer_load_dwordx4 v[128:131], v7, s[8:11], s60 offen offset:0 sc1
    v_mfma_f32_16x16x32_bf16 v[40:43], a[52:55], v[248:251], v[40:43]
    ds_read_b128 a[48:51], v5 offset:49152
    v_mfma_f32_16x16x32_bf16 v[44:47], a[52:55], v[252:255], v[44:47]
    v_swap_b32 v98, v100
    v_mfma_f32_16x16x32_bf16 v[48:51], a[56:59], v[248:251], v[48:51]
    ds_read_b128 a[52:55], v5 offset:50176
    v_mfma_f32_16x16x32_bf16 v[52:55], a[56:59], v[252:255], v[52:55]
    buffer_load_dwordx4 v[132:135], v7, s[8:11], s60 offen offset:256 sc1
    v_mfma_f32_16x16x32_bf16 v[56:59], a[60:63], v[248:251], v[56:59]
    ds_read_b128 a[56:59], v5 offset:51200
    v_mfma_f32_16x16x32_bf16 v[60:63], a[60:63], v[252:255], v[60:63]
    s_waitcnt lgkmcnt(3)
    v_mfma_f32_16x16x32_bf16 v[64:67], a[64:67], v[248:251], v[64:67]
    ds_read_b128 a[60:63], v5 offset:52224
    v_mfma_f32_16x16x32_bf16 v[68:71], a[64:67], v[252:255], v[68:71]
    v_swap_b32 v99, v101
    v_mfma_f32_16x16x32_bf16 v[72:75], a[68:71], v[248:251], v[72:75]
    ds_read_b128 a[64:67], v5 offset:53248
    v_mfma_f32_16x16x32_bf16 v[76:79], a[68:71], v[252:255], v[76:79]
    buffer_load_dwordx4 v4, s[8:11], s61 offen offset:1024 sc1 lds
    v_mfma_f32_16x16x32_bf16 v[80:83], a[72:75], v[248:251], v[80:83]
    ds_read_b128 a[68:71], v5 offset:54272
    v_mfma_f32_16x16x32_bf16 v[84:87], a[72:75], v[252:255], v[84:87]
    v_mfma_f32_16x16x32_bf16 v[88:91], a[76:79], v[248:251], v[88:91]
    ds_read_b128 a[72:75], v5 offset:55296
    v_mfma_f32_16x16x32_bf16 v[92:95], a[76:79], v[252:255], v[92:95]
    s_waitcnt lgkmcnt(3)
    v_mfma_f32_16x16x32_bf16 v[32:35], a[48:51], v[96:99], v[32:35]
    ds_read_b128 a[76:79], v5 offset:56320
    s_waitcnt vmcnt(11)
    v_mfma_f32_16x16x32_bf16 v[36:39], a[48:51], v[100:103], v[36:39]
    buffer_load_dwordx4 v[136:139], v7, s[8:11], s60 offen offset:2048 sc1
    v_mfma_f32_16x16x32_bf16 v[40:43], a[52:55], v[96:99], v[40:43]
    ds_read_b128 a[48:51], v5 offset:57344
    v_mfma_f32_16x16x32_bf16 v[44:47], a[52:55], v[100:103], v[44:47]
    v_swap_b32 v106, v108
    v_mfma_f32_16x16x32_bf16 v[48:51], a[56:59], v[96:99], v[48:51]
    ds_read_b128 a[52:55], v5 offset:58368
    v_mfma_f32_16x16x32_bf16 v[52:55], a[56:59], v[100:103], v[52:55]
    buffer_load_dwordx4 v[140:143], v7, s[8:11], s60 offen offset:2304 sc1
    v_mfma_f32_16x16x32_bf16 v[56:59], a[60:63], v[96:99], v[56:59]
    ds_read_b128 a[56:59], v5 offset:59392
    v_mfma_f32_16x16x32_bf16 v[60:63], a[60:63], v[100:103], v[60:63]
    s_waitcnt lgkmcnt(3)
    v_mfma_f32_16x16x32_bf16 v[64:67], a[64:67], v[96:99], v[64:67]
    ds_read_b128 a[60:63], v5 offset:60416
    v_mfma_f32_16x16x32_bf16 v[68:71], a[64:67], v[100:103], v[68:71]
    v_swap_b32 v107, v109
    v_mfma_f32_16x16x32_bf16 v[72:75], a[68:71], v[96:99], v[72:75]
    ds_read_b128 a[64:67], v5 offset:61440
    v_accvgpr_write_b32 a0, v96
    v_mfma_f32_16x16x32_bf16 v[76:79], a[68:71], v[100:103], v[76:79]
    buffer_load_dwordx4 v4, s[8:11], s61 offen offset:2048 sc1 lds
    v_mfma_f32_16x16x32_bf16 v[80:83], a[72:75], v[96:99], v[80:83]
    ds_read_b128 a[68:71], v5 offset:62464
    v_accvgpr_write_b32 a1, v97
    v_mfma_f32_16x16x32_bf16 v[84:87], a[72:75], v[100:103], v[84:87]
    v_accvgpr_write_b32 a2, v98
    v_accvgpr_write_b32 a3, v99
    v_mfma_f32_16x16x32_bf16 v[88:91], a[76:79], v[96:99], v[88:91]
    ds_read_b128 a[72:75], v5 offset:63488
    v_accvgpr_write_b32 a4, v100
    v_mfma_f32_16x16x32_bf16 v[92:95], a[76:79], v[100:103], v[92:95]
    v_accvgpr_write_b32 a5, v101
    v_accvgpr_write_b32 a6, v102
    v_accvgpr_write_b32 a7, v103
    s_waitcnt lgkmcnt(3)
    v_mfma_f32_16x16x32_bf16 v[32:35], a[48:51], v[104:107], v[32:35]
    ds_read_b128 a[76:79], v5 offset:64512
    s_waitcnt vmcnt(11)
    v_mfma_f32_16x16x32_bf16 v[36:39], a[48:51], v[108:111], v[36:39]
    buffer_load_dwordx4 v4, s[8:11], s61 offen offset:3072 sc1 lds
    v_mfma_f32_16x16x32_bf16 v[40:43], a[52:55], v[104:107], v[40:43]
    ds_read_b128 a[48:51], v6 offset:0
    v_mfma_f32_16x16x32_bf16 v[44:47], a[52:55], v[108:111], v[44:47]
    s_add_u32 m0, s62, 65536
    s_add_u32 s61, s61, 16384
    v_mfma_f32_16x16x32_bf16 v[48:51], a[56:59], v[104:107], v[48:51]
    ds_read_b128 a[52:55], v6 offset:1024
    v_mfma_f32_16x16x32_bf16 v[52:55], a[56:59], v[108:111], v[52:55]
    v_swap_b32 v114, v116
    v_mfma_f32_16x16x32_bf16 v[56:59], a[60:63], v[104:107], v[56:59]
    ds_read_b128 a[56:59], v6 offset:2048
    v_mfma_f32_16x16x32_bf16 v[60:63], a[60:63], v[108:111], v[60:63]
    s_waitcnt lgkmcnt(3)
    v_mfma_f32_16x16x32_bf16 v[64:67], a[64:67], v[104:107], v[64:67]
    ds_read_b128 a[60:63], v6 offset:3072
    v_mfma_f32_16x16x32_bf16 v[68:71], a[64:67], v[108:111], v[68:71]
    buffer_load_dwordx4 v4, s[8:11], s61 offen offset:0 sc1 lds
    v_mfma_f32_16x16x32_bf16 v[72:75], a[68:71], v[104:107], v[72:75]
    ds_read_b128 a[64:67], v6 offset:4096
    v_mfma_f32_16x16x32_bf16 v[76:79], a[68:71], v[108:111], v[76:79]
    v_swap_b32 v115, v117
    v_mfma_f32_16x16x32_bf16 v[80:83], a[72:75], v[104:107], v[80:83]
    ds_read_b128 a[68:71], v6 offset:5120
    v_accvgpr_write_b32 a8, v104
    v_mfma_f32_16x16x32_bf16 v[84:87], a[72:75], v[108:111], v[84:87]
    v_accvgpr_write_b32 a9, v105
    v_accvgpr_write_b32 a10, v106
    v_mfma_f32_16x16x32_bf16 v[88:91], a[76:79], v[104:107], v[88:91]
    ds_read_b128 a[72:75], v6 offset:6144
    v_accvgpr_write_b32 a11, v107
    v_mfma_f32_16x16x32_bf16 v[92:95], a[76:79], v[108:111], v[92:95]
    v_accvgpr_write_b32 a12, v108
    v_accvgpr_write_b32 a13, v109
    v_accvgpr_write_b32 a14, v110
    v_accvgpr_write_b32 a15, v111
    s_waitcnt vmcnt(11)
    s_barrier
    s_waitcnt lgkmcnt(3)
    v_mfma_f32_16x16x32_bf16 v[32:35], a[48:51], v[112:115], v[32:35]
    ds_read_b128 a[76:79], v6 offset:7168
    s_waitcnt vmcnt(9)
    v_mfma_f32_16x16x32_bf16 v[36:39], a[48:51], v[116:119], v[36:39]
    buffer_load_dwordx4 v4, s[8:11], s61 offen offset:1024 sc1 lds
    v_mfma_f32_16x16x32_bf16 v[40:43], a[52:55], v[112:115], v[40:43]
    ds_read_b128 a[48:51], v6 offset:8192
    v_mfma_f32_16x16x32_bf16 v[44:47], a[52:55], v[116:119], v[44:47]
    v_swap_b32 v122, v124
    v_mfma_f32_16x16x32_bf16 v[48:51], a[56:59], v[112:115], v[48:51]
    ds_read_b128 a[52:55], v6 offset:9216
    v_mfma_f32_16x16x32_bf16 v[52:55], a[56:59], v[116:119], v[52:55]
    v_swap_b32 v123, v125
    v_mfma_f32_16x16x32_bf16 v[56:59], a[60:63], v[112:115], v[56:59]
    ds_read_b128 a[56:59], v6 offset:10240
    v_accvgpr_write_b32 a16, v112
    v_mfma_f32_16x16x32_bf16 v[60:63], a[60:63], v[116:119], v[60:63]
    v_accvgpr_write_b32 a17, v113
    s_waitcnt lgkmcnt(3)
    v_mfma_f32_16x16x32_bf16 v[64:67], a[64:67], v[112:115], v[64:67]
    ds_read_b128 a[60:63], v6 offset:11264
    v_accvgpr_write_b32 a18, v114
    v_mfma_f32_16x16x32_bf16 v[68:71], a[64:67], v[116:119], v[68:71]
    buffer_load_dwordx4 v4, s[8:11], s61 offen offset:2048 sc1 lds
    v_mfma_f32_16x16x32_bf16 v[72:75], a[68:71], v[112:115], v[72:75]
    ds_read_b128 a[64:67], v6 offset:12288
    v_accvgpr_write_b32 a19, v115
    v_mfma_f32_16x16x32_bf16 v[76:79], a[68:71], v[116:119], v[76:79]
    v_accvgpr_write_b32 a20, v116
    v_accvgpr_write_b32 a21, v117
    v_mfma_f32_16x16x32_bf16 v[80:83], a[72:75], v[112:115], v[80:83]
    ds_read_b128 a[68:71], v6 offset:13312
    v_accvgpr_write_b32 a22, v118
    v_mfma_f32_16x16x32_bf16 v[84:87], a[72:75], v[116:119], v[84:87]
    v_accvgpr_write_b32 a23, v119
    v_mfma_f32_16x16x32_bf16 v[88:91], a[76:79], v[112:115], v[88:91]
    ds_read_b128 a[72:75], v6 offset:14336
    v_mfma_f32_16x16x32_bf16 v[92:95], a[76:79], v[116:119], v[92:95]
    s_waitcnt lgkmcnt(3)
    v_mfma_f32_16x16x32_bf16 v[32:35], a[48:51], v[120:123], v[32:35]
    ds_read_b128 a[76:79], v6 offset:15360
    s_waitcnt vmcnt(8)
    v_mfma_f32_16x16x32_bf16 v[36:39], a[48:51], v[124:127], v[36:39]
    buffer_load_dwordx4 v4, s[8:11], s61 offen offset:3072 sc1 lds
    v_mfma_f32_16x16x32_bf16 v[40:43], a[52:55], v[120:123], v[40:43]
    ds_read_b128 a[48:51], v4 offset:0
    v_mfma_f32_16x16x32_bf16 v[44:47], a[52:55], v[124:127], v[44:47]
    s_add_u32 m0, s62, 81920
    s_addk_i32 s61, 16384
    v_mfma_f32_16x16x32_bf16 v[48:51], a[56:59], v[120:123], v[48:51]
    ds_read_b128 a[52:55], v4 offset:1024
    v_mfma_f32_16x16x32_bf16 v[52:55], a[56:59], v[124:127], v[52:55]
    v_swap_b32 v130, v132
    v_mfma_f32_16x16x32_bf16 v[56:59], a[60:63], v[120:123], v[56:59]
    ds_read_b128 a[56:59], v4 offset:2048
    v_mfma_f32_16x16x32_bf16 v[60:63], a[60:63], v[124:127], v[60:63]
    s_waitcnt lgkmcnt(3)
    v_mfma_f32_16x16x32_bf16 v[64:67], a[64:67], v[120:123], v[64:67]
    ds_read_b128 a[60:63], v4 offset:3072
    v_mfma_f32_16x16x32_bf16 v[68:71], a[64:67], v[124:127], v[68:71]
    buffer_load_dwordx4 v4, s[8:11], s61 offen offset:0 sc1 lds
    v_mfma_f32_16x16x32_bf16 v[72:75], a[68:71], v[120:123], v[72:75]
    ds_read_b128 a[64:67], v4 offset:4096
    v_mfma_f32_16x16x32_bf16 v[76:79], a[68:71], v[124:127], v[76:79]
    v_swap_b32 v131, v133
    v_mfma_f32_16x16x32_bf16 v[80:83], a[72:75], v[120:123], v[80:83]
    ds_read_b128 a[68:71], v4 offset:5120
    v_accvgpr_write_b32 a24, v120
    v_mfma_f32_16x16x32_bf16 v[84:87], a[72:75], v[124:127], v[84:87]
    v_accvgpr_write_b32 a25, v121
    v_accvgpr_write_b32 a26, v122
    v_mfma_f32_16x16x32_bf16 v[88:91], a[76:79], v[120:123], v[88:91]
    ds_read_b128 a[72:75], v4 offset:6144
    v_accvgpr_write_b32 a27, v123
    v_mfma_f32_16x16x32_bf16 v[92:95], a[76:79], v[124:127], v[92:95]
    v_accvgpr_write_b32 a28, v124
    v_accvgpr_write_b32 a29, v125
    v_accvgpr_write_b32 a30, v126
    v_accvgpr_write_b32 a31, v127
    s_waitcnt lgkmcnt(3)
    v_mfma_f32_16x16x32_bf16 v[32:35], a[48:51], v[128:131], v[32:35]
    ds_read_b128 a[76:79], v4 offset:7168
    s_waitcnt vmcnt(7)
    v_mfma_f32_16x16x32_bf16 v[36:39], a[48:51], v[132:135], v[36:39]
    buffer_load_dwordx4 v4, s[8:11], s61 offen offset:1024 sc1 lds
    v_mfma_f32_16x16x32_bf16 v[40:43], a[52:55], v[128:131], v[40:43]
    ds_read_b128 a[48:51], v4 offset:8192
    v_mfma_f32_16x16x32_bf16 v[44:47], a[52:55], v[132:135], v[44:47]
    v_swap_b32 v138, v140
    v_mfma_f32_16x16x32_bf16 v[48:51], a[56:59], v[128:131], v[48:51]
    ds_read_b128 a[52:55], v4 offset:9216
    v_mfma_f32_16x16x32_bf16 v[52:55], a[56:59], v[132:135], v[52:55]
    v_swap_b32 v139, v141
    v_mfma_f32_16x16x32_bf16 v[56:59], a[60:63], v[128:131], v[56:59]
    ds_read_b128 a[56:59], v4 offset:10240
    v_accvgpr_write_b32 a32, v128
    v_mfma_f32_16x16x32_bf16 v[60:63], a[60:63], v[132:135], v[60:63]
    v_accvgpr_write_b32 a33, v129
    s_waitcnt lgkmcnt(3)
    v_mfma_f32_16x16x32_bf16 v[64:67], a[64:67], v[128:131], v[64:67]
    ds_read_b128 a[60:63], v4 offset:11264
    v_accvgpr_write_b32 a34, v130
    v_mfma_f32_16x16x32_bf16 v[68:71], a[64:67], v[132:135], v[68:71]
    buffer_load_dwordx4 v4, s[8:11], s61 offen offset:2048 sc1 lds
    v_mfma_f32_16x16x32_bf16 v[72:75], a[68:71], v[128:131], v[72:75]
    ds_read_b128 a[64:67], v4 offset:12288
    v_accvgpr_write_b32 a35, v131
    v_mfma_f32_16x16x32_bf16 v[76:79], a[68:71], v[132:135], v[76:79]
    v_accvgpr_write_b32 a36, v132
    v_accvgpr_write_b32 a37, v133
    v_mfma_f32_16x16x32_bf16 v[80:83], a[72:75], v[128:131], v[80:83]
    ds_read_b128 a[68:71], v4 offset:13312
    v_accvgpr_write_b32 a38, v134
    v_mfma_f32_16x16x32_bf16 v[84:87], a[72:75], v[132:135], v[84:87]
    v_accvgpr_write_b32 a39, v135
    v_mfma_f32_16x16x32_bf16 v[88:91], a[76:79], v[128:131], v[88:91]
    ds_read_b128 a[72:75], v4 offset:14336
    v_mfma_f32_16x16x32_bf16 v[92:95], a[76:79], v[132:135], v[92:95]
    buffer_load_dwordx4 v[28:31], v9, s[8:11], s72 offen sc1
    s_waitcnt lgkmcnt(3)
    v_mfma_f32_16x16x32_bf16 v[32:35], a[48:51], v[136:139], v[32:35]
    ds_read_b128 a[76:79], v4 offset:15360
    v_accvgpr_write_b32 a40, v136
    v_mfma_f32_16x16x32_bf16 v[36:39], a[48:51], v[140:143], v[36:39]
    buffer_load_dwordx4 v4, s[8:11], s61 offen offset:3072 sc1 lds
    v_mfma_f32_16x16x32_bf16 v[40:43], a[52:55], v[136:139], v[40:43]
    ds_read_b128 a[48:51], v4 offset:16384
    v_accvgpr_write_b32 a41, v137
    v_mfma_f32_16x16x32_bf16 v[44:47], a[52:55], v[140:143], v[44:47]
    s_add_u32 m0, s62, 98304
    s_addk_i32 s61, 16384
    v_mfma_f32_16x16x32_bf16 v[48:51], a[56:59], v[136:139], v[48:51]
    ds_read_b128 a[52:55], v4 offset:17408
    v_accvgpr_write_b32 a42, v138
    v_mfma_f32_16x16x32_bf16 v[52:55], a[56:59], v[140:143], v[52:55]
    v_accvgpr_write_b32 a43, v139
    v_accvgpr_write_b32 a44, v140
    v_mfma_f32_16x16x32_bf16 v[56:59], a[60:63], v[136:139], v[56:59]
    ds_read_b128 a[56:59], v4 offset:18432
    v_accvgpr_write_b32 a45, v141
    v_mfma_f32_16x16x32_bf16 v[60:63], a[60:63], v[140:143], v[60:63]
    v_accvgpr_write_b32 a46, v142
    s_waitcnt lgkmcnt(3)
    v_mfma_f32_16x16x32_bf16 v[64:67], a[64:67], v[136:139], v[64:67]
    ds_read_b128 a[60:63], v4 offset:19456
    v_accvgpr_write_b32 a47, v143
    v_mfma_f32_16x16x32_bf16 v[68:71], a[64:67], v[140:143], v[68:71]
    buffer_load_dwordx4 v4, s[8:11], s61 offen offset:0 sc1 lds
    v_mfma_f32_16x16x32_bf16 v[72:75], a[68:71], v[136:139], v[72:75]
    ds_read_b128 a[64:67], v4 offset:20480
    v_mfma_f32_16x16x32_bf16 v[76:79], a[68:71], v[140:143], v[76:79]
    ds_read_b128 v[16:19], v8 offset:0
    ds_read_b128 v[20:23], v8 offset:448
    v_mfma_f32_16x16x32_bf16 v[80:83], a[72:75], v[136:139], v[80:83]
    ds_read_b128 a[68:71], v4 offset:21504
    v_mfma_f32_16x16x32_bf16 v[84:87], a[72:75], v[140:143], v[84:87]
    v_mfma_f32_16x16x32_bf16 v[88:91], a[76:79], v[136:139], v[88:91]
    ds_read_b128 a[72:75], v4 offset:22528
    v_mfma_f32_16x16x32_bf16 v[92:95], a[76:79], v[140:143], v[92:95]
    s_waitcnt vmcnt(6)
    s_barrier
    s_waitcnt vmcnt(2)
    v_xor_b32 v26, s0, v29
    v_xor_b32 v27, s1, v31
    v_or_b32 v26, v26, v27
    v_cmp_ne_u32_e64 vcc, 0, v26
    s_cbranch_vccz L_ok23
    s_mov_b32 s3, 0
L_poll22:
    buffer_load_dwordx4 v[28:31], v9, s[8:11], s72 offen sc1
    s_waitcnt vmcnt(0)
    v_xor_b32 v26, s0, v29
    v_xor_b32 v27, s1, v31
    v_or_b32 v26, v26, v27
    v_cmp_ne_u32 vcc, 0, v26
    s_add_u32 s3, s3, 1
    s_cmp_gt_u32 s3, 1000000
    s_cbranch_scc1 L_ok23
    s_cbranch_vccnz L_poll22
L_ok23:
    v_lshlrev_b32_e64 v12, 16, v28
    v_lshlrev_b32 v13, 16, v30
    v_xor_b32 v12, 0x80000000, v12
    v_xor_b32 v13, 0x80000000, v13
    s_waitcnt lgkmcnt(5)
    v_mfma_f32_16x16x32_bf16 v[96:99], a[48:51], v[144:147], 0
    ds_read_b128 a[76:79], v4 offset:23552
    buffer_load_dwordx4 v4, s[8:11], s61 offen offset:1024 sc1 lds
    s_waitcnt lgkmcnt(3)
    v_fmac_f32 v32, v16, v12
    v_fmac_f32_e64 v33, v17, v12
    v_mfma_f32_16x16x32_bf16 v[100:103], a[48:51], v[148:151], 0
    v_fmac_f32 v34, v18, v12
    v_fmac_f32 v35, v19, v12
    v_fmac_f32 v40, v20, v12
    v_fmac_f32 v41, v21, v12
    v_fmac_f32 v42, v22, v12
    v_fmac_f32 v43, v23, v12
    v_mfma_f32_16x16x32_bf16 v[104:107], a[52:55], v[144:147], 0
    ds_read_b128 a[48:51], v4 offset:24576
    v_max_f32 v32, 0, v32
    v_max_f32 v33, 0, v33
    v_mfma_f32_16x16x32_bf16 v[108:111], a[52:55], v[148:151], 0
    v_max_f32 v34, 0, v34
    v_max_f32 v35, 0, v35
    v_mul_f32_e64 v32, v32, v40
    v_mfma_f32_16x16x32_bf16 v[112:115], a[56:59], v[144:147], 0
    ds_read_b128 a[52:55], v4 offset:25600
    buffer_load_dwordx4 v4, s[8:11], s61 offen offset:2048 sc1 lds
    v_mfma_f32_16x16x32_bf16 v[116:119], a[56:59], v[148:151], 0
    v_mul_f32 v33, v33, v41
    v_mul_f32 v34, v34, v42
    v_mul_f32 v35, v35, v43
    v_mfma_f32_16x16x32_bf16 v[120:123], a[60:63], v[144:147], 0
    ds_read_b128 a[56:59], v4 offset:26624
    v_cvt_pk_bf16_f32 v40, v32, v33
    v_mfma_f32_16x16x32_bf16 v[124:127], a[60:63], v[148:151], 0
    s_waitcnt lgkmcnt(3)
    v_mfma_f32_16x16x32_bf16 v[96:99], a[64:67], v[152:155], v[96:99]
    ds_read_b128 a[60:63], v4 offset:27648
    buffer_load_dwordx4 v4, s[8:11], s61 offen offset:3072 sc1 lds
    s_add_u32 m0, s62, 114688
    s_add_u32 s61, s61, 16384
    v_cvt_pk_bf16_f32 v41, v34, v35
    v_mfma_f32_16x16x32_bf16 v[100:103], a[64:67], v[156:159], v[100:103]
    v_fmac_f32 v36, v16, v13
    v_fmac_f32 v37, v17, v13
    v_fmac_f32 v38, v18, v13
    v_fmac_f32 v39, v19, v13
    v_fmac_f32 v44, v20, v13
    v_fmac_f32 v45, v21, v13
    v_mfma_f32_16x16x32_bf16 v[104:107], a[68:71], v[152:155], v[104:107]
    ds_read_b128 a[64:67], v4 offset:28672
    v_fmac_f32 v46, v22, v13
    v_fmac_f32 v47, v23, v13
    v_mfma_f32_16x16x32_bf16 v[108:111], a[68:71], v[156:159], v[108:111]
    ds_read_b128 v[16:19], v8 offset:64
    ds_read_b128 v[20:23], v8 offset:512
    v_max_f32 v36, 0, v36
    v_max_f32 v37, 0, v37
    v_mfma_f32_16x16x32_bf16 v[112:115], a[72:75], v[152:155], v[112:115]
    ds_read_b128 a[68:71], v4 offset:29696
    buffer_load_dwordx4 v4, s[8:11], s61 offen offset:0 sc1 lds
    v_mfma_f32_16x16x32_bf16 v[116:119], a[72:75], v[156:159], v[116:119]
    v_max_f32 v38, 0, v38
    v_max_f32 v39, 0, v39
    v_mul_f32_e64 v36, v36, v44
    v_mfma_f32_16x16x32_bf16 v[120:123], a[76:79], v[152:155], v[120:123]
    ds_read_b128 a[72:75], v4 offset:30720
    v_mul_f32_e64 v37, v37, v45
    v_mfma_f32_16x16x32_bf16 v[124:127], a[76:79], v[156:159], v[124:127]
    v_mul_f32 v38, v38, v46
    s_waitcnt lgkmcnt(5)
    v_mfma_f32_16x16x32_bf16 v[96:99], a[48:51], v[160:163], v[96:99]
    ds_read_b128 a[76:79], v4 offset:31744
    buffer_load_dwordx4 v4, s[8:11], s61 offen offset:1024 sc1 lds
    v_mul_f32_e64 v39, v39, v47
    v_cvt_pk_bf16_f32 v44, v36, v37
    v_cvt_pk_bf16_f32 v45, v38, v39
    v_mfma_f32_16x16x32_bf16 v[100:103], a[48:51], v[164:167], v[100:103]
    s_waitcnt lgkmcnt(3)
    v_fmac_f32 v48, v16, v12
    v_fmac_f32 v49, v17, v12
    v_fmac_f32 v50, v18, v12
    v_fmac_f32 v51, v19, v12
    v_fmac_f32 v56, v20, v12
    v_mfma_f32_16x16x32_bf16 v[104:107], a[52:55], v[160:163], v[104:107]
    ds_read_b128 a[48:51], v4 offset:32768
    v_fmac_f32 v57, v21, v12
    v_fmac_f32 v58, v22, v12
    v_mfma_f32_16x16x32_bf16 v[108:111], a[52:55], v[164:167], v[108:111]
    v_fmac_f32 v59, v23, v12
    v_max_f32 v48, 0, v48
    v_max_f32_e64 v49, 0, v49
    v_mfma_f32_16x16x32_bf16 v[112:115], a[56:59], v[160:163], v[112:115]
    ds_read_b128 a[52:55], v4 offset:33792
    v_max_f32_e64 v50, 0, v50
    v_mfma_f32_16x16x32_bf16 v[116:119], a[56:59], v[164:167], v[116:119]
    buffer_load_dwordx4 v4, s[8:11], s61 offen offset:2048 sc1 lds
    v_mfma_f32_16x16x32_bf16 v[120:123], a[60:63], v[160:163], v[120:123]
    ds_read_b128 a[56:59], v4 offset:34816
    v_max_f32_e64 v51, 0, v51
    v_mfma_f32_16x16x32_bf16 v[124:127], a[60:63], v[164:167], v[124:127]
    v_mul_f32 v48, v48, v56
    s_waitcnt lgkmcnt(3)
    v_mfma_f32_16x16x32_bf16 v[96:99], a[64:67], v[168:171], v[96:99]
    ds_read_b128 a[60:63], v4 offset:35840
    buffer_load_dwordx4 v4, s[8:11], s61 offen offset:3072 sc1 lds
    s_add_u32 m0, s62, 131072
    s_addk_i32 s61, 16384
    v_mul_f32 v49, v49, v57
    v_mul_f32_e64 v50, v50, v58
    v_mfma_f32_16x16x32_bf16 v[100:103], a[64:67], v[172:175], v[100:103]
    v_mul_f32_e64 v51, v51, v59
    v_cvt_pk_bf16_f32 v42, v48, v49
    v_cvt_pk_bf16_f32 v43, v50, v51
    buffer_store_dwordx4 v[40:43], v4, s[8:11], s68 offen sc1
    v_fmac_f32 v52, v16, v13
    v_fmac_f32 v53, v17, v13
    v_mfma_f32_16x16x32_bf16 v[104:107], a[68:71], v[168:171], v[104:107]
    ds_read_b128 a[64:67], v4 offset:36864
    v_fmac_f32 v54, v18, v13
    v_fmac_f32 v55, v19, v13
    v_mfma_f32_16x16x32_bf16 v[108:111], a[68:71], v[172:175], v[108:111]
    v_fmac_f32 v60, v20, v13
    v_fmac_f32 v61, v21, v13
    v_fmac_f32_e64 v62, v22, v13
    v_mfma_f32_16x16x32_bf16 v[112:115], a[72:75], v[168:171], v[112:115]
    ds_read_b128 a[68:71], v4 offset:37888
    buffer_load_dwordx4 v4, s[8:11], s61 offen offset:0 sc1 lds
    v_mfma_f32_16x16x32_bf16 v[116:119], a[72:75], v[172:175], v[116:119]
    v_fmac_f32_e64 v63, v23, v13
    ds_read_b128 v[16:19], v8 offset:128
    ds_read_b128 v[20:23], v8 offset:576
    v_max_f32_e64 v52, 0, v52
    v_mfma_f32_16x16x32_bf16 v[120:123], a[76:79], v[168:171], v[120:123]
    ds_read_b128 a[72:75], v4 offset:38912
    v_max_f32_e64 v53, 0, v53
    v_mfma_f32_16x16x32_bf16 v[124:127], a[76:79], v[172:175], v[124:127]
    v_max_f32 v54, 0, v54
    s_waitcnt lgkmcnt(5)
    v_mfma_f32_16x16x32_bf16 v[96:99], a[48:51], v[176:179], v[96:99]
    ds_read_b128 a[76:79], v4 offset:39936
    buffer_load_dwordx4 v4, s[8:11], s61 offen offset:1024 sc1 lds
    v_max_f32 v55, 0, v55
    v_mul_f32 v52, v52, v60
    v_mul_f32_e64 v53, v53, v61
    v_mfma_f32_16x16x32_bf16 v[100:103], a[48:51], v[180:183], v[100:103]
    v_mul_f32 v54, v54, v62
    v_mul_f32 v55, v55, v63
    v_cvt_pk_bf16_f32 v46, v52, v53
    v_cvt_pk_bf16_f32 v47, v54, v55
    buffer_store_dwordx4 v[44:47], v24, s[8:11], s68 offen sc1
    v_mfma_f32_16x16x32_bf16 v[104:107], a[52:55], v[176:179], v[104:107]
    ds_read_b128 a[48:51], v4 offset:40960
    s_waitcnt lgkmcnt(3)
    v_fmac_f32 v64, v16, v12
    v_mfma_f32_16x16x32_bf16 v[108:111], a[52:55], v[180:183], v[108:111]
    v_fmac_f32 v65, v17, v12
    v_fmac_f32 v66, v18, v12
    v_fmac_f32_e64 v67, v19, v12
    v_mfma_f32_16x16x32_bf16 v[112:115], a[56:59], v[176:179], v[112:115]
    ds_read_b128 a[52:55], v4 offset:41984
    buffer_load_dwordx4 v4, s[8:11], s61 offen offset:2048 sc1 lds
    v_mfma_f32_16x16x32_bf16 v[116:119], a[56:59], v[180:183], v[116:119]
    v_fmac_f32 v72, v20, v12
    v_fmac_f32 v73, v21, v12
    v_fmac_f32_e64 v74, v22, v12
    v_mfma_f32_16x16x32_bf16 v[120:123], a[60:63], v[176:179], v[120:123]
    ds_read_b128 a[56:59], v4 offset:43008
    v_fmac_f32 v75, v23, v12
    v_mfma_f32_16x16x32_bf16 v[124:127], a[60:63], v[180:183], v[124:127]
    s_waitcnt lgkmcnt(3)
    v_mfma_f32_16x16x32_bf16 v[96:99], a[64:67], v[184:187], v[96:99]
    ds_read_b128 a[60:63], v4 offset:44032
    buffer_load_dwordx4 v4, s[8:11], s61 offen offset:3072 sc1 lds
    s_add_u32 m0, s62, 0
    s_addk_i32 s63, 4096
    v_max_f32 v64, 0, v64
    v_max_f32 v65, 0, v65
    v_mfma_f32_16x16x32_bf16 v[100:103], a[64:67], v[188:191], v[100:103]
    v_max_f32 v66, 0, v66
    v_max_f32 v67, 0, v67
    v_mul_f32 v64, v64, v72
    v_mul_f32 v65, v65, v73
    v_mul_f32 v66, v66, v74
    v_mul_f32 v67, v67, v75
    v_mfma_f32_16x16x32_bf16 v[104:107], a[68:71], v[184:187], v[104:107]
    ds_read_b128 a[64:67], v4 offset:45056
    v_cvt_pk_bf16_f32 v72, v64, v65
    v_cvt_pk_bf16_f32 v73, v66, v67
    v_mfma_f32_16x16x32_bf16 v[108:111], a[68:71], v[188:191], v[108:111]
    v_fmac_f32 v68, v16, v13
    v_fmac_f32 v69, v17, v13
    v_fmac_f32_e64 v70, v18, v13
    v_mfma_f32_16x16x32_bf16 v[112:115], a[72:75], v[184:187], v[112:115]
    ds_read_b128 a[68:71], v4 offset:46080
    buffer_load_dwordx4 v4, s[8:11], s63 offen offset:0 sc1 lds
    v_mfma_f32_16x16x32_bf16 v[116:119], a[72:75], v[188:191], v[116:119]
    v_fmac_f32 v71, v19, v13
    v_fmac_f32 v76, v20, v13
    v_fmac_f32_e64 v77, v21, v13
    v_mfma_f32_16x16x32_bf16 v[120:123], a[76:79], v[184:187], v[120:123]
    ds_read_b128 a[72:75], v4 offset:47104
    v_fmac_f32 v78, v22, v13
    v_mfma_f32_16x16x32_bf16 v[124:127], a[76:79], v[188:191], v[124:127]
    s_waitcnt lgkmcnt(3)
    v_mfma_f32_16x16x32_bf16 v[96:99], a[48:51], v[192:195], v[96:99]
    ds_read_b128 a[76:79], v4 offset:48128
    buffer_load_dwordx4 v4, s[8:11], s63 offen offset:1024 sc1 lds
    v_fmac_f32_e64 v79, v23, v13
    ds_read_b128 v[16:19], v8 offset:192
    ds_read_b128 v[20:23], v8 offset:640
    v_max_f32_e64 v68, 0, v68
    v_mfma_f32_16x16x32_bf16 v[100:103], a[48:51], v[196:199], v[100:103]
    v_max_f32 v69, 0, v69
    v_max_f32 v70, 0, v70
    v_max_f32 v71, 0, v71
    v_mul_f32 v68, v68, v76
    v_mul_f32 v69, v69, v77
    v_mul_f32 v70, v70, v78
    v_mfma_f32_16x16x32_bf16 v[104:107], a[52:55], v[192:195], v[104:107]
    ds_read_b128 a[48:51], v4 offset:49152
    v_mul_f32_e64 v71, v71, v79
    v_cvt_pk_bf16_f32 v76, v68, v69
    v_mfma_f32_16x16x32_bf16 v[108:111], a[52:55], v[196:199], v[108:111]
    v_cvt_pk_bf16_f32 v77, v70, v71
    s_waitcnt lgkmcnt(1)
    v_fmac_f32 v80, v16, v12
    v_mfma_f32_16x16x32_bf16 v[112:115], a[56:59], v[192:195], v[112:115]
    ds_read_b128 a[52:55], v4 offset:50176
    v_fmac_f32_e64 v81, v17, v12
    v_mfma_f32_16x16x32_bf16 v[116:119], a[56:59], v[196:199], v[116:119]
    v_fmac_f32 v82, v18, v12
    v_fmac_f32 v83, v19, v12
    v_mfma_f32_16x16x32_bf16 v[120:123], a[60:63], v[192:195], v[120:123]
    ds_read_b128 a[56:59], v4 offset:51200
    v_fmac_f32_e64 v88, v20, v12
    v_mfma_f32_16x16x32_bf16 v[124:127], a[60:63], v[196:199], v[124:127]
    v_mfma_f32_16x16x32_bf16 v[96:99], a[64:67], v[200:203], v[96:99]
    ds_read_b128 a[60:63], v4 offset:52224
    buffer_load_dwordx4 v4, s[8:11], s63 offen offset:2048 sc1 lds
    v_fmac_f32 v89, v21, v12
    v_fmac_f32 v90, v22, v12
    v_fmac_f32_e64 v91, v23, v12
    v_mfma_f32_16x16x32_bf16 v[100:103], a[64:67], v[204:207], v[100:103]
    v_max_f32 v80, 0, v80
    v_max_f32 v81, 0, v81
    v_max_f32 v82, 0, v82
    v_max_f32 v83, 0, v83
    v_mul_f32 v80, v80, v88
    v_mul_f32 v81, v81, v89
    v_mfma_f32_16x16x32_bf16 v[104:107], a[68:71], v[200:203], v[104:107]
    ds_read_b128 a[64:67], v4 offset:53248
    v_mul_f32 v82, v82, v90
    v_mul_f32 v83, v83, v91
    v_mfma_f32_16x16x32_bf16 v[108:111], a[68:71], v[204:207], v[108:111]
    v_cvt_pk_bf16_f32 v74, v80, v81
    v_cvt_pk_bf16_f32 v75, v82, v83
    v_mfma_f32_16x16x32_bf16 v[112:115], a[72:75], v[200:203], v[112:115]
    ds_read_b128 a[68:71], v4 offset:54272
    v_mfma_f32_16x16x32_bf16 v[116:119], a[72:75], v[204:207], v[116:119]
    buffer_store_dwordx4 v[72:75], v4, s[8:11], s69 offen sc1
    v_mfma_f32_16x16x32_bf16 v[120:123], a[76:79], v[200:203], v[120:123]
    ds_read_b128 a[72:75], v4 offset:55296
    v_fmac_f32 v84, v16, v13
    v_fmac_f32 v85, v17, v13
    v_mfma_f32_16x16x32_bf16 v[124:127], a[76:79], v[204:207], v[124:127]
    v_fmac_f32 v86, v18, v13
    s_waitcnt lgkmcnt(3)
    v_mfma_f32_16x16x32_bf16 v[96:99], a[48:51], v[208:211], v[96:99]
    ds_read_b128 a[76:79], v4 offset:56320
    buffer_load_dwordx4 v4, s[8:11], s63 offen offset:3072 sc1 lds
    v_fmac_f32 v87, v19, v13
    v_fmac_f32 v92, v20, v13
    v_fmac_f32_e64 v93, v21, v13
    v_mfma_f32_16x16x32_bf16 v[100:103], a[48:51], v[212:215], v[100:103]
    v_fmac_f32 v94, v22, v13
    v_fmac_f32 v95, v23, v13
    v_max_f32 v84, 0, v84
    v_max_f32 v85, 0, v85
    v_max_f32 v86, 0, v86
    v_max_f32 v87, 0, v87
    v_mfma_f32_16x16x32_bf16 v[104:107], a[52:55], v[208:211], v[104:107]
    ds_read_b128 a[48:51], v4 offset:57344
    v_mul_f32_e64 v84, v84, v92
    v_mfma_f32_16x16x32_bf16 v[108:111], a[52:55], v[212:215], v[108:111]
    v_mul_f32 v85, v85, v93
    v_mul_f32 v86, v86, v94
    v_mfma_f32_16x16x32_bf16 v[112:115], a[56:59], v[208:211], v[112:115]
    ds_read_b128 a[52:55], v4 offset:58368
    v_mul_f32_e64 v87, v87, v95
    v_mfma_f32_16x16x32_bf16 v[116:119], a[56:59], v[212:215], v[116:119]
    v_cvt_pk_bf16_f32 v78, v84, v85
    v_cvt_pk_bf16_f32 v79, v86, v87
    v_mfma_f32_16x16x32_bf16 v[120:123], a[60:63], v[208:211], v[120:123]
    ds_read_b128 a[56:59], v4 offset:59392
    v_mfma_f32_16x16x32_bf16 v[124:127], a[60:63], v[212:215], v[124:127]
    buffer_store_dwordx4 v[76:79], v24, s[8:11], s69 offen sc1
    s_waitcnt lgkmcnt(3)
    v_mfma_f32_16x16x32_bf16 v[96:99], a[64:67], v[216:219], v[96:99]
    ds_read_b128 a[60:63], v4 offset:60416
    s_add_u32 m0, s62, 147456
    s_addk_i32 s63, 4096
    v_mfma_f32_16x16x32_bf16 v[100:103], a[64:67], v[220:223], v[100:103]
    buffer_load_dwordx4 v4, s[8:11], s63 offen offset:0 sc1 lds
    v_mfma_f32_16x16x32_bf16 v[104:107], a[68:71], v[216:219], v[104:107]
    ds_read_b128 a[64:67], v4 offset:61440
    s_mul_i32 s50, s54, 1024
    v_mfma_f32_16x16x32_bf16 v[108:111], a[68:71], v[220:223], v[108:111]
    s_cmp_eq_u32 s48, 3
    s_cselect_b32 s59, 7168, -1
    s_cselect_b32 s73, 3072, -1
    v_mfma_f32_16x16x32_bf16 v[112:115], a[72:75], v[216:219], v[112:115]
    ds_read_b128 a[68:71], v4 offset:62464
    v_and_b32 v2, 15, v1
    v_mfma_f32_16x16x32_bf16 v[116:119], a[72:75], v[220:223], v[116:119]
    v_lshrrev_b32_e64 v3, 4, v1
    v_lshlrev_b32 v14, 4, v2
    v_mfma_f32_16x16x32_bf16 v[120:123], a[76:79], v[216:219], v[120:123]
    ds_read_b128 a[72:75], v4 offset:63488
    v_lshl_add_u32 v14, v3, 8, v14
    v_mfma_f32_16x16x32_bf16 v[124:127], a[76:79], v[220:223], v[124:127]
    s_waitcnt lgkmcnt(3)
    v_mfma_f32_16x16x32_bf16 v[96:99], a[48:51], v[224:227], v[96:99]
    ds_read_b128 a[76:79], v4 offset:64512
    s_lshr_b32 s56, s48, 1
    v_mfma_f32_16x16x32_bf16 v[100:103], a[48:51], v[228:231], v[100:103]
    buffer_load_dwordx4 v4, s[8:11], s63 offen offset:1024 sc1 lds
    v_mfma_f32_16x16x32_bf16 v[104:107], a[52:55], v[224:227], v[104:107]
    ds_read_b128 a[48:51], v5 offset:0
    s_lshl_b32 s57, s53, 1
    v_mfma_f32_16x16x32_bf16 v[108:111], a[52:55], v[228:231], v[108:111]
    s_add_u32 s56, s56, s57
    s_and_b32 s57, s48, 1
    v_mfma_f32_16x16x32_bf16 v[112:115], a[56:59], v[224:227], v[112:115]
    ds_read_b128 a[52:55], v5 offset:1024
    s_mul_i32 s58, s56, 40960
    v_mfma_f32_16x16x32_bf16 v[116:119], a[56:59], v[228:231], v[116:119]
    s_mul_i32 s3, s54, 5120
    v_mfma_f32_16x16x32_bf16 v[120:123], a[60:63], v[224:227], v[120:123]
    ds_read_b128 a[56:59], v5 offset:2048
    v_mfma_f32_16x16x32_bf16 v[124:127], a[60:63], v[228:231], v[124:127]
    s_waitcnt lgkmcnt(3)
    v_mfma_f32_16x16x32_bf16 v[96:99], a[64:67], v[232:235], v[96:99]
    ds_read_b128 a[60:63], v5 offset:3072
    s_add_u32 s58, s58, s3
    v_mfma_f32_16x16x32_bf16 v[100:103], a[64:67], v[236:239], v[100:103]
    buffer_load_dwordx4 v4, s[8:11], s63 offen offset:2048 sc1 lds
    v_mfma_f32_16x16x32_bf16 v[104:107], a[68:71], v[232:235], v[104:107]
    ds_read_b128 a[64:67], v5 offset:4096
    s_lshl_b32 s3, s57, 3
    v_mfma_f32_16x16x32_bf16 v[108:111], a[68:71], v[236:239], v[108:111]
    s_add_u32 s58, s58, s3
    s_add_u32 s74, s58, 3145728
    v_mfma_f32_16x16x32_bf16 v[112:115], a[72:75], v[232:235], v[112:115]
    ds_read_b128 a[68:71], v5 offset:5120
    s_add_u32 s75, s74, 4096
    v_mfma_f32_16x16x32_bf16 v[116:119], a[72:75], v[236:239], v[116:119]
    s_lshl_b32 s56, s56, 5
    v_mfma_f32_16x16x32_bf16 v[120:123], a[76:79], v[232:235], v[120:123]
    ds_read_b128 a[72:75], v5 offset:6144
    v_mfma_f32_16x16x32_bf16 v[124:127], a[76:79], v[236:239], v[124:127]
    s_waitcnt lgkmcnt(3)
    v_mfma_f32_16x16x32_bf16 v[96:99], a[48:51], v[240:243], v[96:99]
    ds_read_b128 a[76:79], v5 offset:7168
    s_add_u32 s56, s56, s57
    v_mfma_f32_16x16x32_bf16 v[100:103], a[48:51], v[244:247], v[100:103]
    s_lshl_b32 s76, s56, 3
    s_add_u32 s76, s76, 16384
    v_mfma_f32_16x16x32_bf16 v[104:107], a[52:55], v[240:243], v[104:107]
    ds_read_b128 a[48:51], v5 offset:8192
    s_mul_i32 s77, s56, 1280
    v_mfma_f32_16x16x32_bf16 v[108:111], a[52:55], v[244:247], v[108:111]
    s_mul_i32 s3, s54, 160
    s_add_u32 s77, s77, s3
    v_mfma_f32_16x16x32_bf16 v[112:115], a[56:59], v[240:243], v[112:115]
    ds_read_b128 a[52:55], v5 offset:9216
    v_mfma_f32_16x16x32_bf16 v[116:119], a[56:59], v[244:247], v[116:119]
    v_mfma_f32_16x16x32_bf16 v[120:123], a[60:63], v[240:243], v[120:123]
    ds_read_b128 a[56:59], v5 offset:10240
    v_mfma_f32_16x16x32_bf16 v[124:127], a[60:63], v[244:247], v[124:127]
    s_waitcnt lgkmcnt(3)
    v_mfma_f32_16x16x32_bf16 v[96:99], a[64:67], v[248:251], v[96:99]
    ds_read_b128 a[60:63], v5 offset:11264
    v_mul_u32_u24 v15, 2560, v2
    v_mfma_f32_16x16x32_bf16 v[100:103], a[64:67], v[252:255], v[100:103]
    v_lshl_add_u32 v15, v3, 3, v15
    v_mfma_f32_16x16x32_bf16 v[104:107], a[68:71], v[248:251], v[104:107]
    ds_read_b128 a[64:67], v5 offset:12288
    v_mfma_f32_16x16x32_bf16 v[108:111], a[68:71], v[252:255], v[108:111]
    v_mfma_f32_16x16x32_bf16 v[112:115], a[72:75], v[248:251], v[112:115]
    ds_read_b128 a[68:71], v5 offset:13312
    v_mfma_f32_16x16x32_bf16 v[116:119], a[72:75], v[252:255], v[116:119]
    v_mfma_f32_16x16x32_bf16 v[120:123], a[76:79], v[248:251], v[120:123]
    ds_read_b128 a[72:75], v5 offset:14336
    v_mfma_f32_16x16x32_bf16 v[124:127], a[76:79], v[252:255], v[124:127]
    s_waitcnt vmcnt(3)
    s_barrier
    s_lshl_b32 s16, s51, 4
    s_add_u32 s16, s16, s52
    s_lshl_b32 s16, s16, 7
    s_add_u32 s16, s16, 22216704
    s_lshl_b32 s55, s48, 30
    v_lshl_add_u32 v26, v1, 3, s55
    v_mov_b32 v28, s0
    v_mov_b32 v29, s1
    s_mov_b64 exec, 0xffff
    buffer_store_dwordx2 v[28:29], v26, s[8:11], s16 offen sc1
    s_mov_b64 exec, -1
    s_waitcnt lgkmcnt(3)
    v_mfma_f32_16x16x32_bf16 v[96:99], a[48:51], a[0:3], v[96:99]
    ds_read_b128 a[76:79], v5 offset:15360
    s_add_u32 m0, s62, 13312
    v_mfma_f32_16x16x32_bf16 v[100:103], a[48:51], a[4:7], v[100:103]
    buffer_load_dwordx4 v4, s[8:11], s63 offen offset:3072 sc1 lds
    v_mfma_f32_16x16x32_bf16 v[104:107], a[52:55], a[0:3], v[104:107]
    ds_read_b128 a[48:51], v5 offset:16384
    s_add_u32 m0, s62, 17408
    s_addk_i32 s63, 4096
    v_mfma_f32_16x16x32_bf16 v[108:111], a[52:55], a[4:7], v[108:111]
    v_mfma_f32_16x16x32_bf16 v[112:115], a[56:59], a[0:3], v[112:115]
    ds_read_b128 a[52:55], v5 offset:17408
    v_mfma_f32_16x16x32_bf16 v[116:119], a[56:59], a[4:7], v[116:119]
    buffer_load_dwordx4 v4, s[8:11], s63 offen offset:0 sc1 lds
    v_mfma_f32_16x16x32_bf16 v[120:123], a[60:63], a[0:3], v[120:123]
    ds_read_b128 a[56:59], v5 offset:18432
    v_mfma_f32_16x16x32_bf16 v[124:127], a[60:63], a[4:7], v[124:127]
    s_waitcnt lgkmcnt(3)
    v_mfma_f32_16x16x32_bf16 v[96:99], a[64:67], a[8:11], v[96:99]
    ds_read_b128 a[60:63], v5 offset:19456
    v_mfma_f32_16x16x32_bf16 v[100:103], a[64:67], a[12:15], v[100:103]
    buffer_load_dwordx4 v4, s[8:11], s63 offen offset:1024 sc1 lds
    v_mfma_f32_16x16x32_bf16 v[104:107], a[68:71], a[8:11], v[104:107]
    ds_read_b128 a[64:67], v5 offset:20480
    v_mfma_f32_16x16x32_bf16 v[108:111], a[68:71], a[12:15], v[108:111]
    v_mfma_f32_16x16x32_bf16 v[112:115], a[72:75], a[8:11], v[112:115]
    ds_read_b128 a[68:71], v5 offset:21504
    v_mfma_f32_16x16x32_bf16 v[116:119], a[72:75], a[12:15], v[116:119]
    v_mfma_f32_16x16x32_bf16 v[120:123], a[76:79], a[8:11], v[120:123]
    ds_read_b128 a[72:75], v5 offset:22528
    v_mfma_f32_16x16x32_bf16 v[124:127], a[76:79], a[12:15], v[124:127]
    s_waitcnt lgkmcnt(3)
    v_mfma_f32_16x16x32_bf16 v[96:99], a[48:51], a[16:19], v[96:99]
    ds_read_b128 a[76:79], v5 offset:23552
    v_mfma_f32_16x16x32_bf16 v[100:103], a[48:51], a[20:23], v[100:103]
    buffer_load_dwordx4 v4, s[8:11], s63 offen offset:2048 sc1 lds
    v_mfma_f32_16x16x32_bf16 v[104:107], a[52:55], a[16:19], v[104:107]
    ds_read_b128 a[48:51], v5 offset:24576
    v_mfma_f32_16x16x32_bf16 v[108:111], a[52:55], a[20:23], v[108:111]
    v_mfma_f32_16x16x32_bf16 v[112:115], a[56:59], a[16:19], v[112:115]
    ds_read_b128 a[52:55], v5 offset:25600
    v_mfma_f32_16x16x32_bf16 v[116:119], a[56:59], a[20:23], v[116:119]
    v_mfma_f32_16x16x32_bf16 v[120:123], a[60:63], a[16:19], v[120:123]
    ds_read_b128 a[56:59], v5 offset:26624
    v_mfma_f32_16x16x32_bf16 v[124:127], a[60:63], a[20:23], v[124:127]
    s_waitcnt lgkmcnt(3)
    v_mfma_f32_16x16x32_bf16 v[96:99], a[64:67], a[24:27], v[96:99]
    ds_read_b128 a[60:63], v5 offset:27648
    s_add_u32 m0, s62, 29696
    v_mfma_f32_16x16x32_bf16 v[100:103], a[64:67], a[28:31], v[100:103]
    buffer_load_dwordx4 v4, s[8:11], s63 offen offset:3072 sc1 lds
    v_mfma_f32_16x16x32_bf16 v[104:107], a[68:71], a[24:27], v[104:107]
    ds_read_b128 a[64:67], v5 offset:28672
    v_mfma_f32_16x16x32_bf16 v[108:111], a[68:71], a[28:31], v[108:111]
    v_mfma_f32_16x16x32_bf16 v[112:115], a[72:75], a[24:27], v[112:115]
    ds_read_b128 a[68:71], v5 offset:29696
    v_mfma_f32_16x16x32_bf16 v[116:119], a[72:75], a[28:31], v[116:119]
    v_mfma_f32_16x16x32_bf16 v[120:123], a[76:79], a[24:27], v[120:123]
    ds_read_b128 a[72:75], v5 offset:30720
    v_mfma_f32_16x16x32_bf16 v[124:127], a[76:79], a[28:31], v[124:127]
    s_waitcnt lgkmcnt(3)
    v_mfma_f32_16x16x32_bf16 v[96:99], a[48:51], a[32:35], v[96:99]
    ds_read_b128 a[76:79], v5 offset:31744
    s_add_u32 m0, s62, 33792
    s_addk_i32 s63, 4096
    v_mfma_f32_16x16x32_bf16 v[100:103], a[48:51], a[36:39], v[100:103]
    buffer_load_dwordx4 v4, s[8:11], s63 offen offset:0 sc1 lds
    v_mfma_f32_16x16x32_bf16 v[104:107], a[52:55], a[32:35], v[104:107]
    ds_read_b128 a[48:51], v5 offset:32768
    v_mfma_f32_16x16x32_bf16 v[108:111], a[52:55], a[36:39], v[108:111]
    v_mfma_f32_16x16x32_bf16 v[112:115], a[56:59], a[32:35], v[112:115]
    ds_read_b128 a[52:55], v5 offset:33792
    v_mfma_f32_16x16x32_bf16 v[116:119], a[56:59], a[36:39], v[116:119]
    v_mfma_f32_16x16x32_bf16 v[120:123], a[60:63], a[32:35], v[120:123]
    ds_read_b128 a[56:59], v5 offset:34816
    v_mfma_f32_16x16x32_bf16 v[124:127], a[60:63], a[36:39], v[124:127]
    s_waitcnt lgkmcnt(3)
    v_mfma_f32_16x16x32_bf16 v[96:99], a[64:67], a[40:43], v[96:99]
    ds_read_b128 a[60:63], v5 offset:35840
    v_mfma_f32_16x16x32_bf16 v[100:103], a[64:67], a[44:47], v[100:103]
    buffer_load_dwordx4 v4, s[8:11], s63 offen offset:1024 sc1 lds
    v_mfma_f32_16x16x32_bf16 v[104:107], a[68:71], a[40:43], v[104:107]
    ds_read_b128 a[64:67], v5 offset:36864
    v_mfma_f32_16x16x32_bf16 v[108:111], a[68:71], a[44:47], v[108:111]
    ds_read_b128 v[16:19], v8 offset:256
    ds_read_b128 v[20:23], v8 offset:704
    v_mfma_f32_16x16x32_bf16 v[112:115], a[72:75], a[40:43], v[112:115]
    ds_read_b128 a[68:71], v5 offset:37888
    v_mfma_f32_16x16x32_bf16 v[116:119], a[72:75], a[44:47], v[116:119]
    v_mfma_f32_16x16x32_bf16 v[120:123], a[76:79], a[40:43], v[120:123]
    ds_read_b128 a[72:75], v5 offset:38912
    v_mfma_f32_16x16x32_bf16 v[124:127], a[76:79], a[44:47], v[124:127]
    s_waitcnt lgkmcnt(5)
    v_mfma_f32_16x16x32_bf16 v[128:131], a[48:51], v[144:147], 0
    ds_read_b128 a[76:79], v5 offset:39936
    buffer_load_dwordx4 v4, s[8:11], s63 offen offset:2048 sc1 lds
    s_waitcnt lgkmcnt(3)
    v_fmac_f32 v96, v16, v12
    v_fmac_f32_e64 v97, v17, v12
    v_mfma_f32_16x16x32_bf16 v[132:135], a[48:51], v[148:151], 0
    v_fmac_f32 v98, v18, v12
    v_fmac_f32 v99, v19, v12
    v_fmac_f32 v104, v20, v12
    v_fmac_f32 v105, v21, v12
    v_fmac_f32_e64 v106, v22, v12
    v_mfma_f32_16x16x32_bf16 v[136:139], a[52:55], v[144:147], 0
    ds_read_b128 a[48:51], v5 offset:40960
    v_mfma_f32_16x16x32_bf16 v[140:143], a[52:55], v[148:151], 0
    v_mfma_f32_16x16x32_bf16 v[128:131], a[56:59], v[152:155], v[128:131]
    ds_read_b128 a[52:55], v5 offset:41984
    s_add_u32 m0, s62, 46080
    v_fmac_f32_e64 v107, v23, v12
    v_mfma_f32_16x16x32_bf16 v[132:135], a[56:59], v[156:159], v[132:135]
    buffer_load_dwordx4 v4, s[8:11], s63 offen offset:3072 sc1 lds
    v_max_f32_e64 v96, 0, v96
    v_mfma_f32_16x16x32_bf16 v[136:139], a[60:63], v[152:155], v[136:139]
    ds_read_b128 a[56:59], v5 offset:43008
    v_max_f32 v97, 0, v97
    v_max_f32 v98, 0, v98
    v_mfma_f32_16x16x32_bf16 v[140:143], a[60:63], v[156:159], v[140:143]
    v_max_f32 v99, 0, v99
    v_mul_f32 v96, v96, v104
    v_mul_f32 v97, v97, v105
    s_waitcnt lgkmcnt(3)
    v_mfma_f32_16x16x32_bf16 v[128:131], a[64:67], v[160:163], v[128:131]
    ds_read_b128 a[60:63], v5 offset:44032
    s_add_u32 m0, s62, 50176
    s_add_u32 s63, s63, 4096
    buffer_load_dwordx4 v4, s[8:11], s63 offen offset:0 sc1 lds
    buffer_load_dwordx2 a[240:241], v14, s[8:11], s74 offen offset:0 sc1
    s_lshr_b32 s55, s53, 1
    s_lshl_b32 s55, s55, 11
    s_add_u32 s55, s55, 22216704
    v_min_u32 v26, 15, v1
    v_lshlrev_b32 v26, 7, v26
    buffer_load_dwordx2 v[28:29], v26, s[8:11], s55 offen sc1
    v_mfma_f32_16x16x32_bf16 v[132:135], a[64:67], v[164:167], v[132:135]
    buffer_load_dwordx2 a[242:243], v14, s[8:11], s74 offen offset:1024 sc1
    v_mul_f32 v98, v98, v106
    v_mul_f32 v99, v99, v107
    v_cvt_pk_bf16_f32 v104, v96, v97
    v_cvt_pk_bf16_f32 v105, v98, v99
    v_fmac_f32 v100, v16, v13
    v_fmac_f32 v101, v17, v13
    v_fmac_f32_e64 v102, v18, v13
    v_mfma_f32_16x16x32_bf16 v[136:139], a[68:71], v[160:163], v[136:139]
    ds_read_b128 a[64:67], v5 offset:45056
    buffer_load_dwordx2 a[244:245], v14, s[8:11], s74 offen offset:2048 sc1
    buffer_load_dwordx2 a[246:247], v14, s[8:11], s74 offen offset:3072 sc1
    v_mfma_f32_16x16x32_bf16 v[140:143], a[68:71], v[164:167], v[140:143]
    buffer_load_dwordx2 a[248:249], v14, s[8:11], s75 offen offset:0 sc1
    v_mfma_f32_16x16x32_bf16 v[128:131], a[72:75], v[168:171], v[128:131]
    ds_read_b128 a[68:71], v5 offset:46080
    buffer_load_dwordx4 v4, s[8:11], s63 offen offset:1024 sc1 lds
    v_mfma_f32_16x16x32_bf16 v[132:135], a[72:75], v[172:175], v[132:135]
    v_fmac_f32 v103, v19, v13
    v_fmac_f32 v108, v20, v13
    v_fmac_f32_e64 v109, v21, v13
    v_mfma_f32_16x16x32_bf16 v[136:139], a[76:79], v[168:171], v[136:139]
    ds_read_b128 a[72:75], v5 offset:47104
    v_fmac_f32 v110, v22, v13
    v_fmac_f32 v111, v23, v13
    v_mfma_f32_16x16x32_bf16 v[140:143], a[76:79], v[172:175], v[140:143]
    ds_read_b128 v[16:19], v8 offset:320
    ds_read_b128 v[20:23], v8 offset:768
    v_max_f32 v100, 0, v100
    s_waitcnt lgkmcnt(5)
    v_mfma_f32_16x16x32_bf16 v[128:131], a[48:51], v[176:179], v[128:131]
    ds_read_b128 a[76:79], v5 offset:48128
    buffer_load_dwordx4 v4, s[8:11], s63 offen offset:2048 sc1 lds
    v_mfma_f32_16x16x32_bf16 v[132:135], a[48:51], v[180:183], v[132:135]
    v_max_f32 v101, 0, v101
    v_max_f32 v102, 0, v102
    v_max_f32_e64 v103, 0, v103
    v_mfma_f32_16x16x32_bf16 v[136:139], a[52:55], v[176:179], v[136:139]
    ds_read_b128 a[48:51], v5 offset:49152
    v_mul_f32 v100, v100, v108
    v_mul_f32 v101, v101, v109
    v_mfma_f32_16x16x32_bf16 v[140:143], a[52:55], v[180:183], v[140:143]
    v_mul_f32 v102, v102, v110
    v_mul_f32 v103, v103, v111
    v_mfma_f32_16x16x32_bf16 v[128:131], a[56:59], v[184:187], v[128:131]
    ds_read_b128 a[52:55], v5 offset:50176
    v_cvt_pk_bf16_f32 v108, v100, v101
    v_cvt_pk_bf16_f32 v109, v102, v103
    v_mfma_f32_16x16x32_bf16 v[132:135], a[56:59], v[188:191], v[132:135]
    s_waitcnt lgkmcnt(3)
    v_fmac_f32 v112, v16, v12
    v_fmac_f32_e64 v113, v17, v12
    v_mfma_f32_16x16x32_bf16 v[136:139], a[60:63], v[184:187], v[136:139]
    ds_read_b128 a[56:59], v5 offset:51200
    v_fmac_f32_e64 v114, v18, v12
    v_mfma_f32_16x16x32_bf16 v[140:143], a[60:63], v[188:191], v[140:143]
    v_fmac_f32 v115, v19, v12
    s_waitcnt vmcnt(6)
    v_cmp_ne_u64 s[18:19], s[0:1], v[28:29]
    s_nop 0
    s_mov_b64 vcc, s[18:19]
    s_cbranch_vccz L_mok25
    s_mov_b32 s3, 0
L_mp24:
    s_mov_b64 exec, s[18:19]
    s_cbranch_execz L_mp24_0
    buffer_load_dwordx2 v[28:29], v26, s[8:11], s55 offen sc1
L_mp24_0:
    s_mov_b64 exec, -1
    s_waitcnt vmcnt(0)
    v_cmp_ne_u64 s[18:19], s[0:1], v[28:29]
    s_nop 0
    s_mov_b64 vcc, s[18:19]
    s_add_u32 s3, s3, 1
    s_cmp_gt_u32 s3, 1000000
    s_cbranch_scc1 L_mok25
    s_cbranch_vccnz L_mp24
L_mok25:
    s_waitcnt lgkmcnt(3)
    v_mfma_f32_16x16x32_bf16 v[128:131], a[64:67], v[192:195], v[128:131]
    ds_read_b128 a[60:63], v5 offset:52224
    s_add_u32 s56, s50, 0
    s_and_b32 s56, s56, 7168
    s_cmp_eq_u32 s56, s59
    s_cselect_b32 s56, 1073741824, s56
    v_add_u32 v25, s56, v4
    buffer_load_dwordx4 v[32:35], v25, s[8:11], s64 offen sc1
    v_fmac_f32 v120, v20, v12
    v_fmac_f32 v121, v21, v12
    v_mfma_f32_16x16x32_bf16 v[132:135], a[64:67], v[196:199], v[132:135]
    v_fmac_f32 v122, v22, v12
    v_fmac_f32 v123, v23, v12
    v_max_f32 v112, 0, v112
    v_max_f32 v113, 0, v113
    v_max_f32_e64 v114, 0, v114
    v_mfma_f32_16x16x32_bf16 v[136:139], a[68:71], v[192:195], v[136:139]
    ds_read_b128 a[64:67], v5 offset:53248
    v_mfma_f32_16x16x32_bf16 v[140:143], a[68:71], v[196:199], v[140:143]
    buffer_load_dwordx4 v[36:39], v25, s[8:11], s65 offen sc1
    v_mfma_f32_16x16x32_bf16 v[128:131], a[72:75], v[200:203], v[128:131]
    ds_read_b128 a[68:71], v5 offset:54272
    buffer_load_dwordx4 v[40:43], v25, s[8:11], s66 offen sc1
    v_mfma_f32_16x16x32_bf16 v[132:135], a[72:75], v[204:207], v[132:135]
    v_max_f32 v115, 0, v115
    v_mul_f32 v112, v112, v120
    v_mul_f32_e64 v113, v113, v121
    v_mfma_f32_16x16x32_bf16 v[136:139], a[76:79], v[200:203], v[136:139]
    ds_read_b128 a[72:75], v5 offset:55296
    v_mul_f32_e64 v114, v114, v122
    v_mul_f32 v115, v115, v123
    v_mfma_f32_16x16x32_bf16 v[140:143], a[76:79], v[204:207], v[140:143]
    v_cvt_pk_bf16_f32 v106, v112, v113
    v_cvt_pk_bf16_f32 v107, v114, v115
    s_waitcnt lgkmcnt(3)
    v_mfma_f32_16x16x32_bf16 v[128:131], a[48:51], v[208:211], v[128:131]
    ds_read_b128 a[76:79], v5 offset:56320
    buffer_load_dwordx4 v[44:47], v25, s[8:11], s67 offen sc1
    v_mfma_f32_16x16x32_bf16 v[132:135], a[48:51], v[212:215], v[132:135]
    buffer_store_dwordx4 v[104:107], v4, s[8:11], s70 offen sc1
    v_fmac_f32_e64 v116, v16, v13
    v_mfma_f32_16x16x32_bf16 v[136:139], a[52:55], v[208:211], v[136:139]
    ds_read_b128 a[48:51], v5 offset:57344
    v_fmac_f32 v117, v17, v13
    v_fmac_f32 v118, v18, v13
    v_mfma_f32_16x16x32_bf16 v[140:143], a[52:55], v[212:215], v[140:143]
    v_fmac_f32 v119, v19, v13
    v_fmac_f32 v124, v20, v13
    v_fmac_f32_e64 v125, v21, v13
    v_mfma_f32_16x16x32_bf16 v[128:131], a[56:59], v[216:219], v[128:131]
    ds_read_b128 a[52:55], v5 offset:58368
    s_add_u32 s56, s50, 1024
    s_and_b32 s56, s56, 7168
    s_cmp_eq_u32 s56, s59
    s_cselect_b32 s56, 1073741824, s56
    v_add_u32_e64 v27, s56, v4
    buffer_load_dwordx4 v[48:51], v27, s[8:11], s64 offen sc1
    v_fmac_f32_e64 v126, v22, v13
    v_mfma_f32_16x16x32_bf16 v[132:135], a[56:59], v[220:223], v[132:135]
    v_fmac_f32 v127, v23, v13
    v_max_f32 v116, 0, v116
    v_max_f32 v117, 0, v117
    v_max_f32 v118, 0, v118
    v_max_f32 v119, 0, v119
    v_mfma_f32_16x16x32_bf16 v[136:139], a[60:63], v[216:219], v[136:139]
    ds_read_b128 a[56:59], v5 offset:59392
    v_mfma_f32_16x16x32_bf16 v[140:143], a[60:63], v[220:223], v[140:143]
    s_waitcnt lgkmcnt(3)
    v_mfma_f32_16x16x32_bf16 v[128:131], a[64:67], v[224:227], v[128:131]
    ds_read_b128 a[60:63], v5 offset:60416
    buffer_load_dwordx4 v[52:55], v27, s[8:11], s65 offen sc1
    v_mfma_f32_16x16x32_bf16 v[132:135], a[64:67], v[228:231], v[132:135]
    v_mul_f32 v116, v116, v124
    v_mul_f32 v117, v117, v125
    v_mul_f32_e64 v118, v118, v126
    v_mfma_f32_16x16x32_bf16 v[136:139], a[68:71], v[224:227], v[136:139]
    ds_read_b128 a[64:67], v5 offset:61440
    v_mul_f32 v119, v119, v127
    v_cvt_pk_bf16_f32 v110, v116, v117
    v_mfma_f32_16x16x32_bf16 v[140:143], a[68:71], v[228:231], v[140:143]
    v_cvt_pk_bf16_f32 v111, v118, v119
    buffer_store_dwordx4 v[108:111], v24, s[8:11], s70 offen sc1
    v_mfma_f32_16x16x32_bf16 v[128:131], a[72:75], v[232:235], v[128:131]
    ds_read_b128 a[68:71], v5 offset:62464
    v_mfma_f32_16x16x32_bf16 v[132:135], a[72:75], v[236:239], v[132:135]
    buffer_load_dwordx4 v[56:59], v27, s[8:11], s66 offen sc1
    v_mfma_f32_16x16x32_bf16 v[136:139], a[76:79], v[232:235], v[136:139]
    ds_read_b128 a[72:75], v5 offset:63488
    v_mfma_f32_16x16x32_bf16 v[140:143], a[76:79], v[236:239], v[140:143]
    s_waitcnt lgkmcnt(3)
    v_mfma_f32_16x16x32_bf16 v[128:131], a[48:51], v[240:243], v[128:131]
    ds_read_b128 a[76:79], v5 offset:64512
    v_mfma_f32_16x16x32_bf16 v[132:135], a[48:51], v[244:247], v[132:135]
    buffer_load_dwordx4 v[60:63], v27, s[8:11], s67 offen sc1
    v_mfma_f32_16x16x32_bf16 v[136:139], a[52:55], v[240:243], v[136:139]
    ds_read_b128 a[48:51], v6 offset:0
    v_mfma_f32_16x16x32_bf16 v[140:143], a[52:55], v[244:247], v[140:143]
    v_mfma_f32_16x16x32_bf16 v[128:131], a[56:59], v[248:251], v[128:131]
    ds_read_b128 a[52:55], v6 offset:1024
    v_mfma_f32_16x16x32_bf16 v[132:135], a[56:59], v[252:255], v[132:135]
    s_add_u32 s56, s50, 2048
    s_and_b32 s56, s56, 7168
    s_cmp_eq_u32 s56, s59
    s_cselect_b32 s56, 1073741824, s56
    v_add_u32 v25, s56, v4
    v_mfma_f32_16x16x32_bf16 v[136:139], a[60:63], v[248:251], v[136:139]
    ds_read_b128 a[56:59], v6 offset:2048
    v_mfma_f32_16x16x32_bf16 v[140:143], a[60:63], v[252:255], v[140:143]
    buffer_load_dwordx4 v[64:67], v25, s[8:11], s64 offen sc1
    s_waitcnt lgkmcnt(3)
    v_mfma_f32_16x16x32_bf16 v[128:131], a[64:67], a[0:3], v[128:131]
    ds_read_b128 a[60:63], v6 offset:3072
    v_mfma_f32_16x16x32_bf16 v[132:135], a[64:67], a[4:7], v[132:135]
    buffer_load_dwordx4 v[68:71], v25, s[8:11], s65 offen sc1
    v_mfma_f32_16x16x32_bf16 v[136:139], a[68:71], a[0:3], v[136:139]
    ds_read_b128 a[64:67], v6 offset:4096
    v_mfma_f32_16x16x32_bf16 v[140:143], a[68:71], a[4:7], v[140:143]
    v_mfma_f32_16x16x32_bf16 v[128:131], a[72:75], a[8:11], v[128:131]
    ds_read_b128 a[68:71], v6 offset:5120
    v_mfma_f32_16x16x32_bf16 v[132:135], a[72:75], a[12:15], v[132:135]
    buffer_load_dwordx4 v[72:75], v25, s[8:11], s66 offen sc1
    v_mfma_f32_16x16x32_bf16 v[136:139], a[76:79], a[8:11], v[136:139]
    ds_read_b128 a[72:75], v6 offset:6144
    v_mfma_f32_16x16x32_bf16 v[140:143], a[76:79], a[12:15], v[140:143]
    s_waitcnt lgkmcnt(3)
    v_mfma_f32_16x16x32_bf16 v[128:131], a[48:51], a[16:19], v[128:131]
    ds_read_b128 a[76:79], v6 offset:7168
    v_mfma_f32_16x16x32_bf16 v[132:135], a[48:51], a[20:23], v[132:135]
    buffer_load_dwordx4 v[76:79], v25, s[8:11], s67 offen sc1
    v_mfma_f32_16x16x32_bf16 v[136:139], a[52:55], a[16:19], v[136:139]
    v_mfma_f32_16x16x32_bf16 v[140:143], a[52:55], a[20:23], v[140:143]
    v_mfma_f32_16x16x32_bf16 v[128:131], a[56:59], a[24:27], v[128:131]
    v_mfma_f32_16x16x32_bf16 v[132:135], a[56:59], a[28:31], v[132:135]
    v_mfma_f32_16x16x32_bf16 v[136:139], a[60:63], a[24:27], v[136:139]
    v_mfma_f32_16x16x32_bf16 v[140:143], a[60:63], a[28:31], v[140:143]
    s_waitcnt lgkmcnt(0)
    v_mfma_f32_16x16x32_bf16 v[128:131], a[64:67], a[32:35], v[128:131]
    v_mfma_f32_16x16x32_bf16 v[132:135], a[64:67], a[36:39], v[132:135]
    v_mfma_f32_16x16x32_bf16 v[136:139], a[68:71], a[32:35], v[136:139]
    v_mfma_f32_16x16x32_bf16 v[140:143], a[68:71], a[36:39], v[140:143]
    v_mfma_f32_16x16x32_bf16 v[128:131], a[72:75], a[40:43], v[128:131]
    ds_read_b128 v[16:19], v8 offset:384
    ds_read_b128 v[20:23], v8 offset:832
    v_mfma_f32_16x16x32_bf16 v[132:135], a[72:75], a[44:47], v[132:135]
    v_mfma_f32_16x16x32_bf16 v[136:139], a[76:79], a[40:43], v[136:139]
    v_mfma_f32_16x16x32_bf16 v[140:143], a[76:79], a[44:47], v[140:143]
    v_add_u32 v10, s62, v4
    v_add_u32 v5, s62, v5
    v_add_u32_e64 v6, s62, v6
    s_waitcnt lgkmcnt(0)
    v_pk_fma_f32 v[128:129], v[16:17], v[12:13], v[128:129] op_sel:[0,0,0] op_sel_hi:[1,0,1]
    v_pk_fma_f32 v[130:131], v[18:19], v[12:13], v[130:131] op_sel:[0,0,0] op_sel_hi:[1,0,1]
    s_nop 0
    v_pk_fma_f32 v[136:137], v[20:21], v[12:13], v[136:137] op_sel:[0,0,0] op_sel_hi:[1,0,1]
    v_pk_fma_f32 v[138:139], v[22:23], v[12:13], v[138:139] op_sel:[0,0,0] op_sel_hi:[1,0,1]
    v_max_f32 v128, 0, v128
    v_max_f32 v129, 0, v129
    v_max_f32 v130, 0, v130
    v_max_f32 v131, 0, v131
    v_pk_mul_f32 v[128:129], v[128:129], v[136:137]
    v_pk_mul_f32 v[130:131], v[130:131], v[138:139]
    v_cvt_pk_bf16_f32 v136, v128, v129
    v_cvt_pk_bf16_f32 v137, v130, v131
    v_pk_fma_f32 v[132:133], v[16:17], v[12:13], v[132:133] op_sel:[0,1,0] op_sel_hi:[1,1,1]
    v_pk_fma_f32 v[134:135], v[18:19], v[12:13], v[134:135] op_sel:[0,1,0] op_sel_hi:[1,1,1]
    v_pk_fma_f32 v[140:141], v[20:21], v[12:13], v[140:141] op_sel:[0,1,0] op_sel_hi:[1,1,1]
    v_pk_fma_f32 v[142:143], v[22:23], v[12:13], v[142:143] op_sel:[0,1,0] op_sel_hi:[1,1,1]
    v_max_f32 v132, 0, v132
    v_max_f32 v133, 0, v133
    v_max_f32 v134, 0, v134
    v_max_f32 v135, 0, v135
    v_pk_mul_f32 v[132:133], v[132:133], v[140:141]
    v_pk_mul_f32 v[134:135], v[134:135], v[142:143]
    v_cvt_pk_bf16_f32 v138, v132, v133
    v_cvt_pk_bf16_f32 v139, v134, v135
    s_bitcmp0_b32 s52, 1
    s_cbranch_scc1 L_hs26
    v_swap_b32 v136, v138
    v_swap_b32 v137, v139
L_hs26:
    buffer_store_dwordx4 v[136:139], v4, s[8:11], s71 offen sc1
    s_waitcnt vmcnt(7)
    s_barrier
    s_lshl_b32 s16, s51, 4
    s_add_u32 s16, s16, s52
    s_lshl_b32 s16, s16, 7
    s_add_u32 s16, s16, 22282240
    s_lshl_b32 s55, s48, 30
    v_lshl_add_u32 v26, v1, 3, s55
    v_mov_b32_e64 v28, s0
    v_mov_b32 v29, s1
    s_mov_b64 exec, 0xffff
    buffer_store_dwordx2 v[28:29], v26, s[8:11], s16 offen sc1
    s_mov_b64 exec, -1
    v_mfma_f32_16x16x32_bf16 v[144:147], a[80:83], v[32:35], 0
    s_add_u32 s56, s50, 3072
    s_and_b32 s56, s56, 7168
    s_cmp_eq_u32 s56, s59
    s_cselect_b32 s56, 1073741824, s56
    v_add_u32_e64 v27, s56, v4
    v_mfma_f32_16x16x32_bf16 v[164:167], a[80:83], v[36:39], 0
    buffer_load_dwordx4 v[80:83], v27, s[8:11], s64 offen sc1
    v_mfma_f32_16x16x32_bf16 v[184:187], a[80:83], v[40:43], 0
    v_mfma_f32_16x16x32_bf16 v[204:207], a[80:83], v[44:47], 0
    v_mfma_f32_16x16x32_bf16 v[148:151], a[84:87], v[32:35], 0
    v_mfma_f32_16x16x32_bf16 v[168:171], a[84:87], v[36:39], 0
    buffer_load_dwordx4 v[84:87], v27, s[8:11], s65 offen sc1
    v_mfma_f32_16x16x32_bf16 v[188:191], a[84:87], v[40:43], 0
    v_mfma_f32_16x16x32_bf16 v[208:211], a[84:87], v[44:47], 0
    v_mfma_f32_16x16x32_bf16 v[152:155], a[88:91], v[32:35], 0
    v_mfma_f32_16x16x32_bf16 v[172:175], a[88:91], v[36:39], 0
    v_mfma_f32_16x16x32_bf16 v[192:195], a[88:91], v[40:43], 0
    buffer_load_dwordx4 v[88:91], v27, s[8:11], s66 offen sc1
    v_mfma_f32_16x16x32_bf16 v[212:215], a[88:91], v[44:47], 0
    v_mfma_f32_16x16x32_bf16 v[156:159], a[92:95], v[32:35], 0
    v_mfma_f32_16x16x32_bf16 v[176:179], a[92:95], v[36:39], 0
    v_mfma_f32_16x16x32_bf16 v[196:199], a[92:95], v[40:43], 0
    v_mfma_f32_16x16x32_bf16 v[216:219], a[92:95], v[44:47], 0
    buffer_load_dwordx4 v[92:95], v27, s[8:11], s67 offen sc1
    v_mfma_f32_16x16x32_bf16 v[160:163], a[96:99], v[32:35], 0
    v_mfma_f32_16x16x32_bf16 v[180:183], a[96:99], v[36:39], 0
    v_mfma_f32_16x16x32_bf16 v[200:203], a[96:99], v[40:43], 0
    v_mfma_f32_16x16x32_bf16 v[220:223], a[96:99], v[44:47], 0
    s_waitcnt vmcnt(10)
    v_mfma_f32_16x16x32_bf16 v[144:147], a[100:103], v[48:51], v[144:147]
    s_add_u32 s56, s50, 4096
    s_and_b32 s56, s56, 7168
    s_cmp_eq_u32 s56, s59
    s_cselect_b32 s56, 1073741824, s56
    v_add_u32 v25, s56, v4
    v_mfma_f32_16x16x32_bf16 v[164:167], a[100:103], v[52:55], v[164:167]
    buffer_load_dwordx4 v[32:35], v25, s[8:11], s64 offen sc1
    v_mfma_f32_16x16x32_bf16 v[184:187], a[100:103], v[56:59], v[184:187]
    ds_read_b128 a[80:83], v10 offset:0
    ds_read_b128 a[84:87], v10 offset:1024
    v_mfma_f32_16x16x32_bf16 v[204:207], a[100:103], v[60:63], v[204:207]
    ds_read_b128 a[88:91], v10 offset:2048
    ds_read_b128 a[92:95], v10 offset:3072
    v_mfma_f32_16x16x32_bf16 v[148:151], a[104:107], v[48:51], v[148:151]
    ds_read_b128 a[96:99], v6 offset:16384
    v_mfma_f32_16x16x32_bf16 v[168:171], a[104:107], v[52:55], v[168:171]
    buffer_load_dwordx4 v[36:39], v25, s[8:11], s65 offen sc1
    v_mfma_f32_16x16x32_bf16 v[188:191], a[104:107], v[56:59], v[188:191]
    v_mfma_f32_16x16x32_bf16 v[208:211], a[104:107], v[60:63], v[208:211]
    v_mfma_f32_16x16x32_bf16 v[152:155], a[108:111], v[48:51], v[152:155]
    v_mfma_f32_16x16x32_bf16 v[172:175], a[108:111], v[52:55], v[172:175]
    v_mfma_f32_16x16x32_bf16 v[192:195], a[108:111], v[56:59], v[192:195]
    buffer_load_dwordx4 v[40:43], v25, s[8:11], s66 offen sc1
    v_mfma_f32_16x16x32_bf16 v[212:215], a[108:111], v[60:63], v[212:215]
    v_mfma_f32_16x16x32_bf16 v[156:159], a[112:115], v[48:51], v[156:159]
    v_mfma_f32_16x16x32_bf16 v[176:179], a[112:115], v[52:55], v[176:179]
    v_mfma_f32_16x16x32_bf16 v[196:199], a[112:115], v[56:59], v[196:199]
    v_mfma_f32_16x16x32_bf16 v[216:219], a[112:115], v[60:63], v[216:219]
    buffer_load_dwordx4 v[44:47], v25, s[8:11], s67 offen sc1
    v_mfma_f32_16x16x32_bf16 v[160:163], a[116:119], v[48:51], v[160:163]
    v_mfma_f32_16x16x32_bf16 v[180:183], a[116:119], v[52:55], v[180:183]
    v_mfma_f32_16x16x32_bf16 v[200:203], a[116:119], v[56:59], v[200:203]
    v_mfma_f32_16x16x32_bf16 v[220:223], a[116:119], v[60:63], v[220:223]
    s_waitcnt vmcnt(10)
    v_mfma_f32_16x16x32_bf16 v[144:147], a[120:123], v[64:67], v[144:147]
    s_add_u32 s56, s50, 5120
    s_and_b32 s56, s56, 7168
    s_cmp_eq_u32 s56, s59
    s_cselect_b32 s56, 1073741824, s56
    v_add_u32 v27, s56, v4
    v_mfma_f32_16x16x32_bf16 v[164:167], a[120:123], v[68:71], v[164:167]
    buffer_load_dwordx4 v[48:51], v27, s[8:11], s64 offen sc1
    v_mfma_f32_16x16x32_bf16 v[184:187], a[120:123], v[72:75], v[184:187]
    ds_read_b128 a[100:103], v6 offset:17408
    ds_read_b128 a[104:107], v6 offset:18432
    v_mfma_f32_16x16x32_bf16 v[204:207], a[120:123], v[76:79], v[204:207]
    ds_read_b128 a[108:111], v10 offset:16384
    ds_read_b128 a[112:115], v10 offset:17408
    v_mfma_f32_16x16x32_bf16 v[148:151], a[124:127], v[64:67], v[148:151]
    ds_read_b128 a[116:119], v10 offset:18432
    v_mfma_f32_16x16x32_bf16 v[168:171], a[124:127], v[68:71], v[168:171]
    buffer_load_dwordx4 v[52:55], v27, s[8:11], s65 offen sc1
    v_mfma_f32_16x16x32_bf16 v[188:191], a[124:127], v[72:75], v[188:191]
    v_mfma_f32_16x16x32_bf16 v[208:211], a[124:127], v[76:79], v[208:211]
    v_mfma_f32_16x16x32_bf16 v[152:155], a[128:131], v[64:67], v[152:155]
    v_mfma_f32_16x16x32_bf16 v[172:175], a[128:131], v[68:71], v[172:175]
    v_mfma_f32_16x16x32_bf16 v[192:195], a[128:131], v[72:75], v[192:195]
    buffer_load_dwordx4 v[56:59], v27, s[8:11], s66 offen sc1
    v_mfma_f32_16x16x32_bf16 v[212:215], a[128:131], v[76:79], v[212:215]
    v_mfma_f32_16x16x32_bf16 v[156:159], a[132:135], v[64:67], v[156:159]
    v_mfma_f32_16x16x32_bf16 v[176:179], a[132:135], v[68:71], v[176:179]
    v_mfma_f32_16x16x32_bf16 v[196:199], a[132:135], v[72:75], v[196:199]
    v_mfma_f32_16x16x32_bf16 v[216:219], a[132:135], v[76:79], v[216:219]
    buffer_load_dwordx4 v[60:63], v27, s[8:11], s67 offen sc1
    v_mfma_f32_16x16x32_bf16 v[160:163], a[136:139], v[64:67], v[160:163]
    v_mfma_f32_16x16x32_bf16 v[180:183], a[136:139], v[68:71], v[180:183]
    v_mfma_f32_16x16x32_bf16 v[200:203], a[136:139], v[72:75], v[200:203]
    v_mfma_f32_16x16x32_bf16 v[220:223], a[136:139], v[76:79], v[220:223]
    s_waitcnt vmcnt(13)
    s_barrier
    s_lshl_b32 s16, s51, 4
    s_add_u32 s16, s16, s52
    s_lshl_b32 s16, s16, 7
    s_add_u32 s16, s16, 22249472
    s_lshl_b32 s55, s48, 30
    v_lshl_add_u32 v26, v1, 3, s55
    v_mov_b32 v28, s0
    v_mov_b32 v29, s1
    s_mov_b64 exec, 0xffff
    buffer_store_dwordx2 v[28:29], v26, s[8:11], s16 offen sc1
    s_mov_b64 exec, -1
    s_waitcnt vmcnt(9)
    v_mfma_f32_16x16x32_bf16 v[144:147], a[140:143], v[80:83], v[144:147]
    s_add_u32 s56, s50, 6144
    s_and_b32 s56, s56, 7168
    s_cmp_eq_u32 s56, s59
    s_cselect_b32 s56, 1073741824, s56
    v_add_u32_e64 v25, s56, v4
    v_mfma_f32_16x16x32_bf16 v[164:167], a[140:143], v[84:87], v[164:167]
    buffer_load_dwordx4 v[64:67], v25, s[8:11], s64 offen sc1
    v_mfma_f32_16x16x32_bf16 v[184:187], a[140:143], v[88:91], v[184:187]
    s_lshr_b32 s55, s53, 1
    s_lshl_b32 s55, s55, 11
    s_add_u32 s55, s55, 22282240
    v_min_u32 v26, 15, v1
    v_lshlrev_b32 v26, 7, v26
    buffer_load_dwordx2 v[28:29], v26, s[8:11], s55 offen sc1
    v_mfma_f32_16x16x32_bf16 v[204:207], a[140:143], v[92:95], v[204:207]
    ds_read_b128 a[120:123], v10 offset:19456
    ds_read_b128 a[124:127], v10 offset:32768
    v_mfma_f32_16x16x32_bf16 v[148:151], a[144:147], v[80:83], v[148:151]
    ds_read_b128 a[128:131], v10 offset:33792
    ds_read_b128 a[132:135], v10 offset:34816
    v_mfma_f32_16x16x32_bf16 v[168:171], a[144:147], v[84:87], v[168:171]
    buffer_load_dwordx4 v[68:71], v25, s[8:11], s65 offen sc1
    v_mfma_f32_16x16x32_bf16 v[188:191], a[144:147], v[88:91], v[188:191]
    ds_read_b128 a[136:139], v10 offset:35840
    v_mfma_f32_16x16x32_bf16 v[208:211], a[144:147], v[92:95], v[208:211]
    buffer_load_dword v106, v9, s[8:11], s76 offen sc1
    v_mfma_f32_16x16x32_bf16 v[152:155], a[148:151], v[80:83], v[152:155]
    v_mfma_f32_16x16x32_bf16 v[172:175], a[148:151], v[84:87], v[172:175]
    v_mfma_f32_16x16x32_bf16 v[192:195], a[148:151], v[88:91], v[192:195]
    buffer_load_dwordx4 v[72:75], v25, s[8:11], s66 offen sc1
    v_mfma_f32_16x16x32_bf16 v[212:215], a[148:151], v[92:95], v[212:215]
    v_mfma_f32_16x16x32_bf16 v[156:159], a[152:155], v[80:83], v[156:159]
    v_mfma_f32_16x16x32_bf16 v[176:179], a[152:155], v[84:87], v[176:179]
    v_mfma_f32_16x16x32_bf16 v[196:199], a[152:155], v[88:91], v[196:199]
    v_mfma_f32_16x16x32_bf16 v[216:219], a[152:155], v[92:95], v[216:219]
    buffer_load_dwordx4 v[76:79], v25, s[8:11], s67 offen sc1
    v_mfma_f32_16x16x32_bf16 v[160:163], a[156:159], v[80:83], v[160:163]
    v_mfma_f32_16x16x32_bf16 v[180:183], a[156:159], v[84:87], v[180:183]
    v_mfma_f32_16x16x32_bf16 v[200:203], a[156:159], v[88:91], v[200:203]
    v_mfma_f32_16x16x32_bf16 v[220:223], a[156:159], v[92:95], v[220:223]
    s_waitcnt vmcnt(11)
    v_mfma_f32_16x16x32_bf16 v[144:147], a[160:163], v[32:35], v[144:147]
    s_add_u32 s56, s50, 7168
    s_and_b32 s56, s56, 7168
    s_cmp_eq_u32 s56, s59
    s_cselect_b32 s56, 1073741824, s56
    v_add_u32 v27, s56, v4
    v_mfma_f32_16x16x32_bf16 v[164:167], a[160:163], v[36:39], v[164:167]
    buffer_load_dwordx4 v[80:83], v27, s[8:11], s64 offen sc1
    v_mfma_f32_16x16x32_bf16 v[184:187], a[160:163], v[40:43], v[184:187]
    ds_read_b128 a[140:143], v10 offset:49152
    ds_read_b128 a[144:147], v10 offset:50176
    v_mfma_f32_16x16x32_bf16 v[204:207], a[160:163], v[44:47], v[204:207]
    ds_read_b128 a[148:151], v10 offset:51200
    ds_read_b128 a[152:155], v10 offset:52224
    v_mfma_f32_16x16x32_bf16 v[148:151], a[164:167], v[32:35], v[148:151]
    v_mfma_f32_16x16x32_bf16 v[168:171], a[164:167], v[36:39], v[168:171]
    buffer_load_dwordx4 v[84:87], v27, s[8:11], s65 offen sc1
    v_mfma_f32_16x16x32_bf16 v[188:191], a[164:167], v[40:43], v[188:191]
    v_mfma_f32_16x16x32_bf16 v[208:211], a[164:167], v[44:47], v[208:211]
    v_mfma_f32_16x16x32_bf16 v[152:155], a[168:171], v[32:35], v[152:155]
    v_mfma_f32_16x16x32_bf16 v[172:175], a[168:171], v[36:39], v[172:175]
    v_mfma_f32_16x16x32_bf16 v[192:195], a[168:171], v[40:43], v[192:195]
    buffer_load_dwordx4 v[88:91], v27, s[8:11], s66 offen sc1
    v_mfma_f32_16x16x32_bf16 v[212:215], a[168:171], v[44:47], v[212:215]
    v_mfma_f32_16x16x32_bf16 v[156:159], a[172:175], v[32:35], v[156:159]
    v_mfma_f32_16x16x32_bf16 v[176:179], a[172:175], v[36:39], v[176:179]
    v_mfma_f32_16x16x32_bf16 v[196:199], a[172:175], v[40:43], v[196:199]
    v_mfma_f32_16x16x32_bf16 v[216:219], a[172:175], v[44:47], v[216:219]
    buffer_load_dwordx4 v[92:95], v27, s[8:11], s67 offen sc1
    v_mfma_f32_16x16x32_bf16 v[160:163], a[176:179], v[32:35], v[160:163]
    v_mfma_f32_16x16x32_bf16 v[180:183], a[176:179], v[36:39], v[180:183]
    v_mfma_f32_16x16x32_bf16 v[200:203], a[176:179], v[40:43], v[200:203]
    v_mfma_f32_16x16x32_bf16 v[220:223], a[176:179], v[44:47], v[220:223]
    s_waitcnt vmcnt(8)
    v_cmp_ne_u64 s[18:19], s[0:1], v[28:29]
    s_nop 0
    s_mov_b64 vcc, s[18:19]
    s_cbranch_vccz L_mok28
    s_mov_b32 s3, 0
L_mp27:
    s_mov_b64 exec, s[18:19]
    s_cbranch_execz L_mp27_0
    buffer_load_dwordx2 v[28:29], v26, s[8:11], s55 offen sc1
L_mp27_0:
    s_mov_b64 exec, -1
    s_waitcnt vmcnt(0)
    v_cmp_ne_u64 s[18:19], s[0:1], v[28:29]
    s_nop 0
    s_mov_b64 vcc, s[18:19]
    s_add_u32 s3, s3, 1
    s_cmp_gt_u32 s3, 1000000
    s_cbranch_scc1 L_mok28
    s_cbranch_vccnz L_mp27
L_mok28:
    v_mfma_f32_16x16x32_bf16 v[144:147], a[180:183], v[48:51], v[144:147]
    s_add_u32 s56, s50, 8192
    s_and_b32 s56, s56, 3072
    s_cmp_eq_u32 s56, s73
    s_cselect_b32 s56, 1073741824, s56
    s_add_u32 s56, s56, 8192
    v_add_u32_e64 v25, s56, v4
    v_mfma_f32_16x16x32_bf16 v[164:167], a[180:183], v[52:55], v[164:167]
    buffer_load_dwordx4 v[32:35], v25, s[8:11], s64 offen sc1
    v_mfma_f32_16x16x32_bf16 v[184:187], a[180:183], v[56:59], v[184:187]
    v_mfma_f32_16x16x32_bf16 v[204:207], a[180:183], v[60:63], v[204:207]
    v_mfma_f32_16x16x32_bf16 v[148:151], a[184:187], v[48:51], v[148:151]
    v_mfma_f32_16x16x32_bf16 v[168:171], a[184:187], v[52:55], v[168:171]
    buffer_load_dwordx4 v[36:39], v25, s[8:11], s65 offen sc1
    v_mfma_f32_16x16x32_bf16 v[188:191], a[184:187], v[56:59], v[188:191]
    v_mfma_f32_16x16x32_bf16 v[208:211], a[184:187], v[60:63], v[208:211]
    v_mfma_f32_16x16x32_bf16 v[152:155], a[188:191], v[48:51], v[152:155]
    v_mfma_f32_16x16x32_bf16 v[172:175], a[188:191], v[52:55], v[172:175]
    v_mfma_f32_16x16x32_bf16 v[192:195], a[188:191], v[56:59], v[192:195]
    buffer_load_dwordx4 v[40:43], v25, s[8:11], s66 offen sc1
    v_mfma_f32_16x16x32_bf16 v[212:215], a[188:191], v[60:63], v[212:215]
    v_mfma_f32_16x16x32_bf16 v[156:159], a[192:195], v[48:51], v[156:159]
    v_mfma_f32_16x16x32_bf16 v[176:179], a[192:195], v[52:55], v[176:179]
    v_mfma_f32_16x16x32_bf16 v[196:199], a[192:195], v[56:59], v[196:199]
    v_mfma_f32_16x16x32_bf16 v[216:219], a[192:195], v[60:63], v[216:219]
    buffer_load_dwordx4 v[44:47], v25, s[8:11], s67 offen sc1
    v_mfma_f32_16x16x32_bf16 v[160:163], a[196:199], v[48:51], v[160:163]
    v_mfma_f32_16x16x32_bf16 v[180:183], a[196:199], v[52:55], v[180:183]
    v_mfma_f32_16x16x32_bf16 v[200:203], a[196:199], v[56:59], v[200:203]
    v_mfma_f32_16x16x32_bf16 v[220:223], a[196:199], v[60:63], v[220:223]
    s_waitcnt vmcnt(8)
    v_mfma_f32_16x16x32_bf16 v[144:147], a[200:203], v[64:67], v[144:147]
    s_add_u32 s56, s50, 9216
    s_and_b32 s56, s56, 3072
    s_cmp_eq_u32 s56, s73
    s_cselect_b32 s56, 1073741824, s56
    s_add_u32 s56, s56, 8192
    v_add_u32 v27, s56, v4
    v_mfma_f32_16x16x32_bf16 v[164:167], a[200:203], v[68:71], v[164:167]
    buffer_load_dwordx4 v[48:51], v27, s[8:11], s64 offen sc1
    v_mfma_f32_16x16x32_bf16 v[184:187], a[200:203], v[72:75], v[184:187]
    v_mfma_f32_16x16x32_bf16 v[204:207], a[200:203], v[76:79], v[204:207]
    v_mfma_f32_16x16x32_bf16 v[148:151], a[204:207], v[64:67], v[148:151]
    v_mfma_f32_16x16x32_bf16 v[168:171], a[204:207], v[68:71], v[168:171]
    buffer_load_dwordx4 v[52:55], v27, s[8:11], s65 offen sc1
    v_mfma_f32_16x16x32_bf16 v[188:191], a[204:207], v[72:75], v[188:191]
    v_mfma_f32_16x16x32_bf16 v[208:211], a[204:207], v[76:79], v[208:211]
    v_mfma_f32_16x16x32_bf16 v[152:155], a[208:211], v[64:67], v[152:155]
    v_mfma_f32_16x16x32_bf16 v[172:175], a[208:211], v[68:71], v[172:175]
    v_mfma_f32_16x16x32_bf16 v[192:195], a[208:211], v[72:75], v[192:195]
    buffer_load_dwordx4 v[56:59], v27, s[8:11], s66 offen sc1
    v_mfma_f32_16x16x32_bf16 v[212:215], a[208:211], v[76:79], v[212:215]
    v_mfma_f32_16x16x32_bf16 v[156:159], a[212:215], v[64:67], v[156:159]
    v_mfma_f32_16x16x32_bf16 v[176:179], a[212:215], v[68:71], v[176:179]
    v_mfma_f32_16x16x32_bf16 v[196:199], a[212:215], v[72:75], v[196:199]
    v_mfma_f32_16x16x32_bf16 v[216:219], a[212:215], v[76:79], v[216:219]
    buffer_load_dwordx4 v[60:63], v27, s[8:11], s67 offen sc1
    v_mfma_f32_16x16x32_bf16 v[160:163], a[216:219], v[64:67], v[160:163]
    v_mfma_f32_16x16x32_bf16 v[180:183], a[216:219], v[68:71], v[180:183]
    v_mfma_f32_16x16x32_bf16 v[200:203], a[216:219], v[72:75], v[200:203]
    v_mfma_f32_16x16x32_bf16 v[220:223], a[216:219], v[76:79], v[220:223]
    s_waitcnt vmcnt(8)
    v_mfma_f32_16x16x32_bf16 v[144:147], a[220:223], v[80:83], v[144:147]
    s_add_u32 s56, s50, 10240
    s_and_b32 s56, s56, 3072
    s_cmp_eq_u32 s56, s73
    s_cselect_b32 s56, 1073741824, s56
    s_add_u32 s56, s56, 8192
    v_add_u32 v25, s56, v4
    v_mfma_f32_16x16x32_bf16 v[164:167], a[220:223], v[84:87], v[164:167]
    buffer_load_dwordx4 v[64:67], v25, s[8:11], s64 offen sc1
    v_mfma_f32_16x16x32_bf16 v[184:187], a[220:223], v[88:91], v[184:187]
    buffer_load_dwordx4 v[68:71], v25, s[8:11], s65 offen sc1
    v_mfma_f32_16x16x32_bf16 v[204:207], a[220:223], v[92:95], v[204:207]
    s_lshr_b32 s55, s53, 1
    s_lshl_b32 s55, s55, 11
    s_add_u32 s55, s55, 22249472
    v_min_u32 v26, 15, v1
    v_lshlrev_b32 v26, 7, v26
    buffer_load_dwordx2 v[28:29], v26, s[8:11], s55 offen sc1
    v_mfma_f32_16x16x32_bf16 v[148:151], a[224:227], v[80:83], v[148:151]
    v_mfma_f32_16x16x32_bf16 v[168:171], a[224:227], v[84:87], v[168:171]
    buffer_load_dwordx4 v[72:75], v25, s[8:11], s66 offen sc1
    v_mfma_f32_16x16x32_bf16 v[188:191], a[224:227], v[88:91], v[188:191]
    v_mfma_f32_16x16x32_bf16 v[208:211], a[224:227], v[92:95], v[208:211]
    v_mfma_f32_16x16x32_bf16 v[152:155], a[228:231], v[80:83], v[152:155]
    buffer_load_dwordx4 v[76:79], v25, s[8:11], s67 offen sc1
    v_mfma_f32_16x16x32_bf16 v[172:175], a[228:231], v[84:87], v[172:175]
    v_mfma_f32_16x16x32_bf16 v[192:195], a[228:231], v[88:91], v[192:195]
    v_mfma_f32_16x16x32_bf16 v[212:215], a[228:231], v[92:95], v[212:215]
    buffer_load_dwordx4 a[156:159], v4, s[8:11], s63 offen offset:3072 sc1
    v_mfma_f32_16x16x32_bf16 v[156:159], a[232:235], v[80:83], v[156:159]
    v_mfma_f32_16x16x32_bf16 v[176:179], a[232:235], v[84:87], v[176:179]
    v_mfma_f32_16x16x32_bf16 v[196:199], a[232:235], v[88:91], v[196:199]
    s_add_u32 s63, s63, 4096
    buffer_load_dwordx4 a[160:163], v4, s[8:11], s63 offen offset:0 sc1
    v_mfma_f32_16x16x32_bf16 v[216:219], a[232:235], v[92:95], v[216:219]
    v_mfma_f32_16x16x32_bf16 v[160:163], a[236:239], v[80:83], v[160:163]
    v_mfma_f32_16x16x32_bf16 v[180:183], a[236:239], v[84:87], v[180:183]
    buffer_load_dwordx4 a[164:167], v4, s[8:11], s63 offen offset:1024 sc1
    v_mfma_f32_16x16x32_bf16 v[200:203], a[236:239], v[88:91], v[200:203]
    v_mfma_f32_16x16x32_bf16 v[220:223], a[236:239], v[92:95], v[220:223]
    s_waitcnt vmcnt(12) lgkmcnt(14)
    v_mfma_f32_16x16x32_bf16 v[144:147], a[80:83], v[32:35], v[144:147]
    s_add_u32 s56, s50, 11264
    s_and_b32 s56, s56, 3072
    s_cmp_eq_u32 s56, s73
    s_cselect_b32 s56, 1073741824, s56
    s_add_u32 s56, s56, 8192
    v_add_u32 v27, s56, v4
    v_mfma_f32_16x16x32_bf16 v[164:167], a[80:83], v[36:39], v[164:167]
    buffer_load_dwordx4 v[80:83], v27, s[8:11], s64 offen sc1
    v_mfma_f32_16x16x32_bf16 v[184:187], a[80:83], v[40:43], v[184:187]
    buffer_load_dwordx4 v[84:87], v27, s[8:11], s65 offen sc1
    v_mfma_f32_16x16x32_bf16 v[204:207], a[80:83], v[44:47], v[204:207]
    v_mfma_f32_16x16x32_bf16 v[148:151], a[84:87], v[32:35], v[148:151]
    v_mfma_f32_16x16x32_bf16 v[168:171], a[84:87], v[36:39], v[168:171]
    buffer_load_dwordx4 v[88:91], v27, s[8:11], s66 offen sc1
    v_mfma_f32_16x16x32_bf16 v[188:191], a[84:87], v[40:43], v[188:191]
    v_mfma_f32_16x16x32_bf16 v[208:211], a[84:87], v[44:47], v[208:211]
    v_mfma_f32_16x16x32_bf16 v[152:155], a[88:91], v[32:35], v[152:155]
    buffer_load_dwordx4 v[92:95], v27, s[8:11], s67 offen sc1
    v_mfma_f32_16x16x32_bf16 v[172:175], a[88:91], v[36:39], v[172:175]
    v_mfma_f32_16x16x32_bf16 v[192:195], a[88:91], v[40:43], v[192:195]
    v_mfma_f32_16x16x32_bf16 v[212:215], a[88:91], v[44:47], v[212:215]
    buffer_load_dwordx4 a[168:171], v4, s[8:11], s63 offen offset:2048 sc1
    v_mfma_f32_16x16x32_bf16 v[156:159], a[92:95], v[32:35], v[156:159]
    v_mfma_f32_16x16x32_bf16 v[176:179], a[92:95], v[36:39], v[176:179]
    v_mfma_f32_16x16x32_bf16 v[196:199], a[92:95], v[40:43], v[196:199]
    buffer_load_dwordx4 a[172:175], v4, s[8:11], s63 offen offset:3072 sc1
    v_mfma_f32_16x16x32_bf16 v[216:219], a[92:95], v[44:47], v[216:219]
    v_mfma_f32_16x16x32_bf16 v[160:163], a[96:99], v[32:35], v[160:163]
    v_mfma_f32_16x16x32_bf16 v[180:183], a[96:99], v[36:39], v[180:183]
    s_addk_i32 s63, 4096
    buffer_load_dwordx4 a[176:179], v4, s[8:11], s63 offen offset:0 sc1
    v_mfma_f32_16x16x32_bf16 v[200:203], a[96:99], v[40:43], v[200:203]
    v_mfma_f32_16x16x32_bf16 v[220:223], a[96:99], v[44:47], v[220:223]
    s_waitcnt vmcnt(12)
    v_cmp_ne_u64 s[18:19], s[0:1], v[28:29]
    s_nop 0
    s_mov_b64 vcc, s[18:19]
    s_cbranch_vccz L_mok30
    s_mov_b32 s3, 0
L_mp29:
    s_mov_b64 exec, s[18:19]
    s_cbranch_execz L_mp29_0
    buffer_load_dwordx2 v[28:29], v26, s[8:11], s55 offen sc1
L_mp29_0:
    s_mov_b64 exec, -1
    s_waitcnt vmcnt(0)
    v_cmp_ne_u64 s[18:19], s[0:1], v[28:29]
    s_nop 0
    s_mov_b64 vcc, s[18:19]
    s_add_u32 s3, s3, 1
    s_cmp_gt_u32 s3, 1000000
    s_cbranch_scc1 L_mok30
    s_cbranch_vccnz L_mp29
L_mok30:
    s_waitcnt lgkmcnt(9)
    v_mfma_f32_16x16x32_bf16 v[144:147], a[100:103], v[48:51], v[144:147]
    s_add_u32 s56, s50, 12288
    s_and_b32 s56, s56, 1024
    s_add_u32 s56, s56, 12288
    v_add_u32_e64 v25, s56, v4
    v_mfma_f32_16x16x32_bf16 v[164:167], a[100:103], v[52:55], v[164:167]
    buffer_load_dwordx4 v[32:35], v25, s[8:11], s64 offen sc1
    v_mfma_f32_16x16x32_bf16 v[184:187], a[100:103], v[56:59], v[184:187]
    buffer_load_dwordx4 v[36:39], v25, s[8:11], s65 offen sc1
    v_mfma_f32_16x16x32_bf16 v[204:207], a[100:103], v[60:63], v[204:207]
    s_xor_b32 s58, s48, 1
    s_mul_i32 s58, s58, 15360
    v_mfma_f32_16x16x32_bf16 v[148:151], a[104:107], v[48:51], v[148:151]
    s_add_u32 s58, s58, 81920
    v_add_u32 v16, s58, v4
    v_mfma_f32_16x16x32_bf16 v[168:171], a[104:107], v[52:55], v[168:171]
    buffer_load_dwordx4 v[40:43], v25, s[8:11], s66 offen sc1
    v_mfma_f32_16x16x32_bf16 v[188:191], a[104:107], v[56:59], v[188:191]
    s_xor_b32 s58, s48, 2
    s_mul_i32 s58, s58, 15360
    v_mfma_f32_16x16x32_bf16 v[208:211], a[104:107], v[60:63], v[208:211]
    s_add_u32 s58, s58, 81920
    v_add_u32 v17, s58, v4
    v_mfma_f32_16x16x32_bf16 v[152:155], a[108:111], v[48:51], v[152:155]
    buffer_load_dwordx4 v[44:47], v25, s[8:11], s67 offen sc1
    v_mfma_f32_16x16x32_bf16 v[172:175], a[108:111], v[52:55], v[172:175]
    s_xor_b32 s58, s48, 3
    s_mul_i32 s58, s58, 15360
    v_mfma_f32_16x16x32_bf16 v[192:195], a[108:111], v[56:59], v[192:195]
    s_add_u32 s58, s58, 81920
    v_add_u32 v18, s58, v4
    v_mfma_f32_16x16x32_bf16 v[212:215], a[108:111], v[60:63], v[212:215]
    buffer_load_dwordx4 a[180:183], v4, s[8:11], s63 offen offset:1024 sc1
    v_mfma_f32_16x16x32_bf16 v[156:159], a[112:115], v[48:51], v[156:159]
    s_mul_i32 s58, s48, 15360
    s_add_u32 s58, s58, 81920
    v_mfma_f32_16x16x32_bf16 v[176:179], a[112:115], v[52:55], v[176:179]
    v_add_u32_e64 v19, s58, v4
    v_mfma_f32_16x16x32_bf16 v[196:199], a[112:115], v[56:59], v[196:199]
    buffer_load_dwordx4 a[184:187], v4, s[8:11], s63 offen offset:2048 sc1
    v_mfma_f32_16x16x32_bf16 v[216:219], a[112:115], v[60:63], v[216:219]
    v_mfma_f32_16x16x32_bf16 v[160:163], a[116:119], v[48:51], v[160:163]
    v_mfma_f32_16x16x32_bf16 v[180:183], a[116:119], v[52:55], v[180:183]
    buffer_load_dwordx4 a[188:191], v4, s[8:11], s63 offen offset:3072 sc1
    v_mfma_f32_16x16x32_bf16 v[200:203], a[116:119], v[56:59], v[200:203]
    v_mfma_f32_16x16x32_bf16 v[220:223], a[116:119], v[60:63], v[220:223]
    s_waitcnt vmcnt(17) lgkmcnt(4)
    v_mfma_f32_16x16x32_bf16 v[144:147], a[120:123], v[64:67], v[144:147]
    s_add_u32 s56, s50, 13312
    s_and_b32 s56, s56, 1024
    s_add_u32 s56, s56, 12288
    v_add_u32 v27, s56, v4
    v_mfma_f32_16x16x32_bf16 v[164:167], a[120:123], v[68:71], v[164:167]
    buffer_load_dwordx4 v[48:51], v27, s[8:11], s64 offen sc1
    v_mfma_f32_16x16x32_bf16 v[184:187], a[120:123], v[72:75], v[184:187]
    v_and_b32 v106, 0xffff0000, v106
    v_mfma_f32_16x16x32_bf16 v[204:207], a[120:123], v[76:79], v[204:207]
    buffer_load_dwordx4 v[52:55], v27, s[8:11], s65 offen sc1
    v_mfma_f32_16x16x32_bf16 v[148:151], a[124:127], v[64:67], v[148:151]
    v_rcp_f32_e64 v106, v106
    v_mfma_f32_16x16x32_bf16 v[168:171], a[124:127], v[68:71], v[168:171]
    v_accvgpr_read_b32 v96, a240
    v_mfma_f32_16x16x32_bf16 v[188:191], a[124:127], v[72:75], v[188:191]
    buffer_load_dwordx4 v[56:59], v27, s[8:11], s66 offen sc1
    v_mfma_f32_16x16x32_bf16 v[208:211], a[124:127], v[76:79], v[208:211]
    v_lshlrev_b32_e64 v108, 16, v96
    v_and_b32 v109, 0xffff0000, v96
    v_mfma_f32_16x16x32_bf16 v[152:155], a[128:131], v[64:67], v[152:155]
    v_accvgpr_read_b32 v97, a241
    v_mfma_f32_16x16x32_bf16 v[172:175], a[128:131], v[68:71], v[172:175]
    v_lshlrev_b32_e64 v110, 16, v97
    v_and_b32 v111, 0xffff0000, v97
    v_mfma_f32_16x16x32_bf16 v[192:195], a[128:131], v[72:75], v[192:195]
    buffer_load_dwordx4 v[60:63], v27, s[8:11], s67 offen sc1
    v_mfma_f32_16x16x32_bf16 v[212:215], a[128:131], v[76:79], v[212:215]
    v_accvgpr_read_b32 v98, a242
    v_mfma_f32_16x16x32_bf16 v[156:159], a[132:135], v[64:67], v[156:159]
    v_lshlrev_b32_e64 v112, 16, v98
    v_and_b32 v113, 0xffff0000, v98
    v_mfma_f32_16x16x32_bf16 v[176:179], a[132:135], v[68:71], v[176:179]
    s_add_u32 s63, s63, 4096
    buffer_load_dwordx4 a[192:195], v4, s[8:11], s63 offen offset:0 sc1
    v_mfma_f32_16x16x32_bf16 v[196:199], a[132:135], v[72:75], v[196:199]
    v_accvgpr_read_b32 v99, a243
    v_mfma_f32_16x16x32_bf16 v[216:219], a[132:135], v[76:79], v[216:219]
    v_lshlrev_b32_e64 v114, 16, v99
    v_and_b32 v115, 0xffff0000, v99
    v_mfma_f32_16x16x32_bf16 v[160:163], a[136:139], v[64:67], v[160:163]
    buffer_load_dwordx4 a[196:199], v4, s[8:11], s63 offen offset:1024 sc1
    v_mfma_f32_16x16x32_bf16 v[180:183], a[136:139], v[68:71], v[180:183]
    v_accvgpr_read_b32 v100, a244
    v_mfma_f32_16x16x32_bf16 v[200:203], a[136:139], v[72:75], v[200:203]
    v_lshlrev_b32_e64 v116, 16, v100
    v_and_b32 v117, 0xffff0000, v100
    v_mfma_f32_16x16x32_bf16 v[220:223], a[136:139], v[76:79], v[220:223]
    v_accvgpr_read_b32 v101, a245
    v_lshlrev_b32_e64 v118, 16, v101
    v_and_b32 v119, 0xffff0000, v101
    v_accvgpr_read_b32 v102, a246
    v_lshlrev_b32_e64 v120, 16, v102
    v_and_b32 v121, 0xffff0000, v102
    v_accvgpr_read_b32 v103, a247
    v_lshlrev_b32_e64 v122, 16, v103
    v_and_b32 v123, 0xffff0000, v103
    v_accvgpr_read_b32 v104, a248
    v_lshlrev_b32_e64 v124, 16, v104
    v_and_b32 v125, 0xffff0000, v104
    v_accvgpr_read_b32 v105, a249
    v_lshlrev_b32_e64 v126, 16, v105
    v_and_b32 v127, 0xffff0000, v105
    v_mul_f32 v106, v106, v106
    s_waitcnt vmcnt(16) lgkmcnt(0)
    v_mfma_f32_16x16x32_bf16 v[144:147], a[140:143], v[80:83], v[144:147]
    s_waitcnt vmcnt(9)
    v_mfma_f32_16x16x32_bf16 v[164:167], a[140:143], v[84:87], v[164:167]
    v_swap_b32 v34, v36
    v_mfma_f32_16x16x32_bf16 v[184:187], a[140:143], v[88:91], v[184:187]
    v_swap_b32 v35, v37
    v_mfma_f32_16x16x32_bf16 v[204:207], a[140:143], v[92:95], v[204:207]
    v_swap_b32 v42, v44
    v_mfma_f32_16x16x32_bf16 v[148:151], a[144:147], v[80:83], v[148:151]
    v_swap_b32 v43, v45
    v_mfma_f32_16x16x32_bf16 v[168:171], a[144:147], v[84:87], v[168:171]
    s_waitcnt vmcnt(2)
    v_mfma_f32_16x16x32_bf16 v[188:191], a[144:147], v[88:91], v[188:191]
    v_swap_b32 v50, v52
    v_mfma_f32_16x16x32_bf16 v[208:211], a[144:147], v[92:95], v[208:211]
    v_swap_b32 v51, v53
    v_mfma_f32_16x16x32_bf16 v[152:155], a[148:151], v[80:83], v[152:155]
    v_swap_b32 v58, v60
    v_mfma_f32_16x16x32_bf16 v[172:175], a[148:151], v[84:87], v[172:175]
    v_swap_b32 v59, v61
    v_mfma_f32_16x16x32_bf16 v[192:195], a[148:151], v[88:91], v[192:195]
    v_mfma_f32_16x16x32_bf16 v[212:215], a[148:151], v[92:95], v[212:215]
    v_mfma_f32_16x16x32_bf16 v[156:159], a[152:155], v[80:83], v[156:159]
    v_mfma_f32_16x16x32_bf16 v[176:179], a[152:155], v[84:87], v[176:179]
    v_mfma_f32_16x16x32_bf16 v[196:199], a[152:155], v[88:91], v[196:199]
    v_mfma_f32_16x16x32_bf16 v[216:219], a[152:155], v[92:95], v[216:219]
    v_mfma_f32_16x16x32_bf16 v[160:163], a[156:159], v[80:83], v[160:163]
    v_mfma_f32_16x16x32_bf16 v[180:183], a[156:159], v[84:87], v[180:183]
    v_mfma_f32_16x16x32_bf16 v[200:203], a[156:159], v[88:91], v[200:203]
    v_mfma_f32_16x16x32_bf16 v[220:223], a[156:159], v[92:95], v[220:223]
    s_waitcnt vmcnt(0)
    v_mfma_f32_16x16x32_bf16 v[164:167], a[160:163], v[36:39], v[164:167]
    v_mfma_f32_16x16x32_bf16 v[168:171], a[164:167], v[36:39], v[168:171]
    v_mfma_f32_16x16x32_bf16 v[172:175], a[168:171], v[36:39], v[172:175]
    v_mfma_f32_16x16x32_bf16 v[176:179], a[172:175], v[36:39], v[176:179]
    v_mfma_f32_16x16x32_bf16 v[180:183], a[176:179], v[36:39], v[180:183]
    v_mfma_f32_16x16x32_bf16 v[164:167], a[180:183], v[52:55], v[164:167]
    v_mfma_f32_16x16x32_bf16 v[168:171], a[184:187], v[52:55], v[168:171]
    v_mfma_f32_16x16x32_bf16 v[172:175], a[188:191], v[52:55], v[172:175]
    v_mfma_f32_16x16x32_bf16 v[176:179], a[192:195], v[52:55], v[176:179]
    v_mfma_f32_16x16x32_bf16 v[180:183], a[196:199], v[52:55], v[180:183]
    v_mfma_f32_16x16x32_bf16 v[184:187], a[160:163], v[40:43], v[184:187]
    v_mfma_f32_16x16x32_bf16 v[188:191], a[164:167], v[40:43], v[188:191]
    s_nop 1
    ds_write_b128 v16, v[164:167] offset:0
    v_mfma_f32_16x16x32_bf16 v[192:195], a[168:171], v[40:43], v[192:195]
    v_mfma_f32_16x16x32_bf16 v[196:199], a[172:175], v[40:43], v[196:199]
    ds_write_b128 v16, v[168:171] offset:1024
    v_mfma_f32_16x16x32_bf16 v[200:203], a[176:179], v[40:43], v[200:203]
    v_mfma_f32_16x16x32_bf16 v[184:187], a[180:183], v[56:59], v[184:187]
    ds_write_b128 v16, v[172:175] offset:2048
    v_mfma_f32_16x16x32_bf16 v[188:191], a[184:187], v[56:59], v[188:191]
    v_mfma_f32_16x16x32_bf16 v[192:195], a[188:191], v[56:59], v[192:195]
    ds_write_b128 v16, v[176:179] offset:3072
    v_mfma_f32_16x16x32_bf16 v[196:199], a[192:195], v[56:59], v[196:199]
    v_mfma_f32_16x16x32_bf16 v[200:203], a[196:199], v[56:59], v[200:203]
    ds_write_b128 v16, v[180:183] offset:4096
    v_mfma_f32_16x16x32_bf16 v[204:207], a[160:163], v[44:47], v[204:207]
    v_mfma_f32_16x16x32_bf16 v[208:211], a[164:167], v[44:47], v[208:211]
    ds_write_b128 v17, v[184:187] offset:5120
    v_mfma_f32_16x16x32_bf16 v[212:215], a[168:171], v[44:47], v[212:215]
    v_mfma_f32_16x16x32_bf16 v[216:219], a[172:175], v[44:47], v[216:219]
    ds_write_b128 v17, v[188:191] offset:6144
    v_mfma_f32_16x16x32_bf16 v[220:223], a[176:179], v[44:47], v[220:223]
    v_mfma_f32_16x16x32_bf16 v[204:207], a[180:183], v[60:63], v[204:207]
    ds_write_b128 v17, v[192:195] offset:7168
    v_mfma_f32_16x16x32_bf16 v[208:211], a[184:187], v[60:63], v[208:211]
    v_mfma_f32_16x16x32_bf16 v[212:215], a[188:191], v[60:63], v[212:215]
    ds_write_b128 v17, v[196:199] offset:8192
    v_mfma_f32_16x16x32_bf16 v[216:219], a[192:195], v[60:63], v[216:219]
    v_mfma_f32_16x16x32_bf16 v[220:223], a[196:199], v[60:63], v[220:223]
    ds_write_b128 v17, v[200:203] offset:9216
    v_mfma_f32_16x16x32_bf16 v[144:147], a[160:163], v[32:35], v[144:147]
    v_mfma_f32_16x16x32_bf16 v[148:151], a[164:167], v[32:35], v[148:151]
    ds_write_b128 v18, v[204:207] offset:10240
    v_mfma_f32_16x16x32_bf16 v[152:155], a[168:171], v[32:35], v[152:155]
    v_mfma_f32_16x16x32_bf16 v[156:159], a[172:175], v[32:35], v[156:159]
    ds_write_b128 v18, v[208:211] offset:11264
    v_mfma_f32_16x16x32_bf16 v[160:163], a[176:179], v[32:35], v[160:163]
    v_mfma_f32_16x16x32_bf16 v[144:147], a[180:183], v[48:51], v[144:147]
    ds_write_b128 v18, v[212:215] offset:12288
    v_mfma_f32_16x16x32_bf16 v[148:151], a[184:187], v[48:51], v[148:151]
    v_mfma_f32_16x16x32_bf16 v[152:155], a[188:191], v[48:51], v[152:155]
    ds_write_b128 v18, v[216:219] offset:13312
    v_mfma_f32_16x16x32_bf16 v[156:159], a[192:195], v[48:51], v[156:159]
    v_mfma_f32_16x16x32_bf16 v[160:163], a[196:199], v[48:51], v[160:163]
    ds_write_b128 v18, v[220:223] offset:14336
    s_waitcnt lgkmcnt(0)
    s_barrier
    ds_read_b128 v[32:35], v19 offset:0
    ds_read_b128 v[36:39], v19 offset:5120
    ds_read_b128 v[40:43], v19 offset:10240
    ds_read_b128 v[44:47], v19 offset:1024
    ds_read_b128 v[48:51], v19 offset:6144
    ds_read_b128 v[52:55], v19 offset:11264
    ds_read_b128 v[56:59], v19 offset:2048
    ds_read_b128 v[60:63], v19 offset:7168
    ds_read_b128 v[64:67], v19 offset:12288
    ds_read_b128 v[68:71], v19 offset:3072
    ds_read_b128 v[72:75], v19 offset:8192
    ds_read_b128 v[76:79], v19 offset:13312
    ds_read_b128 v[80:83], v19 offset:4096
    ds_read_b128 v[84:87], v19 offset:9216
    ds_read_b128 v[88:91], v19 offset:14336
    s_nop 0
    s_waitcnt lgkmcnt(12)
    v_pk_add_f32 v[144:145], v[144:145], v[32:33]
    v_pk_add_f32 v[36:37], v[36:37], v[40:41]
    v_pk_add_f32 v[146:147], v[146:147], v[34:35]
    v_pk_add_f32 v[38:39], v[38:39], v[42:43]
    v_pk_add_f32 v[144:145], v[144:145], v[36:37]
    v_pk_add_f32 v[146:147], v[146:147], v[38:39]
    v_pk_fma_f32 v[144:145], v[144:145], v[106:107], v[108:109] op_sel_hi:[1,0,1]
    v_pk_fma_f32 v[146:147], v[146:147], v[106:107], v[110:111] op_sel_hi:[1,0,1]
    v_cvt_pk_bf16_f32 v144, v144, v145
    v_cvt_pk_bf16_f32 v145, v146, v147
    buffer_store_dwordx2 v[144:145], v15, s[12:15], s77 offen offset:0
    s_nop 0
    s_waitcnt lgkmcnt(9)
    v_pk_add_f32 v[148:149], v[148:149], v[44:45]
    v_pk_add_f32 v[48:49], v[48:49], v[52:53]
    v_pk_add_f32 v[150:151], v[150:151], v[46:47]
    v_pk_add_f32 v[50:51], v[50:51], v[54:55]
    v_pk_add_f32 v[148:149], v[148:149], v[48:49]
    v_pk_add_f32 v[150:151], v[150:151], v[50:51]
    v_pk_fma_f32 v[148:149], v[148:149], v[106:107], v[112:113] op_sel_hi:[1,0,1]
    v_pk_fma_f32 v[150:151], v[150:151], v[106:107], v[114:115] op_sel_hi:[1,0,1]
    v_cvt_pk_bf16_f32 v148, v148, v149
    v_cvt_pk_bf16_f32 v149, v150, v151
    buffer_store_dwordx2 v[148:149], v15, s[12:15], s77 offen offset:32
    s_nop 0
    s_waitcnt lgkmcnt(6)
    v_pk_add_f32 v[152:153], v[152:153], v[56:57]
    v_pk_add_f32 v[60:61], v[60:61], v[64:65]
    v_pk_add_f32 v[154:155], v[154:155], v[58:59]
    v_pk_add_f32 v[62:63], v[62:63], v[66:67]
    v_pk_add_f32 v[152:153], v[152:153], v[60:61]
    v_pk_add_f32 v[154:155], v[154:155], v[62:63]
    v_pk_fma_f32 v[152:153], v[152:153], v[106:107], v[116:117] op_sel_hi:[1,0,1]
    v_pk_fma_f32 v[154:155], v[154:155], v[106:107], v[118:119] op_sel_hi:[1,0,1]
    v_cvt_pk_bf16_f32 v152, v152, v153
    v_cvt_pk_bf16_f32 v153, v154, v155
    buffer_store_dwordx2 v[152:153], v15, s[12:15], s77 offen offset:64
    s_nop 0
    s_waitcnt lgkmcnt(3)
    v_pk_add_f32 v[156:157], v[156:157], v[68:69]
    v_pk_add_f32 v[72:73], v[72:73], v[76:77]
    v_pk_add_f32 v[158:159], v[158:159], v[70:71]
    v_pk_add_f32 v[74:75], v[74:75], v[78:79]
    v_pk_add_f32 v[156:157], v[156:157], v[72:73]
    v_pk_add_f32 v[158:159], v[158:159], v[74:75]
    v_pk_fma_f32 v[156:157], v[156:157], v[106:107], v[120:121] op_sel_hi:[1,0,1]
    v_pk_fma_f32 v[158:159], v[158:159], v[106:107], v[122:123] op_sel_hi:[1,0,1]
    v_cvt_pk_bf16_f32 v156, v156, v157
    v_cvt_pk_bf16_f32 v157, v158, v159
    buffer_store_dwordx2 v[156:157], v15, s[12:15], s77 offen offset:96
    s_nop 0
    s_waitcnt lgkmcnt(0)
    v_pk_add_f32 v[160:161], v[160:161], v[80:81]
    v_pk_add_f32 v[84:85], v[84:85], v[88:89]
    v_pk_add_f32 v[162:163], v[162:163], v[82:83]
    v_pk_add_f32 v[86:87], v[86:87], v[90:91]
    v_pk_add_f32 v[160:161], v[160:161], v[84:85]
    v_pk_add_f32 v[162:163], v[162:163], v[86:87]
    v_pk_fma_f32 v[160:161], v[160:161], v[106:107], v[124:125] op_sel_hi:[1,0,1]
    v_pk_fma_f32 v[162:163], v[162:163], v[106:107], v[126:127] op_sel_hi:[1,0,1]
    v_cvt_pk_bf16_f32 v160, v160, v161
    v_cvt_pk_bf16_f32 v161, v162, v163
    buffer_store_dwordx2 v[160:161], v15, s[12:15], s77 offen offset:128
    s_nop 0
    s_endpgm
L_j15:
    buffer_load_dwordx4 v[144:147], v7, s[8:11], s60 offen offset:0 sc1
    buffer_load_dwordx4 v[148:151], v7, s[8:11], s60 offen offset:256 sc1
    buffer_load_dwordx4 v[152:155], v7, s[8:11], s60 offen offset:2048 sc1
    buffer_load_dwordx4 v[156:159], v7, s[8:11], s60 offen offset:2304 sc1
    s_add_u32 s60, s60, 4096
    buffer_load_dwordx4 v[160:163], v7, s[8:11], s60 offen offset:0 sc1
    buffer_load_dwordx4 v[164:167], v7, s[8:11], s60 offen offset:256 sc1
    buffer_load_dwordx4 v[168:171], v7, s[8:11], s60 offen offset:2048 sc1
    buffer_load_dwordx4 v[172:175], v7, s[8:11], s60 offen offset:2304 sc1
    s_add_u32 s60, s60, 4096
    buffer_load_dwordx4 v[176:179], v7, s[8:11], s60 offen offset:0 sc1
    buffer_load_dwordx4 v[180:183], v7, s[8:11], s60 offen offset:256 sc1
    v_add_u32 v24, 57344, v4
    s_cmp_lg_u32 s2, 255
    s_cbranch_scc1 L_dz31
    s_mov_b32 s14, 128
    v_mov_b32 v23, 0
    v_lshlrev_b32_e64 v3, 2, v0
    buffer_store_dword v23, v3, s[12:15], 0 offen sc1
L_dz31:
    s_mov_b32 s12, s42
    s_mov_b32 s13, s43
    s_mov_b32 s14, 2621440
    s_mov_b32 s15, 0x20000
    v_add_f32 v16, v16, v17
    v_add_f32 v18, v18, v19
    v_add_f32 v20, v20, v21
    v_add_f32 v16, v16, v22
    v_add_f32 v18, v18, v20
    v_lshlrev_b32 v2, 2, v0
    v_add_u32 v2, 162816, v2
    v_add_f32_e64 v16, v16, v18
    ds_write_b32 v2, v16
    s_waitcnt lgkmcnt(0)
    s_barrier
    s_mov_b32 s3, 0x3f803f80
    v_mov_b32 v12, s3
    v_mov_b32 v13, s3
    v_mov_b32 v14, s3
    v_mov_b32 v15, s3
    s_waitcnt vmcnt(8)
    v_swap_b32 v146, v148
    v_swap_b32 v147, v149
    buffer_load_dwordx4 v[184:187], v7, s[8:11], s60 offen offset:2048 sc1
    buffer_load_dwordx4 v[188:191], v7, s[8:11], s60 offen offset:2304 sc1
    s_waitcnt vmcnt(8)
    v_swap_b32 v154, v156
    v_swap_b32 v155, v157
    v_mfma_f32_16x16x32_bf16 v[96:99], v[12:15], v[144:147], 0
    v_mfma_f32_16x16x32_bf16 v[104:107], v[144:147], v[144:147], 0
    v_mfma_f32_16x16x32_bf16 v[100:103], v[12:15], v[148:151], 0
    v_mfma_f32_16x16x32_bf16 v[108:111], v[148:151], v[148:151], 0
    s_addk_i32 s60, 4096
    buffer_load_dwordx4 v[192:195], v7, s[8:11], s60 offen offset:0 sc1
    buffer_load_dwordx4 v[196:199], v7, s[8:11], s60 offen offset:256 sc1
    s_waitcnt vmcnt(8)
    v_swap_b32 v162, v164
    v_swap_b32 v163, v165
    v_mfma_f32_16x16x32_bf16 v[96:99], v[12:15], v[152:155], v[96:99]
    v_mfma_f32_16x16x32_bf16 v[104:107], v[152:155], v[152:155], v[104:107]
    v_mfma_f32_16x16x32_bf16 v[100:103], v[12:15], v[156:159], v[100:103]
    v_mfma_f32_16x16x32_bf16 v[108:111], v[156:159], v[156:159], v[108:111]
    buffer_load_dwordx4 v[200:203], v7, s[8:11], s60 offen offset:2048 sc1
    buffer_load_dwordx4 v[204:207], v7, s[8:11], s60 offen offset:2304 sc1
    s_waitcnt vmcnt(8)
    v_swap_b32 v170, v172
    v_swap_b32 v171, v173
    v_mfma_f32_16x16x32_bf16 v[96:99], v[12:15], v[160:163], v[96:99]
    v_mfma_f32_16x16x32_bf16 v[104:107], v[160:163], v[160:163], v[104:107]
    v_mfma_f32_16x16x32_bf16 v[100:103], v[12:15], v[164:167], v[100:103]
    v_mfma_f32_16x16x32_bf16 v[108:111], v[164:167], v[164:167], v[108:111]
    s_addk_i32 s60, 4096
    buffer_load_dwordx4 v[208:211], v7, s[8:11], s60 offen offset:0 sc1
    buffer_load_dwordx4 v[212:215], v7, s[8:11], s60 offen offset:256 sc1
    s_waitcnt vmcnt(8)
    v_swap_b32 v178, v180
    v_swap_b32 v179, v181
    v_mfma_f32_16x16x32_bf16 v[96:99], v[12:15], v[168:171], v[96:99]
    v_mfma_f32_16x16x32_bf16 v[104:107], v[168:171], v[168:171], v[104:107]
    v_mfma_f32_16x16x32_bf16 v[100:103], v[12:15], v[172:175], v[100:103]
    v_mfma_f32_16x16x32_bf16 v[108:111], v[172:175], v[172:175], v[108:111]
    buffer_load_dwordx4 v[216:219], v7, s[8:11], s60 offen offset:2048 sc1
    buffer_load_dwordx4 v[220:223], v7, s[8:11], s60 offen offset:2304 sc1
    s_waitcnt vmcnt(8)
    v_swap_b32 v186, v188
    v_swap_b32 v187, v189
    v_mfma_f32_16x16x32_bf16 v[96:99], v[12:15], v[176:179], v[96:99]
    v_mfma_f32_16x16x32_bf16 v[104:107], v[176:179], v[176:179], v[104:107]
    v_mfma_f32_16x16x32_bf16 v[100:103], v[12:15], v[180:183], v[100:103]
    v_mfma_f32_16x16x32_bf16 v[108:111], v[180:183], v[180:183], v[108:111]
    s_addk_i32 s60, 4096
    buffer_load_dwordx4 v[224:227], v7, s[8:11], s60 offen offset:0 sc1
    buffer_load_dwordx4 v[228:231], v7, s[8:11], s60 offen offset:256 sc1
    s_waitcnt vmcnt(8)
    v_swap_b32 v194, v196
    v_swap_b32 v195, v197
    v_mfma_f32_16x16x32_bf16 v[96:99], v[12:15], v[184:187], v[96:99]
    v_mfma_f32_16x16x32_bf16 v[104:107], v[184:187], v[184:187], v[104:107]
    v_mfma_f32_16x16x32_bf16 v[100:103], v[12:15], v[188:191], v[100:103]
    v_mfma_f32_16x16x32_bf16 v[108:111], v[188:191], v[188:191], v[108:111]
    buffer_load_dwordx4 v[232:235], v7, s[8:11], s60 offen offset:2048 sc1
    buffer_load_dwordx4 v[236:239], v7, s[8:11], s60 offen offset:2304 sc1
    s_waitcnt vmcnt(8)
    v_swap_b32 v202, v204
    v_swap_b32 v203, v205
    v_mfma_f32_16x16x32_bf16 v[96:99], v[12:15], v[192:195], v[96:99]
    v_mfma_f32_16x16x32_bf16 v[104:107], v[192:195], v[192:195], v[104:107]
    v_mfma_f32_16x16x32_bf16 v[100:103], v[12:15], v[196:199], v[100:103]
    v_mfma_f32_16x16x32_bf16 v[108:111], v[196:199], v[196:199], v[108:111]
    s_addk_i32 s60, 4096
    buffer_load_dwordx4 v[240:243], v7, s[8:11], s60 offen offset:0 sc1
    buffer_load_dwordx4 v[244:247], v7, s[8:11], s60 offen offset:256 sc1
    s_waitcnt vmcnt(8)
    v_swap_b32 v210, v212
    v_swap_b32 v211, v213
    v_mfma_f32_16x16x32_bf16 v[96:99], v[12:15], v[200:203], v[96:99]
    v_mfma_f32_16x16x32_bf16 v[104:107], v[200:203], v[200:203], v[104:107]
    v_mfma_f32_16x16x32_bf16 v[100:103], v[12:15], v[204:207], v[100:103]
    v_mfma_f32_16x16x32_bf16 v[108:111], v[204:207], v[204:207], v[108:111]
    buffer_load_dwordx4 v[248:251], v7, s[8:11], s60 offen offset:2048 sc1
    buffer_load_dwordx4 v[252:255], v7, s[8:11], s60 offen offset:2304 sc1
    s_waitcnt vmcnt(8)
    v_swap_b32 v218, v220
    v_swap_b32 v219, v221
    v_mfma_f32_16x16x32_bf16 v[96:99], v[12:15], v[208:211], v[96:99]
    v_mfma_f32_16x16x32_bf16 v[104:107], v[208:211], v[208:211], v[104:107]
    v_mfma_f32_16x16x32_bf16 v[100:103], v[12:15], v[212:215], v[100:103]
    v_mfma_f32_16x16x32_bf16 v[108:111], v[212:215], v[212:215], v[108:111]
    s_addk_i32 s60, 4096
    buffer_load_dwordx4 v[32:35], v7, s[8:11], s60 offen offset:0 sc1
    buffer_load_dwordx4 v[36:39], v7, s[8:11], s60 offen offset:256 sc1
    s_waitcnt vmcnt(8)
    v_swap_b32 v226, v228
    v_swap_b32 v227, v229
    v_mfma_f32_16x16x32_bf16 v[96:99], v[12:15], v[216:219], v[96:99]
    v_mfma_f32_16x16x32_bf16 v[104:107], v[216:219], v[216:219], v[104:107]
    v_mfma_f32_16x16x32_bf16 v[100:103], v[12:15], v[220:223], v[100:103]
    v_mfma_f32_16x16x32_bf16 v[108:111], v[220:223], v[220:223], v[108:111]
    buffer_load_dwordx4 v[40:43], v7, s[8:11], s60 offen offset:2048 sc1
    buffer_load_dwordx4 v[44:47], v7, s[8:11], s60 offen offset:2304 sc1
    s_waitcnt vmcnt(8)
    v_swap_b32 v234, v236
    v_swap_b32 v235, v237
    v_mfma_f32_16x16x32_bf16 v[96:99], v[12:15], v[224:227], v[96:99]
    v_mfma_f32_16x16x32_bf16 v[104:107], v[224:227], v[224:227], v[104:107]
    v_mfma_f32_16x16x32_bf16 v[100:103], v[12:15], v[228:231], v[100:103]
    v_mfma_f32_16x16x32_bf16 v[108:111], v[228:231], v[228:231], v[108:111]
    s_addk_i32 s60, 4096
    buffer_load_dwordx4 v[48:51], v7, s[8:11], s60 offen offset:0 sc1
    buffer_load_dwordx4 v[52:55], v7, s[8:11], s60 offen offset:256 sc1
    s_waitcnt vmcnt(8)
    v_swap_b32 v242, v244
    v_swap_b32 v243, v245
    v_mfma_f32_16x16x32_bf16 v[96:99], v[12:15], v[232:235], v[96:99]
    v_mfma_f32_16x16x32_bf16 v[104:107], v[232:235], v[232:235], v[104:107]
    v_mfma_f32_16x16x32_bf16 v[100:103], v[12:15], v[236:239], v[100:103]
    v_mfma_f32_16x16x32_bf16 v[108:111], v[236:239], v[236:239], v[108:111]
    buffer_load_dwordx4 v[56:59], v7, s[8:11], s60 offen offset:2048 sc1
    buffer_load_dwordx4 v[60:63], v7, s[8:11], s60 offen offset:2304 sc1
    s_waitcnt vmcnt(8)
    v_swap_b32 v250, v252
    v_swap_b32 v251, v253
    v_mfma_f32_16x16x32_bf16 v[96:99], v[12:15], v[240:243], v[96:99]
    v_mfma_f32_16x16x32_bf16 v[104:107], v[240:243], v[240:243], v[104:107]
    v_mfma_f32_16x16x32_bf16 v[100:103], v[12:15], v[244:247], v[100:103]
    v_mfma_f32_16x16x32_bf16 v[108:111], v[244:247], v[244:247], v[108:111]
    s_addk_i32 s60, 4096
    buffer_load_dwordx4 v[64:67], v7, s[8:11], s60 offen offset:0 sc1
    buffer_load_dwordx4 v[68:71], v7, s[8:11], s60 offen offset:256 sc1
    s_waitcnt vmcnt(8)
    v_swap_b32 v34, v36
    v_swap_b32 v35, v37
    v_mfma_f32_16x16x32_bf16 v[96:99], v[12:15], v[248:251], v[96:99]
    v_mfma_f32_16x16x32_bf16 v[104:107], v[248:251], v[248:251], v[104:107]
    v_mfma_f32_16x16x32_bf16 v[100:103], v[12:15], v[252:255], v[100:103]
    v_mfma_f32_16x16x32_bf16 v[108:111], v[252:255], v[252:255], v[108:111]
    v_accvgpr_write_b32 a0, v32
    v_accvgpr_write_b32 a1, v33
    v_accvgpr_write_b32 a2, v34
    v_accvgpr_write_b32 a3, v35
    v_accvgpr_write_b32 a4, v36
    v_accvgpr_write_b32 a5, v37
    v_accvgpr_write_b32 a6, v38
    v_accvgpr_write_b32 a7, v39
    buffer_load_dwordx4 v[72:75], v7, s[8:11], s60 offen offset:2048 sc1
    buffer_load_dwordx4 v[76:79], v7, s[8:11], s60 offen offset:2304 sc1
    s_waitcnt vmcnt(8)
    v_swap_b32 v42, v44
    v_swap_b32 v43, v45
    v_mfma_f32_16x16x32_bf16 v[96:99], v[12:15], v[32:35], v[96:99]
    v_mfma_f32_16x16x32_bf16 v[104:107], v[32:35], v[32:35], v[104:107]
    v_mfma_f32_16x16x32_bf16 v[100:103], v[12:15], v[36:39], v[100:103]
    v_mfma_f32_16x16x32_bf16 v[108:111], v[36:39], v[36:39], v[108:111]
    v_accvgpr_write_b32 a8, v40
    v_accvgpr_write_b32 a9, v41
    v_accvgpr_write_b32 a10, v42
    v_accvgpr_write_b32 a11, v43
    v_accvgpr_write_b32 a12, v44
    v_accvgpr_write_b32 a13, v45
    v_accvgpr_write_b32 a14, v46
    v_accvgpr_write_b32 a15, v47
    s_waitcnt vmcnt(6)
    v_swap_b32 v50, v52
    v_swap_b32 v51, v53
    v_mfma_f32_16x16x32_bf16 v[96:99], v[12:15], v[40:43], v[96:99]
    v_mfma_f32_16x16x32_bf16 v[104:107], v[40:43], v[40:43], v[104:107]
    v_mfma_f32_16x16x32_bf16 v[100:103], v[12:15], v[44:47], v[100:103]
    v_mfma_f32_16x16x32_bf16 v[108:111], v[44:47], v[44:47], v[108:111]
    v_accvgpr_write_b32 a16, v48
    v_accvgpr_write_b32 a17, v49
    v_accvgpr_write_b32 a18, v50
    v_accvgpr_write_b32 a19, v51
    v_accvgpr_write_b32 a20, v52
    v_accvgpr_write_b32 a21, v53
    v_accvgpr_write_b32 a22, v54
    v_accvgpr_write_b32 a23, v55
    s_waitcnt vmcnt(4)
    v_swap_b32 v58, v60
    v_swap_b32 v59, v61
    v_mfma_f32_16x16x32_bf16 v[96:99], v[12:15], v[48:51], v[96:99]
    v_mfma_f32_16x16x32_bf16 v[104:107], v[48:51], v[48:51], v[104:107]
    v_mfma_f32_16x16x32_bf16 v[100:103], v[12:15], v[52:55], v[100:103]
    v_mfma_f32_16x16x32_bf16 v[108:111], v[52:55], v[52:55], v[108:111]
    v_accvgpr_write_b32 a24, v56
    v_accvgpr_write_b32 a25, v57
    v_accvgpr_write_b32 a26, v58
    v_accvgpr_write_b32 a27, v59
    v_accvgpr_write_b32 a28, v60
    v_accvgpr_write_b32 a29, v61
    v_accvgpr_write_b32 a30, v62
    v_accvgpr_write_b32 a31, v63
    s_waitcnt vmcnt(2)
    v_swap_b32 v66, v68
    v_swap_b32 v67, v69
    v_mfma_f32_16x16x32_bf16 v[96:99], v[12:15], v[56:59], v[96:99]
    v_mfma_f32_16x16x32_bf16 v[104:107], v[56:59], v[56:59], v[104:107]
    v_mfma_f32_16x16x32_bf16 v[100:103], v[12:15], v[60:63], v[100:103]
    v_mfma_f32_16x16x32_bf16 v[108:111], v[60:63], v[60:63], v[108:111]
    v_accvgpr_write_b32 a32, v64
    v_accvgpr_write_b32 a33, v65
    v_accvgpr_write_b32 a34, v66
    v_accvgpr_write_b32 a35, v67
    v_accvgpr_write_b32 a36, v68
    v_accvgpr_write_b32 a37, v69
    v_accvgpr_write_b32 a38, v70
    v_accvgpr_write_b32 a39, v71
    s_waitcnt vmcnt(0)
    v_swap_b32 v74, v76
    v_swap_b32 v75, v77
    v_mfma_f32_16x16x32_bf16 v[96:99], v[12:15], v[64:67], v[96:99]
    v_mfma_f32_16x16x32_bf16 v[104:107], v[64:67], v[64:67], v[104:107]
    v_mfma_f32_16x16x32_bf16 v[100:103], v[12:15], v[68:71], v[100:103]
    v_mfma_f32_16x16x32_bf16 v[108:111], v[68:71], v[68:71], v[108:111]
    v_accvgpr_write_b32 a40, v72
    v_accvgpr_write_b32 a41, v73
    v_accvgpr_write_b32 a42, v74
    v_accvgpr_write_b32 a43, v75
    v_accvgpr_write_b32 a44, v76
    v_accvgpr_write_b32 a45, v77
    v_accvgpr_write_b32 a46, v78
    v_accvgpr_write_b32 a47, v79
    v_mfma_f32_16x16x32_bf16 v[96:99], v[12:15], v[72:75], v[96:99]
    v_mfma_f32_16x16x32_bf16 v[104:107], v[72:75], v[72:75], v[104:107]
    v_mfma_f32_16x16x32_bf16 v[100:103], v[12:15], v[76:79], v[100:103]
    v_mfma_f32_16x16x32_bf16 v[108:111], v[76:79], v[76:79], v[108:111]
    v_and_b32 v2, 3, v1
    v_cmp_eq_u32 s[56:57], 1, v2
    v_cmp_eq_u32 s[58:59], 2, v2
    v_cmp_eq_u32 s[74:75], 3, v2
    v_bfe_u32 v2, v1, 2, 2
    v_lshrrev_b32_e64 v3, 4, v1
    v_cmp_eq_u32 s[76:77], v2, v3
    v_cndmask_b32 v104, v104, v105, s[56:57]
    v_cndmask_b32 v104, v104, v106, s[58:59]
    v_cndmask_b32 v104, v104, v107, s[74:75]
    s_mov_b32 s3, 0x3acccccd
    v_mul_f32 v96, s3, v96
    v_mul_f32 v104, s3, v104
    v_fma_f32 v104, -v96, v96, v104
    v_max_f32_e64 v104, 0, v104
    v_cvt_pk_bf16_f32 v104, v104, v104
    v_lshlrev_b32_e64 v104, 16, v104
    v_add_f32 v104, 0x3727c5ac, v104
    v_cvt_pk_bf16_f32 v104, v104, v104
    v_lshlrev_b32_e64 v104, 16, v104
    v_sqrt_f32 v104, v104
    s_nop 0
    v_cvt_pk_bf16_f32 v16, v96, v104
    v_cndmask_b32 v108, v108, v109, s[56:57]
    v_cndmask_b32 v108, v108, v110, s[58:59]
    v_cndmask_b32 v108, v108, v111, s[74:75]
    s_mov_b32 s3, 0x3acccccd
    v_mul_f32 v100, s3, v100
    v_mul_f32 v108, s3, v108
    v_fma_f32 v108, -v100, v100, v108
    v_max_f32_e64 v108, 0, v108
    v_cvt_pk_bf16_f32 v108, v108, v108
    v_lshlrev_b32_e64 v108, 16, v108
    v_add_f32 v108, 0x3727c5ac, v108
    v_cvt_pk_bf16_f32 v108, v108, v108
    v_lshlrev_b32_e64 v108, 16, v108
    v_sqrt_f32 v108, v108
    s_nop 0
    v_cvt_pk_bf16_f32 v18, v100, v108
    v_mov_b32 v17, s0
    v_mov_b32 v19, s1
    s_mov_b64 exec, s[76:77]
    buffer_store_dwordx4 v[16:19], v9, s[8:11], s72 offen sc1
    s_mov_b64 exec, -1
    ds_read_b128 a[48:51], v4 offset:0
    ds_read_b128 a[52:55], v4 offset:1024
    ds_read_b128 a[56:59], v4 offset:2048
    ds_read_b128 a[60:63], v4 offset:3072
    ds_read_b128 a[64:67], v4 offset:4096
    ds_read_b128 a[68:71], v4 offset:5120
    ds_read_b128 a[72:75], v4 offset:6144
    s_waitcnt lgkmcnt(3)
    v_mfma_f32_16x16x32_bf16 v[32:35], a[48:51], v[144:147], 0
    ds_read_b128 a[76:79], v4 offset:7168
    v_mfma_f32_16x16x32_bf16 v[36:39], a[48:51], v[148:151], 0
    v_mfma_f32_16x16x32_bf16 v[40:43], a[52:55], v[144:147], 0
    ds_read_b128 a[48:51], v4 offset:8192
    v_mfma_f32_16x16x32_bf16 v[44:47], a[52:55], v[148:151], 0
    v_mfma_f32_16x16x32_bf16 v[48:51], a[56:59], v[144:147], 0
    ds_read_b128 a[52:55], v4 offset:9216
    v_mfma_f32_16x16x32_bf16 v[52:55], a[56:59], v[148:151], 0
    v_mfma_f32_16x16x32_bf16 v[56:59], a[60:63], v[144:147], 0
    ds_read_b128 a[56:59], v4 offset:10240
    v_mfma_f32_16x16x32_bf16 v[60:63], a[60:63], v[148:151], 0
    s_waitcnt lgkmcnt(3)
    v_mfma_f32_16x16x32_bf16 v[32:35], a[64:67], v[152:155], v[32:35]
    ds_read_b128 a[60:63], v4 offset:11264
    v_mfma_f32_16x16x32_bf16 v[36:39], a[64:67], v[156:159], v[36:39]
    v_mfma_f32_16x16x32_bf16 v[40:43], a[68:71], v[152:155], v[40:43]
    ds_read_b128 a[64:67], v4 offset:12288
    v_mfma_f32_16x16x32_bf16 v[44:47], a[68:71], v[156:159], v[44:47]
    v_mfma_f32_16x16x32_bf16 v[48:51], a[72:75], v[152:155], v[48:51]
    ds_read_b128 a[68:71], v4 offset:13312
    v_mfma_f32_16x16x32_bf16 v[52:55], a[72:75], v[156:159], v[52:55]
    v_mfma_f32_16x16x32_bf16 v[56:59], a[76:79], v[152:155], v[56:59]
    ds_read_b128 a[72:75], v4 offset:14336
    v_mfma_f32_16x16x32_bf16 v[60:63], a[76:79], v[156:159], v[60:63]
    s_waitcnt lgkmcnt(3)
    v_mfma_f32_16x16x32_bf16 v[32:35], a[48:51], v[160:163], v[32:35]
    ds_read_b128 a[76:79], v4 offset:15360
    v_mfma_f32_16x16x32_bf16 v[36:39], a[48:51], v[164:167], v[36:39]
    v_mfma_f32_16x16x32_bf16 v[40:43], a[52:55], v[160:163], v[40:43]
    ds_read_b128 a[48:51], v4 offset:16384
    v_mfma_f32_16x16x32_bf16 v[44:47], a[52:55], v[164:167], v[44:47]
    v_mfma_f32_16x16x32_bf16 v[48:51], a[56:59], v[160:163], v[48:51]
    ds_read_b128 a[52:55], v4 offset:17408
    v_mfma_f32_16x16x32_bf16 v[52:55], a[56:59], v[164:167], v[52:55]
    v_mfma_f32_16x16x32_bf16 v[56:59], a[60:63], v[160:163], v[56:59]
    ds_read_b128 a[56:59], v4 offset:18432
    v_mfma_f32_16x16x32_bf16 v[60:63], a[60:63], v[164:167], v[60:63]
    s_waitcnt lgkmcnt(3)
    v_mfma_f32_16x16x32_bf16 v[32:35], a[64:67], v[168:171], v[32:35]
    ds_read_b128 a[60:63], v4 offset:19456
    v_mfma_f32_16x16x32_bf16 v[36:39], a[64:67], v[172:175], v[36:39]
    v_mfma_f32_16x16x32_bf16 v[40:43], a[68:71], v[168:171], v[40:43]
    ds_read_b128 a[64:67], v4 offset:20480
    v_mfma_f32_16x16x32_bf16 v[44:47], a[68:71], v[172:175], v[44:47]
    v_mfma_f32_16x16x32_bf16 v[48:51], a[72:75], v[168:171], v[48:51]
    ds_read_b128 a[68:71], v4 offset:21504
    v_mfma_f32_16x16x32_bf16 v[52:55], a[72:75], v[172:175], v[52:55]
    v_mfma_f32_16x16x32_bf16 v[56:59], a[76:79], v[168:171], v[56:59]
    ds_read_b128 a[72:75], v4 offset:22528
    v_mfma_f32_16x16x32_bf16 v[60:63], a[76:79], v[172:175], v[60:63]
    s_waitcnt lgkmcnt(3)
    v_mfma_f32_16x16x32_bf16 v[32:35], a[48:51], v[176:179], v[32:35]
    ds_read_b128 a[76:79], v4 offset:23552
    v_mfma_f32_16x16x32_bf16 v[36:39], a[48:51], v[180:183], v[36:39]
    v_mfma_f32_16x16x32_bf16 v[40:43], a[52:55], v[176:179], v[40:43]
    ds_read_b128 a[48:51], v4 offset:24576
    v_mfma_f32_16x16x32_bf16 v[44:47], a[52:55], v[180:183], v[44:47]
    v_mfma_f32_16x16x32_bf16 v[48:51], a[56:59], v[176:179], v[48:51]
    ds_read_b128 a[52:55], v4 offset:25600
    v_mfma_f32_16x16x32_bf16 v[52:55], a[56:59], v[180:183], v[52:55]
    v_mfma_f32_16x16x32_bf16 v[56:59], a[60:63], v[176:179], v[56:59]
    ds_read_b128 a[56:59], v4 offset:26624
    v_mfma_f32_16x16x32_bf16 v[60:63], a[60:63], v[180:183], v[60:63]
    s_waitcnt lgkmcnt(3)
    v_mfma_f32_16x16x32_bf16 v[32:35], a[64:67], v[184:187], v[32:35]
    ds_read_b128 a[60:63], v4 offset:27648
    v_mfma_f32_16x16x32_bf16 v[36:39], a[64:67], v[188:191], v[36:39]
    v_mfma_f32_16x16x32_bf16 v[40:43], a[68:71], v[184:187], v[40:43]
    ds_read_b128 a[64:67], v4 offset:28672
    v_mfma_f32_16x16x32_bf16 v[44:47], a[68:71], v[188:191], v[44:47]
    v_mfma_f32_16x16x32_bf16 v[48:51], a[72:75], v[184:187], v[48:51]
    ds_read_b128 a[68:71], v4 offset:29696
    v_mfma_f32_16x16x32_bf16 v[52:55], a[72:75], v[188:191], v[52:55]
    v_mfma_f32_16x16x32_bf16 v[56:59], a[76:79], v[184:187], v[56:59]
    ds_read_b128 a[72:75], v4 offset:30720
    v_mfma_f32_16x16x32_bf16 v[60:63], a[76:79], v[188:191], v[60:63]
    s_waitcnt lgkmcnt(3)
    v_mfma_f32_16x16x32_bf16 v[32:35], a[48:51], v[192:195], v[32:35]
    ds_read_b128 a[76:79], v4 offset:31744
    v_mfma_f32_16x16x32_bf16 v[36:39], a[48:51], v[196:199], v[36:39]
    v_mfma_f32_16x16x32_bf16 v[40:43], a[52:55], v[192:195], v[40:43]
    ds_read_b128 a[48:51], v4 offset:32768
    v_mfma_f32_16x16x32_bf16 v[44:47], a[52:55], v[196:199], v[44:47]
    v_mfma_f32_16x16x32_bf16 v[48:51], a[56:59], v[192:195], v[48:51]
    ds_read_b128 a[52:55], v4 offset:33792
    v_mfma_f32_16x16x32_bf16 v[52:55], a[56:59], v[196:199], v[52:55]
    v_mfma_f32_16x16x32_bf16 v[56:59], a[60:63], v[192:195], v[56:59]
    ds_read_b128 a[56:59], v4 offset:34816
    v_mfma_f32_16x16x32_bf16 v[60:63], a[60:63], v[196:199], v[60:63]
    s_waitcnt lgkmcnt(3)
    v_mfma_f32_16x16x32_bf16 v[32:35], a[64:67], v[200:203], v[32:35]
    ds_read_b128 a[60:63], v4 offset:35840
    v_mfma_f32_16x16x32_bf16 v[36:39], a[64:67], v[204:207], v[36:39]
    v_mfma_f32_16x16x32_bf16 v[40:43], a[68:71], v[200:203], v[40:43]
    ds_read_b128 a[64:67], v4 offset:36864
    v_mfma_f32_16x16x32_bf16 v[44:47], a[68:71], v[204:207], v[44:47]
    v_mfma_f32_16x16x32_bf16 v[48:51], a[72:75], v[200:203], v[48:51]
    ds_read_b128 a[68:71], v4 offset:37888
    v_mfma_f32_16x16x32_bf16 v[52:55], a[72:75], v[204:207], v[52:55]
    v_mfma_f32_16x16x32_bf16 v[56:59], a[76:79], v[200:203], v[56:59]
    ds_read_b128 a[72:75], v4 offset:38912
    v_mfma_f32_16x16x32_bf16 v[60:63], a[76:79], v[204:207], v[60:63]
    s_waitcnt lgkmcnt(3)
    v_mfma_f32_16x16x32_bf16 v[32:35], a[48:51], v[208:211], v[32:35]
    ds_read_b128 a[76:79], v4 offset:39936
    v_mfma_f32_16x16x32_bf16 v[36:39], a[48:51], v[212:215], v[36:39]
    v_mfma_f32_16x16x32_bf16 v[40:43], a[52:55], v[208:211], v[40:43]
    ds_read_b128 a[48:51], v4 offset:40960
    v_mfma_f32_16x16x32_bf16 v[44:47], a[52:55], v[212:215], v[44:47]
    v_mfma_f32_16x16x32_bf16 v[48:51], a[56:59], v[208:211], v[48:51]
    ds_read_b128 a[52:55], v4 offset:41984
    v_mfma_f32_16x16x32_bf16 v[52:55], a[56:59], v[212:215], v[52:55]
    v_mfma_f32_16x16x32_bf16 v[56:59], a[60:63], v[208:211], v[56:59]
    ds_read_b128 a[56:59], v4 offset:43008
    v_mfma_f32_16x16x32_bf16 v[60:63], a[60:63], v[212:215], v[60:63]
    s_waitcnt lgkmcnt(3)
    v_mfma_f32_16x16x32_bf16 v[32:35], a[64:67], v[216:219], v[32:35]
    ds_read_b128 a[60:63], v4 offset:44032
    v_mfma_f32_16x16x32_bf16 v[36:39], a[64:67], v[220:223], v[36:39]
    v_mfma_f32_16x16x32_bf16 v[40:43], a[68:71], v[216:219], v[40:43]
    ds_read_b128 a[64:67], v4 offset:45056
    v_mfma_f32_16x16x32_bf16 v[44:47], a[68:71], v[220:223], v[44:47]
    v_mfma_f32_16x16x32_bf16 v[48:51], a[72:75], v[216:219], v[48:51]
    ds_read_b128 a[68:71], v4 offset:46080
    v_mfma_f32_16x16x32_bf16 v[52:55], a[72:75], v[220:223], v[52:55]
    v_mfma_f32_16x16x32_bf16 v[56:59], a[76:79], v[216:219], v[56:59]
    ds_read_b128 a[72:75], v4 offset:47104
    v_mfma_f32_16x16x32_bf16 v[60:63], a[76:79], v[220:223], v[60:63]
    s_waitcnt lgkmcnt(3)
    v_mfma_f32_16x16x32_bf16 v[32:35], a[48:51], v[224:227], v[32:35]
    ds_read_b128 a[76:79], v4 offset:48128
    v_mfma_f32_16x16x32_bf16 v[36:39], a[48:51], v[228:231], v[36:39]
    v_mfma_f32_16x16x32_bf16 v[40:43], a[52:55], v[224:227], v[40:43]
    ds_read_b128 a[48:51], v4 offset:49152
    v_mfma_f32_16x16x32_bf16 v[44:47], a[52:55], v[228:231], v[44:47]
    v_mfma_f32_16x16x32_bf16 v[48:51], a[56:59], v[224:227], v[48:51]
    ds_read_b128 a[52:55], v4 offset:50176
    v_mfma_f32_16x16x32_bf16 v[52:55], a[56:59], v[228:231], v[52:55]
    v_mfma_f32_16x16x32_bf16 v[56:59], a[60:63], v[224:227], v[56:59]
    ds_read_b128 a[56:59], v4 offset:51200
    v_mfma_f32_16x16x32_bf16 v[60:63], a[60:63], v[228:231], v[60:63]
    s_waitcnt lgkmcnt(3)
    v_mfma_f32_16x16x32_bf16 v[32:35], a[64:67], v[232:235], v[32:35]
    ds_read_b128 a[60:63], v4 offset:52224
    v_mfma_f32_16x16x32_bf16 v[36:39], a[64:67], v[236:239], v[36:39]
    v_mfma_f32_16x16x32_bf16 v[40:43], a[68:71], v[232:235], v[40:43]
    ds_read_b128 a[64:67], v4 offset:53248
    v_mfma_f32_16x16x32_bf16 v[44:47], a[68:71], v[236:239], v[44:47]
    v_mfma_f32_16x16x32_bf16 v[48:51], a[72:75], v[232:235], v[48:51]
    ds_read_b128 a[68:71], v4 offset:54272
    v_mfma_f32_16x16x32_bf16 v[52:55], a[72:75], v[236:239], v[52:55]
    v_mfma_f32_16x16x32_bf16 v[56:59], a[76:79], v[232:235], v[56:59]
    ds_read_b128 a[72:75], v4 offset:55296
    v_mfma_f32_16x16x32_bf16 v[60:63], a[76:79], v[236:239], v[60:63]
    s_waitcnt lgkmcnt(3)
    v_mfma_f32_16x16x32_bf16 v[32:35], a[48:51], v[240:243], v[32:35]
    ds_read_b128 a[76:79], v4 offset:56320
    v_mfma_f32_16x16x32_bf16 v[36:39], a[48:51], v[244:247], v[36:39]
    v_mfma_f32_16x16x32_bf16 v[40:43], a[52:55], v[240:243], v[40:43]
    ds_read_b128 a[48:51], v4 offset:57344
    v_mfma_f32_16x16x32_bf16 v[44:47], a[52:55], v[244:247], v[44:47]
    v_mfma_f32_16x16x32_bf16 v[48:51], a[56:59], v[240:243], v[48:51]
    ds_read_b128 a[52:55], v4 offset:58368
    v_mfma_f32_16x16x32_bf16 v[52:55], a[56:59], v[244:247], v[52:55]
    v_mfma_f32_16x16x32_bf16 v[56:59], a[60:63], v[240:243], v[56:59]
    ds_read_b128 a[56:59], v4 offset:59392
    v_mfma_f32_16x16x32_bf16 v[60:63], a[60:63], v[244:247], v[60:63]
    s_waitcnt lgkmcnt(3)
    v_mfma_f32_16x16x32_bf16 v[32:35], a[64:67], v[248:251], v[32:35]
    ds_read_b128 a[60:63], v4 offset:60416
    v_mfma_f32_16x16x32_bf16 v[36:39], a[64:67], v[252:255], v[36:39]
    v_mfma_f32_16x16x32_bf16 v[40:43], a[68:71], v[248:251], v[40:43]
    ds_read_b128 a[64:67], v4 offset:61440
    v_mfma_f32_16x16x32_bf16 v[44:47], a[68:71], v[252:255], v[44:47]
    v_mfma_f32_16x16x32_bf16 v[48:51], a[72:75], v[248:251], v[48:51]
    ds_read_b128 a[68:71], v4 offset:62464
    v_mfma_f32_16x16x32_bf16 v[52:55], a[72:75], v[252:255], v[52:55]
    v_mfma_f32_16x16x32_bf16 v[56:59], a[76:79], v[248:251], v[56:59]
    ds_read_b128 a[72:75], v4 offset:63488
    v_mfma_f32_16x16x32_bf16 v[60:63], a[76:79], v[252:255], v[60:63]
    s_waitcnt lgkmcnt(3)
    v_mfma_f32_16x16x32_bf16 v[32:35], a[48:51], a[0:3], v[32:35]
    ds_read_b128 a[76:79], v4 offset:64512
    v_mfma_f32_16x16x32_bf16 v[36:39], a[48:51], a[4:7], v[36:39]
    v_mfma_f32_16x16x32_bf16 v[40:43], a[52:55], a[0:3], v[40:43]
    ds_read_b128 a[48:51], v5 offset:0
    v_mfma_f32_16x16x32_bf16 v[44:47], a[52:55], a[4:7], v[44:47]
    v_mfma_f32_16x16x32_bf16 v[48:51], a[56:59], a[0:3], v[48:51]
    ds_read_b128 a[52:55], v5 offset:1024
    v_mfma_f32_16x16x32_bf16 v[52:55], a[56:59], a[4:7], v[52:55]
    v_mfma_f32_16x16x32_bf16 v[56:59], a[60:63], a[0:3], v[56:59]
    ds_read_b128 a[56:59], v5 offset:2048
    v_mfma_f32_16x16x32_bf16 v[60:63], a[60:63], a[4:7], v[60:63]
    s_waitcnt lgkmcnt(3)
    v_mfma_f32_16x16x32_bf16 v[32:35], a[64:67], a[8:11], v[32:35]
    ds_read_b128 a[60:63], v5 offset:3072
    v_mfma_f32_16x16x32_bf16 v[36:39], a[64:67], a[12:15], v[36:39]
    v_mfma_f32_16x16x32_bf16 v[40:43], a[68:71], a[8:11], v[40:43]
    ds_read_b128 a[64:67], v5 offset:4096
    v_mfma_f32_16x16x32_bf16 v[44:47], a[68:71], a[12:15], v[44:47]
    v_mfma_f32_16x16x32_bf16 v[48:51], a[72:75], a[8:11], v[48:51]
    ds_read_b128 a[68:71], v5 offset:5120
    v_mfma_f32_16x16x32_bf16 v[52:55], a[72:75], a[12:15], v[52:55]
    v_mfma_f32_16x16x32_bf16 v[56:59], a[76:79], a[8:11], v[56:59]
    ds_read_b128 a[72:75], v5 offset:6144
    v_mfma_f32_16x16x32_bf16 v[60:63], a[76:79], a[12:15], v[60:63]
    s_waitcnt lgkmcnt(3)
    v_mfma_f32_16x16x32_bf16 v[32:35], a[48:51], a[16:19], v[32:35]
    ds_read_b128 a[76:79], v5 offset:7168
    v_mfma_f32_16x16x32_bf16 v[36:39], a[48:51], a[20:23], v[36:39]
    v_mfma_f32_16x16x32_bf16 v[40:43], a[52:55], a[16:19], v[40:43]
    ds_read_b128 a[48:51], v5 offset:8192
    v_mfma_f32_16x16x32_bf16 v[44:47], a[52:55], a[20:23], v[44:47]
    v_mfma_f32_16x16x32_bf16 v[48:51], a[56:59], a[16:19], v[48:51]
    ds_read_b128 a[52:55], v5 offset:9216
    v_mfma_f32_16x16x32_bf16 v[52:55], a[56:59], a[20:23], v[52:55]
    v_mfma_f32_16x16x32_bf16 v[56:59], a[60:63], a[16:19], v[56:59]
    ds_read_b128 a[56:59], v5 offset:10240
    v_mfma_f32_16x16x32_bf16 v[60:63], a[60:63], a[20:23], v[60:63]
    s_waitcnt lgkmcnt(3)
    v_mfma_f32_16x16x32_bf16 v[32:35], a[64:67], a[24:27], v[32:35]
    ds_read_b128 a[60:63], v5 offset:11264
    v_mfma_f32_16x16x32_bf16 v[36:39], a[64:67], a[28:31], v[36:39]
    v_mfma_f32_16x16x32_bf16 v[40:43], a[68:71], a[24:27], v[40:43]
    ds_read_b128 a[64:67], v5 offset:12288
    v_mfma_f32_16x16x32_bf16 v[44:47], a[68:71], a[28:31], v[44:47]
    v_mfma_f32_16x16x32_bf16 v[48:51], a[72:75], a[24:27], v[48:51]
    ds_read_b128 a[68:71], v5 offset:13312
    v_mfma_f32_16x16x32_bf16 v[52:55], a[72:75], a[28:31], v[52:55]
    v_mfma_f32_16x16x32_bf16 v[56:59], a[76:79], a[24:27], v[56:59]
    ds_read_b128 a[72:75], v5 offset:14336
    v_mfma_f32_16x16x32_bf16 v[60:63], a[76:79], a[28:31], v[60:63]
    s_waitcnt lgkmcnt(3)
    v_mfma_f32_16x16x32_bf16 v[32:35], a[48:51], a[32:35], v[32:35]
    ds_read_b128 a[76:79], v5 offset:15360
    v_mfma_f32_16x16x32_bf16 v[36:39], a[48:51], a[36:39], v[36:39]
    buffer_load_dwordx4 v[28:31], v9, s[8:11], s72 offen sc1
    v_mfma_f32_16x16x32_bf16 v[40:43], a[52:55], a[32:35], v[40:43]
    ds_read_b128 a[48:51], v5 offset:16384
    v_mfma_f32_16x16x32_bf16 v[44:47], a[52:55], a[36:39], v[44:47]
    v_mfma_f32_16x16x32_bf16 v[48:51], a[56:59], a[32:35], v[48:51]
    ds_read_b128 a[52:55], v5 offset:17408
    v_mfma_f32_16x16x32_bf16 v[52:55], a[56:59], a[36:39], v[52:55]
    v_mfma_f32_16x16x32_bf16 v[56:59], a[60:63], a[32:35], v[56:59]
    ds_read_b128 a[56:59], v5 offset:18432
    v_mfma_f32_16x16x32_bf16 v[60:63], a[60:63], a[36:39], v[60:63]
    s_waitcnt lgkmcnt(3)
    v_mfma_f32_16x16x32_bf16 v[32:35], a[64:67], a[40:43], v[32:35]
    ds_read_b128 a[60:63], v5 offset:19456
    v_mfma_f32_16x16x32_bf16 v[36:39], a[64:67], a[44:47], v[36:39]
    ds_read_b128 v[16:19], v8 offset:0
    ds_read_b128 v[20:23], v8 offset:448
    v_mfma_f32_16x16x32_bf16 v[40:43], a[68:71], a[40:43], v[40:43]
    ds_read_b128 a[64:67], v5 offset:20480
    v_mfma_f32_16x16x32_bf16 v[44:47], a[68:71], a[44:47], v[44:47]
    v_mfma_f32_16x16x32_bf16 v[48:51], a[72:75], a[40:43], v[48:51]
    ds_read_b128 a[68:71], v5 offset:21504
    v_mfma_f32_16x16x32_bf16 v[52:55], a[72:75], a[44:47], v[52:55]
    v_mfma_f32_16x16x32_bf16 v[56:59], a[76:79], a[40:43], v[56:59]
    ds_read_b128 a[72:75], v5 offset:22528
    v_mfma_f32_16x16x32_bf16 v[60:63], a[76:79], a[44:47], v[60:63]
    s_waitcnt vmcnt(0)
    v_xor_b32 v26, s0, v29
    v_xor_b32 v27, s1, v31
    v_or_b32 v26, v26, v27
    v_cmp_ne_u32_e64 vcc, 0, v26
    s_cbranch_vccz L_ok33
    s_mov_b32 s3, 0
L_poll32:
    buffer_load_dwordx4 v[28:31], v9, s[8:11], s72 offen sc1
    s_waitcnt vmcnt(0)
    v_xor_b32 v26, s0, v29
    v_xor_b32 v27, s1, v31
    v_or_b32 v26, v26, v27
    v_cmp_ne_u32 vcc, 0, v26
    s_add_u32 s3, s3, 1
    s_cmp_gt_u32 s3, 1000000
    s_cbranch_scc1 L_ok33
    s_cbranch_vccnz L_poll32
L_ok33:
    v_lshlrev_b32 v12, 16, v28
    v_lshlrev_b32 v13, 16, v30
    v_xor_b32 v12, 0x80000000, v12
    v_xor_b32 v13, 0x80000000, v13
    s_barrier
    s_waitcnt lgkmcnt(5)
    v_mfma_f32_16x16x32_bf16 v[128:131], a[48:51], v[144:147], 0
    ds_read_b128 a[76:79], v5 offset:23552
    s_add_u32 m0, s62, 0
    s_addk_i32 s63, 4096
    buffer_load_dwordx4 v4, s[8:11], s63 offen offset:0 sc1 lds
    s_waitcnt lgkmcnt(4)
    v_fmac_f32 v32, v16, v12
    v_fmac_f32_e64 v33, v17, v12
    v_mfma_f32_16x16x32_bf16 v[132:135], a[48:51], v[148:151], 0
    v_fmac_f32 v34, v18, v12
    v_fmac_f32 v35, v19, v12
    v_fmac_f32 v40, v20, v12
    v_fmac_f32 v41, v21, v12
    v_fmac_f32 v42, v22, v12
    v_fmac_f32 v43, v23, v12
    v_max_f32_e64 v32, 0, v32
    v_mfma_f32_16x16x32_bf16 v[136:139], a[52:55], v[144:147], 0
    ds_read_b128 a[48:51], v5 offset:24576
    v_mfma_f32_16x16x32_bf16 v[140:143], a[52:55], v[148:151], 0
    v_mfma_f32_16x16x32_bf16 v[128:131], a[56:59], v[152:155], v[128:131]
    ds_read_b128 a[52:55], v5 offset:25600
    buffer_load_dwordx4 v4, s[8:11], s63 offen offset:1024 sc1 lds
    v_max_f32 v33, 0, v33
    v_max_f32 v34, 0, v34
    v_max_f32 v35, 0, v35
    v_mul_f32 v32, v32, v40
    v_mfma_f32_16x16x32_bf16 v[132:135], a[56:59], v[156:159], v[132:135]
    v_mul_f32 v33, v33, v41
    v_mul_f32 v34, v34, v42
    v_mul_f32_e64 v35, v35, v43
    v_cvt_pk_bf16_f32 v40, v32, v33
    v_cvt_pk_bf16_f32 v41, v34, v35
    v_fmac_f32 v36, v16, v13
    v_mfma_f32_16x16x32_bf16 v[136:139], a[60:63], v[152:155], v[136:139]
    ds_read_b128 a[56:59], v5 offset:26624
    v_mfma_f32_16x16x32_bf16 v[140:143], a[60:63], v[156:159], v[140:143]
    s_waitcnt lgkmcnt(3)
    v_mfma_f32_16x16x32_bf16 v[128:131], a[64:67], v[160:163], v[128:131]
    ds_read_b128 a[60:63], v5 offset:27648
    buffer_load_dwordx4 v4, s[8:11], s63 offen offset:2048 sc1 lds
    v_fmac_f32 v37, v17, v13
    v_fmac_f32 v38, v18, v13
    v_fmac_f32 v39, v19, v13
    v_fmac_f32 v44, v20, v13
    v_mfma_f32_16x16x32_bf16 v[132:135], a[64:67], v[164:167], v[132:135]
    v_fmac_f32 v45, v21, v13
    v_fmac_f32 v46, v22, v13
    v_fmac_f32_e64 v47, v23, v13
    ds_read_b128 v[16:19], v8 offset:64
    ds_read_b128 v[20:23], v8 offset:512
    v_max_f32 v36, 0, v36
    v_max_f32 v37, 0, v37
    v_mfma_f32_16x16x32_bf16 v[136:139], a[68:71], v[160:163], v[136:139]
    ds_read_b128 a[64:67], v5 offset:28672
    v_mfma_f32_16x16x32_bf16 v[140:143], a[68:71], v[164:167], v[140:143]
    v_mfma_f32_16x16x32_bf16 v[128:131], a[72:75], v[168:171], v[128:131]
    ds_read_b128 a[68:71], v5 offset:29696
    buffer_load_dwordx4 v4, s[8:11], s63 offen offset:3072 sc1 lds
    v_max_f32 v38, 0, v38
    v_max_f32 v39, 0, v39
    v_mul_f32 v36, v36, v44
    v_mul_f32 v37, v37, v45
    v_mfma_f32_16x16x32_bf16 v[132:135], a[72:75], v[172:175], v[132:135]
    v_mul_f32_e64 v38, v38, v46
    v_mul_f32 v39, v39, v47
    v_cvt_pk_bf16_f32 v44, v36, v37
    v_cvt_pk_bf16_f32 v45, v38, v39
    s_waitcnt lgkmcnt(2)
    v_mfma_f32_16x16x32_bf16 v[136:139], a[76:79], v[168:171], v[136:139]
    ds_read_b128 a[72:75], v5 offset:30720
    v_mfma_f32_16x16x32_bf16 v[140:143], a[76:79], v[172:175], v[140:143]
    v_mfma_f32_16x16x32_bf16 v[128:131], a[48:51], v[176:179], v[128:131]
    ds_read_b128 a[76:79], v5 offset:31744
    s_add_u32 m0, s62, 147456
    s_add_u32 s63, s63, 4096
    buffer_load_dwordx4 v4, s[8:11], s63 offen offset:0 sc1 lds
    v_fmac_f32 v48, v16, v12
    v_fmac_f32 v49, v17, v12
    v_fmac_f32_e64 v50, v18, v12
    v_mfma_f32_16x16x32_bf16 v[132:135], a[48:51], v[180:183], v[132:135]
    v_fmac_f32 v51, v19, v12
    v_fmac_f32 v56, v20, v12
    v_fmac_f32 v57, v21, v12
    v_fmac_f32 v58, v22, v12
    v_fmac_f32 v59, v23, v12
    v_max_f32 v48, 0, v48
    v_max_f32_e64 v49, 0, v49
    v_mfma_f32_16x16x32_bf16 v[136:139], a[52:55], v[176:179], v[136:139]
    ds_read_b128 a[48:51], v5 offset:32768
    v_mfma_f32_16x16x32_bf16 v[140:143], a[52:55], v[180:183], v[140:143]
    v_mfma_f32_16x16x32_bf16 v[128:131], a[56:59], v[184:187], v[128:131]
    ds_read_b128 a[52:55], v5 offset:33792
    buffer_load_dwordx4 v4, s[8:11], s63 offen offset:1024 sc1 lds
    v_max_f32 v50, 0, v50
    v_max_f32 v51, 0, v51
    v_mul_f32 v48, v48, v56
    v_mul_f32 v49, v49, v57
    v_mfma_f32_16x16x32_bf16 v[132:135], a[56:59], v[188:191], v[132:135]
    v_mul_f32 v50, v50, v58
    v_mul_f32 v51, v51, v59
    v_cvt_pk_bf16_f32 v42, v48, v49
    v_cvt_pk_bf16_f32 v43, v50, v51
    buffer_store_dwordx4 v[40:43], v4, s[8:11], s68 offen sc1
    v_fmac_f32 v52, v16, v13
    v_mfma_f32_16x16x32_bf16 v[136:139], a[60:63], v[184:187], v[136:139]
    ds_read_b128 a[56:59], v5 offset:34816
    v_mfma_f32_16x16x32_bf16 v[140:143], a[60:63], v[188:191], v[140:143]
    s_waitcnt lgkmcnt(3)
    v_mfma_f32_16x16x32_bf16 v[128:131], a[64:67], v[192:195], v[128:131]
    ds_read_b128 a[60:63], v5 offset:35840
    buffer_load_dwordx4 v4, s[8:11], s63 offen offset:2048 sc1 lds
    v_fmac_f32 v53, v17, v13
    v_fmac_f32 v54, v18, v13
    v_fmac_f32 v55, v19, v13
    v_fmac_f32 v60, v20, v13
    v_mfma_f32_16x16x32_bf16 v[132:135], a[64:67], v[196:199], v[132:135]
    v_fmac_f32 v61, v21, v13
    v_fmac_f32 v62, v22, v13
    v_fmac_f32 v63, v23, v13
    v_max_f32 v52, 0, v52
    v_max_f32_e64 v53, 0, v53
    v_mfma_f32_16x16x32_bf16 v[136:139], a[68:71], v[192:195], v[136:139]
    ds_read_b128 a[64:67], v5 offset:36864
    v_mfma_f32_16x16x32_bf16 v[140:143], a[68:71], v[196:199], v[140:143]
    v_mfma_f32_16x16x32_bf16 v[128:131], a[72:75], v[200:203], v[128:131]
    ds_read_b128 a[68:71], v5 offset:37888
    s_add_u32 m0, s62, 13312
    s_nop 0
    buffer_load_dwordx4 v4, s[8:11], s63 offen offset:3072 sc1 lds
    v_max_f32 v54, 0, v54
    v_max_f32 v55, 0, v55
    v_mul_f32 v52, v52, v60
    v_mfma_f32_16x16x32_bf16 v[132:135], a[72:75], v[204:207], v[132:135]
    v_mul_f32 v53, v53, v61
    v_mul_f32 v54, v54, v62
    v_mul_f32_e64 v55, v55, v63
    v_cvt_pk_bf16_f32 v46, v52, v53
    v_cvt_pk_bf16_f32 v47, v54, v55
    buffer_store_dwordx4 v[44:47], v24, s[8:11], s68 offen sc1
    v_mfma_f32_16x16x32_bf16 v[136:139], a[76:79], v[200:203], v[136:139]
    ds_read_b128 a[72:75], v5 offset:38912
    v_mfma_f32_16x16x32_bf16 v[140:143], a[76:79], v[204:207], v[140:143]
    s_waitcnt lgkmcnt(3)
    v_mfma_f32_16x16x32_bf16 v[128:131], a[48:51], v[208:211], v[128:131]
    ds_read_b128 a[76:79], v5 offset:39936
    s_add_u32 m0, s62, 17408
    s_addk_i32 s63, 4096
    buffer_load_dwordx4 v4, s[8:11], s63 offen offset:0 sc1 lds
    s_mul_i32 s50, s54, 1024
    v_mfma_f32_16x16x32_bf16 v[132:135], a[48:51], v[212:215], v[132:135]
    s_cmp_eq_u32 s48, 3
    s_cselect_b32 s59, 7168, -1
    s_cselect_b32 s73, 3072, -1
    v_and_b32 v2, 15, v1
    v_lshrrev_b32 v3, 4, v1
    v_lshlrev_b32 v14, 4, v2
    v_mfma_f32_16x16x32_bf16 v[136:139], a[52:55], v[208:211], v[136:139]
    ds_read_b128 a[48:51], v5 offset:40960
    v_lshl_add_u32 v14, v3, 8, v14
    v_mfma_f32_16x16x32_bf16 v[140:143], a[52:55], v[212:215], v[140:143]
    v_mfma_f32_16x16x32_bf16 v[128:131], a[56:59], v[216:219], v[128:131]
    ds_read_b128 a[52:55], v5 offset:41984
    buffer_load_dwordx4 v4, s[8:11], s63 offen offset:1024 sc1 lds
    v_mfma_f32_16x16x32_bf16 v[132:135], a[56:59], v[220:223], v[132:135]
    s_lshr_b32 s56, s48, 1
    s_lshl_b32 s57, s53, 1
    s_add_u32 s56, s56, s57
    v_mfma_f32_16x16x32_bf16 v[136:139], a[60:63], v[216:219], v[136:139]
    ds_read_b128 a[56:59], v5 offset:43008
    s_and_b32 s57, s48, 1
    s_mul_i32 s58, s56, 40960
    v_mfma_f32_16x16x32_bf16 v[140:143], a[60:63], v[220:223], v[140:143]
    s_mul_i32 s3, s54, 5120
    s_waitcnt lgkmcnt(3)
    v_mfma_f32_16x16x32_bf16 v[128:131], a[64:67], v[224:227], v[128:131]
    ds_read_b128 a[60:63], v5 offset:44032
    buffer_load_dwordx4 v4, s[8:11], s63 offen offset:2048 sc1 lds
    v_mfma_f32_16x16x32_bf16 v[132:135], a[64:67], v[228:231], v[132:135]
    s_add_u32 s58, s58, s3
    s_lshl_b32 s3, s57, 3
    s_add_u32 s58, s58, s3
    v_mfma_f32_16x16x32_bf16 v[136:139], a[68:71], v[224:227], v[136:139]
    ds_read_b128 a[64:67], v5 offset:45056
    s_add_u32 s74, s58, 3145728
    s_add_u32 s75, s74, 4096
    v_mfma_f32_16x16x32_bf16 v[140:143], a[68:71], v[228:231], v[140:143]
    s_lshl_b32 s56, s56, 5
    v_mfma_f32_16x16x32_bf16 v[128:131], a[72:75], v[232:235], v[128:131]
    ds_read_b128 a[68:71], v5 offset:46080
    s_add_u32 m0, s62, 29696
    s_add_u32 s56, s56, s57
    v_mfma_f32_16x16x32_bf16 v[132:135], a[72:75], v[236:239], v[132:135]
    buffer_load_dwordx4 v4, s[8:11], s63 offen offset:3072 sc1 lds
    s_lshl_b32 s76, s56, 3
    v_mfma_f32_16x16x32_bf16 v[136:139], a[76:79], v[232:235], v[136:139]
    ds_read_b128 a[72:75], v5 offset:47104
    s_add_u32 s76, s76, 16384
    s_mul_i32 s77, s56, 1280
    v_mfma_f32_16x16x32_bf16 v[140:143], a[76:79], v[236:239], v[140:143]
    s_mul_i32 s3, s54, 160
    s_add_u32 s77, s77, s3
    s_waitcnt lgkmcnt(3)
    v_mfma_f32_16x16x32_bf16 v[128:131], a[48:51], v[240:243], v[128:131]
    ds_read_b128 a[76:79], v5 offset:48128
    s_add_u32 m0, s62, 33792
    s_addk_i32 s63, 4096
    v_mfma_f32_16x16x32_bf16 v[132:135], a[48:51], v[244:247], v[132:135]
    buffer_load_dwordx4 v4, s[8:11], s63 offen offset:0 sc1 lds
    v_mfma_f32_16x16x32_bf16 v[136:139], a[52:55], v[240:243], v[136:139]
    ds_read_b128 a[48:51], v5 offset:49152
    v_mul_u32_u24 v15, 2560, v2
    v_mfma_f32_16x16x32_bf16 v[140:143], a[52:55], v[244:247], v[140:143]
    v_lshl_add_u32 v15, v3, 3, v15
    s_waitcnt vmcnt(5)
    s_barrier
    s_lshl_b32 s16, s51, 4
    s_add_u32 s16, s16, s52
    s_lshl_b32 s16, s16, 7
    s_add_u32 s16, s16, 22216704
    s_lshl_b32 s55, s48, 30
    v_lshl_add_u32 v26, v1, 3, s55
    v_mov_b32 v28, s0
    v_mov_b32 v29, s1
    s_mov_b64 exec, 0xffff
    buffer_store_dwordx2 v[28:29], v26, s[8:11], s16 offen sc1
    s_mov_b64 exec, -1
    s_lshl_b32 s16, s51, 4
    s_add_u32 s16, s16, s52
    s_lshl_b32 s16, s16, 7
    s_add_u32 s16, s16, 22282240
    s_lshl_b32 s55, s48, 30
    v_lshl_add_u32 v26, v1, 3, s55
    v_mov_b32 v28, s0
    v_mov_b32 v29, s1
    s_mov_b64 exec, 0xffff
    buffer_store_dwordx2 v[28:29], v26, s[8:11], s16 offen sc1
    s_mov_b64 exec, -1
    v_mfma_f32_16x16x32_bf16 v[128:131], a[56:59], v[248:251], v[128:131]
    ds_read_b128 a[52:55], v5 offset:50176
    v_mfma_f32_16x16x32_bf16 v[132:135], a[56:59], v[252:255], v[132:135]
    buffer_load_dwordx4 v4, s[8:11], s63 offen offset:1024 sc1 lds
    v_mfma_f32_16x16x32_bf16 v[136:139], a[60:63], v[248:251], v[136:139]
    ds_read_b128 a[56:59], v5 offset:51200
    v_mfma_f32_16x16x32_bf16 v[140:143], a[60:63], v[252:255], v[140:143]
    s_waitcnt lgkmcnt(3)
    v_mfma_f32_16x16x32_bf16 v[128:131], a[64:67], a[0:3], v[128:131]
    ds_read_b128 a[60:63], v5 offset:52224
    v_mfma_f32_16x16x32_bf16 v[132:135], a[64:67], a[4:7], v[132:135]
    buffer_load_dwordx4 v4, s[8:11], s63 offen offset:2048 sc1 lds
    v_mfma_f32_16x16x32_bf16 v[136:139], a[68:71], a[0:3], v[136:139]
    ds_read_b128 a[64:67], v5 offset:53248
    v_mfma_f32_16x16x32_bf16 v[140:143], a[68:71], a[4:7], v[140:143]
    v_mfma_f32_16x16x32_bf16 v[128:131], a[72:75], a[8:11], v[128:131]
    ds_read_b128 a[68:71], v5 offset:54272
    s_add_u32 m0, s62, 46080
    s_nop 0
    buffer_load_dwordx4 v4, s[8:11], s63 offen offset:3072 sc1 lds
    buffer_load_dwordx2 a[240:241], v14, s[8:11], s74 offen offset:0 sc1
    v_mfma_f32_16x16x32_bf16 v[132:135], a[72:75], a[12:15], v[132:135]
    buffer_load_dwordx2 a[242:243], v14, s[8:11], s74 offen offset:1024 sc1
    s_lshr_b32 s55, s53, 1
    s_lshl_b32 s55, s55, 11
    s_add_u32 s55, s55, 22216704
    v_min_u32 v26, 15, v1
    v_lshlrev_b32 v26, 7, v26
    buffer_load_dwordx2 v[28:29], v26, s[8:11], s55 offen sc1
    v_mfma_f32_16x16x32_bf16 v[136:139], a[76:79], a[8:11], v[136:139]
    ds_read_b128 a[72:75], v5 offset:55296
    buffer_load_dwordx2 a[244:245], v14, s[8:11], s74 offen offset:2048 sc1
    buffer_load_dwordx2 a[246:247], v14, s[8:11], s74 offen offset:3072 sc1
    v_mfma_f32_16x16x32_bf16 v[140:143], a[76:79], a[12:15], v[140:143]
    buffer_load_dwordx2 a[248:249], v14, s[8:11], s75 offen offset:0 sc1
    s_waitcnt lgkmcnt(3)
    v_mfma_f32_16x16x32_bf16 v[128:131], a[48:51], a[16:19], v[128:131]
    ds_read_b128 a[76:79], v5 offset:56320
    s_add_u32 m0, s62, 50176
    s_addk_i32 s63, 4096
    v_mfma_f32_16x16x32_bf16 v[132:135], a[48:51], a[20:23], v[132:135]
    buffer_load_dwordx4 v4, s[8:11], s63 offen offset:0 sc1 lds
    v_mfma_f32_16x16x32_bf16 v[136:139], a[52:55], a[16:19], v[136:139]
    v_mfma_f32_16x16x32_bf16 v[140:143], a[52:55], a[20:23], v[140:143]
    v_mfma_f32_16x16x32_bf16 v[128:131], a[56:59], a[24:27], v[128:131]
    buffer_load_dwordx4 v4, s[8:11], s63 offen offset:1024 sc1 lds
    v_mfma_f32_16x16x32_bf16 v[132:135], a[56:59], a[28:31], v[132:135]
    v_mfma_f32_16x16x32_bf16 v[136:139], a[60:63], a[24:27], v[136:139]
    v_mfma_f32_16x16x32_bf16 v[140:143], a[60:63], a[28:31], v[140:143]
    s_waitcnt lgkmcnt(0)
    v_mfma_f32_16x16x32_bf16 v[128:131], a[64:67], a[32:35], v[128:131]
    buffer_load_dwordx4 v4, s[8:11], s63 offen offset:2048 sc1 lds
    v_mfma_f32_16x16x32_bf16 v[132:135], a[64:67], a[36:39], v[132:135]
    v_mfma_f32_16x16x32_bf16 v[136:139], a[68:71], a[32:35], v[136:139]
    v_mfma_f32_16x16x32_bf16 v[140:143], a[68:71], a[36:39], v[140:143]
    s_waitcnt vmcnt(6)
    v_cmp_ne_u64 s[18:19], s[0:1], v[28:29]
    s_nop 0
    s_mov_b64 vcc, s[18:19]
    s_cbranch_vccz L_mok35
    s_mov_b32 s3, 0
L_mp34:
    s_mov_b64 exec, s[18:19]
    s_cbranch_execz L_mp34_0
    buffer_load_dwordx2 v[28:29], v26, s[8:11], s55 offen sc1
L_mp34_0:
    s_mov_b64 exec, -1
    s_waitcnt vmcnt(0)
    v_cmp_ne_u64 s[18:19], s[0:1], v[28:29]
    s_nop 0
    s_mov_b64 vcc, s[18:19]
    s_add_u32 s3, s3, 1
    s_cmp_gt_u32 s3, 1000000
    s_cbranch_scc1 L_mok35
    s_cbranch_vccnz L_mp34
L_mok35:
    v_mfma_f32_16x16x32_bf16 v[128:131], a[72:75], a[40:43], v[128:131]
    s_add_u32 s56, s50, 0
    s_and_b32 s56, s56, 7168
    s_cmp_eq_u32 s56, s59
    s_cselect_b32 s56, 1073741824, s56
    v_add_u32_e64 v25, s56, v4
    buffer_load_dwordx4 v[32:35], v25, s[8:11], s64 offen sc1
    buffer_load_dwordx4 v[36:39], v25, s[8:11], s65 offen sc1
    buffer_load_dwordx4 v[40:43], v25, s[8:11], s66 offen sc1
    ds_read_b128 v[16:19], v8 offset:128
    ds_read_b128 v[20:23], v8 offset:576
    v_mfma_f32_16x16x32_bf16 v[132:135], a[72:75], a[44:47], v[132:135]
    buffer_load_dwordx4 v[44:47], v25, s[8:11], s67 offen sc1
    s_add_u32 s56, s50, 1024
    s_and_b32 s56, s56, 7168
    s_cmp_eq_u32 s56, s59
    s_cselect_b32 s56, 1073741824, s56
    v_add_u32_e64 v27, s56, v4
    buffer_load_dwordx4 v[48:51], v27, s[8:11], s64 offen sc1
    buffer_load_dwordx4 v[52:55], v27, s[8:11], s65 offen sc1
    buffer_load_dwordx4 v[56:59], v27, s[8:11], s66 offen sc1
    v_mfma_f32_16x16x32_bf16 v[136:139], a[76:79], a[40:43], v[136:139]
    buffer_load_dwordx4 v[60:63], v27, s[8:11], s67 offen sc1
    s_add_u32 s56, s50, 2048
    s_and_b32 s56, s56, 7168
    s_cmp_eq_u32 s56, s59
    s_cselect_b32 s56, 1073741824, s56
    v_add_u32_e64 v25, s56, v4
    buffer_load_dwordx4 v[64:67], v25, s[8:11], s64 offen sc1
    v_mfma_f32_16x16x32_bf16 v[140:143], a[76:79], a[44:47], v[140:143]
    buffer_load_dwordx4 v[68:71], v25, s[8:11], s65 offen sc1
    buffer_load_dwordx4 v[72:75], v25, s[8:11], s66 offen sc1
    buffer_load_dwordx4 v[76:79], v25, s[8:11], s67 offen sc1
    v_add_u32 v10, s62, v4
    v_add_u32 v5, s62, v5
    v_add_u32 v6, s62, v6
    s_waitcnt lgkmcnt(0)
    v_pk_fma_f32 v[128:129], v[16:17], v[12:13], v[128:129] op_sel:[0,0,0] op_sel_hi:[1,0,1]
    v_pk_fma_f32 v[130:131], v[18:19], v[12:13], v[130:131] op_sel:[0,0,0] op_sel_hi:[1,0,1]
    v_pk_fma_f32 v[136:137], v[20:21], v[12:13], v[136:137] op_sel:[0,0,0] op_sel_hi:[1,0,1]
    v_pk_fma_f32 v[138:139], v[22:23], v[12:13], v[138:139] op_sel:[0,0,0] op_sel_hi:[1,0,1]
    v_max_f32 v128, 0, v128
    v_max_f32 v129, 0, v129
    v_max_f32 v130, 0, v130
    v_max_f32 v131, 0, v131
    v_pk_mul_f32 v[128:129], v[128:129], v[136:137]
    v_pk_mul_f32 v[130:131], v[130:131], v[138:139]
    v_cvt_pk_bf16_f32 v136, v128, v129
    v_cvt_pk_bf16_f32 v137, v130, v131
    v_pk_fma_f32 v[132:133], v[16:17], v[12:13], v[132:133] op_sel:[0,1,0] op_sel_hi:[1,1,1]
    v_pk_fma_f32 v[134:135], v[18:19], v[12:13], v[134:135] op_sel:[0,1,0] op_sel_hi:[1,1,1]
    v_pk_fma_f32 v[140:141], v[20:21], v[12:13], v[140:141] op_sel:[0,1,0] op_sel_hi:[1,1,1]
    v_pk_fma_f32 v[142:143], v[22:23], v[12:13], v[142:143] op_sel:[0,1,0] op_sel_hi:[1,1,1]
    v_max_f32 v132, 0, v132
    v_max_f32 v133, 0, v133
    v_max_f32 v134, 0, v134
    v_max_f32 v135, 0, v135
    v_pk_mul_f32 v[132:133], v[132:133], v[140:141]
    v_pk_mul_f32 v[134:135], v[134:135], v[142:143]
    v_cvt_pk_bf16_f32 v138, v132, v133
    v_cvt_pk_bf16_f32 v139, v134, v135
    s_bitcmp0_b32 s52, 1
    s_cbranch_scc1 L_hs36
    v_swap_b32 v136, v138
    v_swap_b32 v137, v139
L_hs36:
    buffer_store_dwordx4 v[136:139], v4, s[8:11], s71 offen sc1
    s_waitcnt vmcnt(9)
    v_mfma_f32_16x16x32_bf16 v[144:147], a[80:83], v[32:35], 0
    s_add_u32 s56, s50, 3072
    s_and_b32 s56, s56, 7168
    s_cmp_eq_u32 s56, s59
    s_cselect_b32 s56, 1073741824, s56
    v_add_u32 v27, s56, v4
    v_mfma_f32_16x16x32_bf16 v[164:167], a[80:83], v[36:39], 0
    buffer_load_dwordx4 v[80:83], v27, s[8:11], s64 offen sc1
    v_mfma_f32_16x16x32_bf16 v[184:187], a[80:83], v[40:43], 0
    v_mfma_f32_16x16x32_bf16 v[204:207], a[80:83], v[44:47], 0
    v_mfma_f32_16x16x32_bf16 v[148:151], a[84:87], v[32:35], 0
    v_mfma_f32_16x16x32_bf16 v[168:171], a[84:87], v[36:39], 0
    buffer_load_dwordx4 v[84:87], v27, s[8:11], s65 offen sc1
    v_mfma_f32_16x16x32_bf16 v[188:191], a[84:87], v[40:43], 0
    v_mfma_f32_16x16x32_bf16 v[208:211], a[84:87], v[44:47], 0
    v_mfma_f32_16x16x32_bf16 v[152:155], a[88:91], v[32:35], 0
    v_mfma_f32_16x16x32_bf16 v[172:175], a[88:91], v[36:39], 0
    v_mfma_f32_16x16x32_bf16 v[192:195], a[88:91], v[40:43], 0
    buffer_load_dwordx4 v[88:91], v27, s[8:11], s66 offen sc1
    v_mfma_f32_16x16x32_bf16 v[212:215], a[88:91], v[44:47], 0
    v_mfma_f32_16x16x32_bf16 v[156:159], a[92:95], v[32:35], 0
    v_mfma_f32_16x16x32_bf16 v[176:179], a[92:95], v[36:39], 0
    v_mfma_f32_16x16x32_bf16 v[196:199], a[92:95], v[40:43], 0
    v_mfma_f32_16x16x32_bf16 v[216:219], a[92:95], v[44:47], 0
    buffer_load_dwordx4 v[92:95], v27, s[8:11], s67 offen sc1
    v_mfma_f32_16x16x32_bf16 v[160:163], a[96:99], v[32:35], 0
    v_mfma_f32_16x16x32_bf16 v[180:183], a[96:99], v[36:39], 0
    v_mfma_f32_16x16x32_bf16 v[200:203], a[96:99], v[40:43], 0
    v_mfma_f32_16x16x32_bf16 v[220:223], a[96:99], v[44:47], 0
    s_waitcnt vmcnt(9)
    v_mfma_f32_16x16x32_bf16 v[144:147], a[100:103], v[48:51], v[144:147]
    s_add_u32 s56, s50, 4096
    s_and_b32 s56, s56, 7168
    s_cmp_eq_u32 s56, s59
    s_cselect_b32 s56, 1073741824, s56
    v_add_u32 v25, s56, v4
    v_mfma_f32_16x16x32_bf16 v[164:167], a[100:103], v[52:55], v[164:167]
    buffer_load_dwordx4 v[32:35], v25, s[8:11], s64 offen sc1
    v_mfma_f32_16x16x32_bf16 v[184:187], a[100:103], v[56:59], v[184:187]
    ds_read_b128 a[80:83], v10 offset:0
    ds_read_b128 a[84:87], v10 offset:1024
    v_mfma_f32_16x16x32_bf16 v[204:207], a[100:103], v[60:63], v[204:207]
    ds_read_b128 a[88:91], v10 offset:2048
    ds_read_b128 a[92:95], v10 offset:3072
    v_mfma_f32_16x16x32_bf16 v[148:151], a[104:107], v[48:51], v[148:151]
    ds_read_b128 a[96:99], v6 offset:16384
    v_mfma_f32_16x16x32_bf16 v[168:171], a[104:107], v[52:55], v[168:171]
    buffer_load_dwordx4 v[36:39], v25, s[8:11], s65 offen sc1
    v_mfma_f32_16x16x32_bf16 v[188:191], a[104:107], v[56:59], v[188:191]
    v_mfma_f32_16x16x32_bf16 v[208:211], a[104:107], v[60:63], v[208:211]
    v_mfma_f32_16x16x32_bf16 v[152:155], a[108:111], v[48:51], v[152:155]
    v_mfma_f32_16x16x32_bf16 v[172:175], a[108:111], v[52:55], v[172:175]
    v_mfma_f32_16x16x32_bf16 v[192:195], a[108:111], v[56:59], v[192:195]
    buffer_load_dwordx4 v[40:43], v25, s[8:11], s66 offen sc1
    v_mfma_f32_16x16x32_bf16 v[212:215], a[108:111], v[60:63], v[212:215]
    v_mfma_f32_16x16x32_bf16 v[156:159], a[112:115], v[48:51], v[156:159]
    v_mfma_f32_16x16x32_bf16 v[176:179], a[112:115], v[52:55], v[176:179]
    v_mfma_f32_16x16x32_bf16 v[196:199], a[112:115], v[56:59], v[196:199]
    v_mfma_f32_16x16x32_bf16 v[216:219], a[112:115], v[60:63], v[216:219]
    buffer_load_dwordx4 v[44:47], v25, s[8:11], s67 offen sc1
    v_mfma_f32_16x16x32_bf16 v[160:163], a[116:119], v[48:51], v[160:163]
    v_mfma_f32_16x16x32_bf16 v[180:183], a[116:119], v[52:55], v[180:183]
    v_mfma_f32_16x16x32_bf16 v[200:203], a[116:119], v[56:59], v[200:203]
    v_mfma_f32_16x16x32_bf16 v[220:223], a[116:119], v[60:63], v[220:223]
    s_waitcnt vmcnt(9)
    v_mfma_f32_16x16x32_bf16 v[144:147], a[120:123], v[64:67], v[144:147]
    s_add_u32 s56, s50, 5120
    s_and_b32 s56, s56, 7168
    s_cmp_eq_u32 s56, s59
    s_cselect_b32 s56, 1073741824, s56
    v_add_u32 v27, s56, v4
    v_mfma_f32_16x16x32_bf16 v[164:167], a[120:123], v[68:71], v[164:167]
    buffer_load_dwordx4 v[48:51], v27, s[8:11], s64 offen sc1
    v_mfma_f32_16x16x32_bf16 v[184:187], a[120:123], v[72:75], v[184:187]
    ds_read_b128 a[100:103], v6 offset:17408
    ds_read_b128 a[104:107], v6 offset:18432
    v_mfma_f32_16x16x32_bf16 v[204:207], a[120:123], v[76:79], v[204:207]
    ds_read_b128 a[108:111], v10 offset:16384
    ds_read_b128 a[112:115], v10 offset:17408
    v_mfma_f32_16x16x32_bf16 v[148:151], a[124:127], v[64:67], v[148:151]
    ds_read_b128 a[116:119], v10 offset:18432
    v_mfma_f32_16x16x32_bf16 v[168:171], a[124:127], v[68:71], v[168:171]
    buffer_load_dwordx4 v[52:55], v27, s[8:11], s65 offen sc1
    v_mfma_f32_16x16x32_bf16 v[188:191], a[124:127], v[72:75], v[188:191]
    v_mfma_f32_16x16x32_bf16 v[208:211], a[124:127], v[76:79], v[208:211]
    v_mfma_f32_16x16x32_bf16 v[152:155], a[128:131], v[64:67], v[152:155]
    v_mfma_f32_16x16x32_bf16 v[172:175], a[128:131], v[68:71], v[172:175]
    v_mfma_f32_16x16x32_bf16 v[192:195], a[128:131], v[72:75], v[192:195]
    buffer_load_dwordx4 v[56:59], v27, s[8:11], s66 offen sc1
    v_mfma_f32_16x16x32_bf16 v[212:215], a[128:131], v[76:79], v[212:215]
    v_mfma_f32_16x16x32_bf16 v[156:159], a[132:135], v[64:67], v[156:159]
    v_mfma_f32_16x16x32_bf16 v[176:179], a[132:135], v[68:71], v[176:179]
    v_mfma_f32_16x16x32_bf16 v[196:199], a[132:135], v[72:75], v[196:199]
    v_mfma_f32_16x16x32_bf16 v[216:219], a[132:135], v[76:79], v[216:219]
    buffer_load_dwordx4 v[60:63], v27, s[8:11], s67 offen sc1
    v_mfma_f32_16x16x32_bf16 v[160:163], a[136:139], v[64:67], v[160:163]
    v_mfma_f32_16x16x32_bf16 v[180:183], a[136:139], v[68:71], v[180:183]
    v_mfma_f32_16x16x32_bf16 v[200:203], a[136:139], v[72:75], v[200:203]
    v_mfma_f32_16x16x32_bf16 v[220:223], a[136:139], v[76:79], v[220:223]
    s_waitcnt vmcnt(12)
    s_barrier
    s_lshl_b32 s16, s51, 4
    s_add_u32 s16, s16, s52
    s_lshl_b32 s16, s16, 7
    s_add_u32 s16, s16, 22249472
    s_lshl_b32 s55, s48, 30
    v_lshl_add_u32 v26, v1, 3, s55
    v_mov_b32 v28, s0
    v_mov_b32 v29, s1
    s_mov_b64 exec, 0xffff
    buffer_store_dwordx2 v[28:29], v26, s[8:11], s16 offen sc1
    s_mov_b64 exec, -1
    s_waitcnt vmcnt(9)
    v_mfma_f32_16x16x32_bf16 v[144:147], a[140:143], v[80:83], v[144:147]
    s_add_u32 s56, s50, 6144
    s_and_b32 s56, s56, 7168
    s_cmp_eq_u32 s56, s59
    s_cselect_b32 s56, 1073741824, s56
    v_add_u32_e64 v25, s56, v4
    v_mfma_f32_16x16x32_bf16 v[164:167], a[140:143], v[84:87], v[164:167]
    buffer_load_dwordx4 v[64:67], v25, s[8:11], s64 offen sc1
    v_mfma_f32_16x16x32_bf16 v[184:187], a[140:143], v[88:91], v[184:187]
    s_lshr_b32 s55, s53, 1
    s_lshl_b32 s55, s55, 11
    s_add_u32 s55, s55, 22282240
    v_min_u32 v26, 15, v1
    v_lshlrev_b32 v26, 7, v26
    buffer_load_dwordx2 v[28:29], v26, s[8:11], s55 offen sc1
    v_mfma_f32_16x16x32_bf16 v[204:207], a[140:143], v[92:95], v[204:207]
    ds_read_b128 a[120:123], v10 offset:19456
    ds_read_b128 a[124:127], v10 offset:32768
    v_mfma_f32_16x16x32_bf16 v[148:151], a[144:147], v[80:83], v[148:151]
    ds_read_b128 a[128:131], v10 offset:33792
    ds_read_b128 a[132:135], v10 offset:34816
    v_mfma_f32_16x16x32_bf16 v[168:171], a[144:147], v[84:87], v[168:171]
    buffer_load_dwordx4 v[68:71], v25, s[8:11], s65 offen sc1
    v_mfma_f32_16x16x32_bf16 v[188:191], a[144:147], v[88:91], v[188:191]
    ds_read_b128 a[136:139], v10 offset:35840
    v_mfma_f32_16x16x32_bf16 v[208:211], a[144:147], v[92:95], v[208:211]
    buffer_load_dword v106, v9, s[8:11], s76 offen sc1
    v_mfma_f32_16x16x32_bf16 v[152:155], a[148:151], v[80:83], v[152:155]
    v_mfma_f32_16x16x32_bf16 v[172:175], a[148:151], v[84:87], v[172:175]
    v_mfma_f32_16x16x32_bf16 v[192:195], a[148:151], v[88:91], v[192:195]
    buffer_load_dwordx4 v[72:75], v25, s[8:11], s66 offen sc1
    v_mfma_f32_16x16x32_bf16 v[212:215], a[148:151], v[92:95], v[212:215]
    v_mfma_f32_16x16x32_bf16 v[156:159], a[152:155], v[80:83], v[156:159]
    v_mfma_f32_16x16x32_bf16 v[176:179], a[152:155], v[84:87], v[176:179]
    v_mfma_f32_16x16x32_bf16 v[196:199], a[152:155], v[88:91], v[196:199]
    v_mfma_f32_16x16x32_bf16 v[216:219], a[152:155], v[92:95], v[216:219]
    buffer_load_dwordx4 v[76:79], v25, s[8:11], s67 offen sc1
    v_mfma_f32_16x16x32_bf16 v[160:163], a[156:159], v[80:83], v[160:163]
    v_mfma_f32_16x16x32_bf16 v[180:183], a[156:159], v[84:87], v[180:183]
    v_mfma_f32_16x16x32_bf16 v[200:203], a[156:159], v[88:91], v[200:203]
    v_mfma_f32_16x16x32_bf16 v[220:223], a[156:159], v[92:95], v[220:223]
    s_waitcnt vmcnt(11)
    v_mfma_f32_16x16x32_bf16 v[144:147], a[160:163], v[32:35], v[144:147]
    s_add_u32 s56, s50, 7168
    s_and_b32 s56, s56, 7168
    s_cmp_eq_u32 s56, s59
    s_cselect_b32 s56, 1073741824, s56
    v_add_u32 v27, s56, v4
    v_mfma_f32_16x16x32_bf16 v[164:167], a[160:163], v[36:39], v[164:167]
    buffer_load_dwordx4 v[80:83], v27, s[8:11], s64 offen sc1
    v_mfma_f32_16x16x32_bf16 v[184:187], a[160:163], v[40:43], v[184:187]
    ds_read_b128 a[140:143], v10 offset:49152
    ds_read_b128 a[144:147], v10 offset:50176
    v_mfma_f32_16x16x32_bf16 v[204:207], a[160:163], v[44:47], v[204:207]
    ds_read_b128 a[148:151], v10 offset:51200
    ds_read_b128 a[152:155], v10 offset:52224
    v_mfma_f32_16x16x32_bf16 v[148:151], a[164:167], v[32:35], v[148:151]
    v_mfma_f32_16x16x32_bf16 v[168:171], a[164:167], v[36:39], v[168:171]
    buffer_load_dwordx4 v[84:87], v27, s[8:11], s65 offen sc1
    v_mfma_f32_16x16x32_bf16 v[188:191], a[164:167], v[40:43], v[188:191]
    v_mfma_f32_16x16x32_bf16 v[208:211], a[164:167], v[44:47], v[208:211]
    v_mfma_f32_16x16x32_bf16 v[152:155], a[168:171], v[32:35], v[152:155]
    v_mfma_f32_16x16x32_bf16 v[172:175], a[168:171], v[36:39], v[172:175]
    v_mfma_f32_16x16x32_bf16 v[192:195], a[168:171], v[40:43], v[192:195]
    buffer_load_dwordx4 v[88:91], v27, s[8:11], s66 offen sc1
    v_mfma_f32_16x16x32_bf16 v[212:215], a[168:171], v[44:47], v[212:215]
    v_mfma_f32_16x16x32_bf16 v[156:159], a[172:175], v[32:35], v[156:159]
    v_mfma_f32_16x16x32_bf16 v[176:179], a[172:175], v[36:39], v[176:179]
    v_mfma_f32_16x16x32_bf16 v[196:199], a[172:175], v[40:43], v[196:199]
    v_mfma_f32_16x16x32_bf16 v[216:219], a[172:175], v[44:47], v[216:219]
    buffer_load_dwordx4 v[92:95], v27, s[8:11], s67 offen sc1
    v_mfma_f32_16x16x32_bf16 v[160:163], a[176:179], v[32:35], v[160:163]
    v_mfma_f32_16x16x32_bf16 v[180:183], a[176:179], v[36:39], v[180:183]
    v_mfma_f32_16x16x32_bf16 v[200:203], a[176:179], v[40:43], v[200:203]
    v_mfma_f32_16x16x32_bf16 v[220:223], a[176:179], v[44:47], v[220:223]
    s_waitcnt vmcnt(8)
    v_cmp_ne_u64 s[18:19], s[0:1], v[28:29]
    s_nop 0
    s_mov_b64 vcc, s[18:19]
    s_cbranch_vccz L_mok38
    s_mov_b32 s3, 0
L_mp37:
    s_mov_b64 exec, s[18:19]
    s_cbranch_execz L_mp37_0
    buffer_load_dwordx2 v[28:29], v26, s[8:11], s55 offen sc1
L_mp37_0:
    s_mov_b64 exec, -1
    s_waitcnt vmcnt(0)
    v_cmp_ne_u64 s[18:19], s[0:1], v[28:29]
    s_nop 0
    s_mov_b64 vcc, s[18:19]
    s_add_u32 s3, s3, 1
    s_cmp_gt_u32 s3, 1000000
    s_cbranch_scc1 L_mok38
    s_cbranch_vccnz L_mp37
L_mok38:
    v_mfma_f32_16x16x32_bf16 v[144:147], a[180:183], v[48:51], v[144:147]
    s_add_u32 s56, s50, 8192
    s_and_b32 s56, s56, 3072
    s_cmp_eq_u32 s56, s73
    s_cselect_b32 s56, 1073741824, s56
    s_add_u32 s56, s56, 8192
    v_add_u32_e64 v25, s56, v4
    v_mfma_f32_16x16x32_bf16 v[164:167], a[180:183], v[52:55], v[164:167]
    buffer_load_dwordx4 v[32:35], v25, s[8:11], s64 offen sc1
    v_mfma_f32_16x16x32_bf16 v[184:187], a[180:183], v[56:59], v[184:187]
    v_mfma_f32_16x16x32_bf16 v[204:207], a[180:183], v[60:63], v[204:207]
    v_mfma_f32_16x16x32_bf16 v[148:151], a[184:187], v[48:51], v[148:151]
    v_mfma_f32_16x16x32_bf16 v[168:171], a[184:187], v[52:55], v[168:171]
    buffer_load_dwordx4 v[36:39], v25, s[8:11], s65 offen sc1
    v_mfma_f32_16x16x32_bf16 v[188:191], a[184:187], v[56:59], v[188:191]
    v_mfma_f32_16x16x32_bf16 v[208:211], a[184:187], v[60:63], v[208:211]
    v_mfma_f32_16x16x32_bf16 v[152:155], a[188:191], v[48:51], v[152:155]
    v_mfma_f32_16x16x32_bf16 v[172:175], a[188:191], v[52:55], v[172:175]
    v_mfma_f32_16x16x32_bf16 v[192:195], a[188:191], v[56:59], v[192:195]
    buffer_load_dwordx4 v[40:43], v25, s[8:11], s66 offen sc1
    v_mfma_f32_16x16x32_bf16 v[212:215], a[188:191], v[60:63], v[212:215]
    v_mfma_f32_16x16x32_bf16 v[156:159], a[192:195], v[48:51], v[156:159]
    v_mfma_f32_16x16x32_bf16 v[176:179], a[192:195], v[52:55], v[176:179]
    v_mfma_f32_16x16x32_bf16 v[196:199], a[192:195], v[56:59], v[196:199]
    v_mfma_f32_16x16x32_bf16 v[216:219], a[192:195], v[60:63], v[216:219]
    buffer_load_dwordx4 v[44:47], v25, s[8:11], s67 offen sc1
    v_mfma_f32_16x16x32_bf16 v[160:163], a[196:199], v[48:51], v[160:163]
    v_mfma_f32_16x16x32_bf16 v[180:183], a[196:199], v[52:55], v[180:183]
    v_mfma_f32_16x16x32_bf16 v[200:203], a[196:199], v[56:59], v[200:203]
    v_mfma_f32_16x16x32_bf16 v[220:223], a[196:199], v[60:63], v[220:223]
    s_waitcnt vmcnt(8)
    v_mfma_f32_16x16x32_bf16 v[144:147], a[200:203], v[64:67], v[144:147]
    s_add_u32 s56, s50, 9216
    s_and_b32 s56, s56, 3072
    s_cmp_eq_u32 s56, s73
    s_cselect_b32 s56, 1073741824, s56
    s_add_u32 s56, s56, 8192
    v_add_u32 v27, s56, v4
    v_mfma_f32_16x16x32_bf16 v[164:167], a[200:203], v[68:71], v[164:167]
    buffer_load_dwordx4 v[48:51], v27, s[8:11], s64 offen sc1
    v_mfma_f32_16x16x32_bf16 v[184:187], a[200:203], v[72:75], v[184:187]
    v_mfma_f32_16x16x32_bf16 v[204:207], a[200:203], v[76:79], v[204:207]
    v_mfma_f32_16x16x32_bf16 v[148:151], a[204:207], v[64:67], v[148:151]
    v_mfma_f32_16x16x32_bf16 v[168:171], a[204:207], v[68:71], v[168:171]
    buffer_load_dwordx4 v[52:55], v27, s[8:11], s65 offen sc1
    v_mfma_f32_16x16x32_bf16 v[188:191], a[204:207], v[72:75], v[188:191]
    v_mfma_f32_16x16x32_bf16 v[208:211], a[204:207], v[76:79], v[208:211]
    v_mfma_f32_16x16x32_bf16 v[152:155], a[208:211], v[64:67], v[152:155]
    v_mfma_f32_16x16x32_bf16 v[172:175], a[208:211], v[68:71], v[172:175]
    v_mfma_f32_16x16x32_bf16 v[192:195], a[208:211], v[72:75], v[192:195]
    buffer_load_dwordx4 v[56:59], v27, s[8:11], s66 offen sc1
    v_mfma_f32_16x16x32_bf16 v[212:215], a[208:211], v[76:79], v[212:215]
    v_mfma_f32_16x16x32_bf16 v[156:159], a[212:215], v[64:67], v[156:159]
    v_mfma_f32_16x16x32_bf16 v[176:179], a[212:215], v[68:71], v[176:179]
    v_mfma_f32_16x16x32_bf16 v[196:199], a[212:215], v[72:75], v[196:199]
    v_mfma_f32_16x16x32_bf16 v[216:219], a[212:215], v[76:79], v[216:219]
    buffer_load_dwordx4 v[60:63], v27, s[8:11], s67 offen sc1
    v_mfma_f32_16x16x32_bf16 v[160:163], a[216:219], v[64:67], v[160:163]
    v_mfma_f32_16x16x32_bf16 v[180:183], a[216:219], v[68:71], v[180:183]
    v_mfma_f32_16x16x32_bf16 v[200:203], a[216:219], v[72:75], v[200:203]
    v_mfma_f32_16x16x32_bf16 v[220:223], a[216:219], v[76:79], v[220:223]
    s_waitcnt vmcnt(8)
    v_mfma_f32_16x16x32_bf16 v[144:147], a[220:223], v[80:83], v[144:147]
    s_add_u32 s56, s50, 10240
    s_and_b32 s56, s56, 3072
    s_cmp_eq_u32 s56, s73
    s_cselect_b32 s56, 1073741824, s56
    s_add_u32 s56, s56, 8192
    v_add_u32 v25, s56, v4
    v_mfma_f32_16x16x32_bf16 v[164:167], a[220:223], v[84:87], v[164:167]
    buffer_load_dwordx4 v[64:67], v25, s[8:11], s64 offen sc1
    v_mfma_f32_16x16x32_bf16 v[184:187], a[220:223], v[88:91], v[184:187]
    buffer_load_dwordx4 v[68:71], v25, s[8:11], s65 offen sc1
    v_mfma_f32_16x16x32_bf16 v[204:207], a[220:223], v[92:95], v[204:207]
    s_lshr_b32 s55, s53, 1
    s_lshl_b32 s55, s55, 11
    s_add_u32 s55, s55, 22249472
    v_min_u32 v26, 15, v1
    v_lshlrev_b32 v26, 7, v26
    buffer_load_dwordx2 v[28:29], v26, s[8:11], s55 offen sc1
    v_mfma_f32_16x16x32_bf16 v[148:151], a[224:227], v[80:83], v[148:151]
    v_mfma_f32_16x16x32_bf16 v[168:171], a[224:227], v[84:87], v[168:171]
    buffer_load_dwordx4 v[72:75], v25, s[8:11], s66 offen sc1
    v_mfma_f32_16x16x32_bf16 v[188:191], a[224:227], v[88:91], v[188:191]
    v_mfma_f32_16x16x32_bf16 v[208:211], a[224:227], v[92:95], v[208:211]
    v_mfma_f32_16x16x32_bf16 v[152:155], a[228:231], v[80:83], v[152:155]
    buffer_load_dwordx4 v[76:79], v25, s[8:11], s67 offen sc1
    v_mfma_f32_16x16x32_bf16 v[172:175], a[228:231], v[84:87], v[172:175]
    v_mfma_f32_16x16x32_bf16 v[192:195], a[228:231], v[88:91], v[192:195]
    v_mfma_f32_16x16x32_bf16 v[212:215], a[228:231], v[92:95], v[212:215]
    buffer_load_dwordx4 a[156:159], v4, s[8:11], s63 offen offset:3072 sc1
    v_mfma_f32_16x16x32_bf16 v[156:159], a[232:235], v[80:83], v[156:159]
    v_mfma_f32_16x16x32_bf16 v[176:179], a[232:235], v[84:87], v[176:179]
    v_mfma_f32_16x16x32_bf16 v[196:199], a[232:235], v[88:91], v[196:199]
    s_add_u32 s63, s63, 4096
    buffer_load_dwordx4 a[160:163], v4, s[8:11], s63 offen offset:0 sc1
    v_mfma_f32_16x16x32_bf16 v[216:219], a[232:235], v[92:95], v[216:219]
    v_mfma_f32_16x16x32_bf16 v[160:163], a[236:239], v[80:83], v[160:163]
    v_mfma_f32_16x16x32_bf16 v[180:183], a[236:239], v[84:87], v[180:183]
    buffer_load_dwordx4 a[164:167], v4, s[8:11], s63 offen offset:1024 sc1
    v_mfma_f32_16x16x32_bf16 v[200:203], a[236:239], v[88:91], v[200:203]
    v_mfma_f32_16x16x32_bf16 v[220:223], a[236:239], v[92:95], v[220:223]
    s_waitcnt vmcnt(12) lgkmcnt(14)
    v_mfma_f32_16x16x32_bf16 v[144:147], a[80:83], v[32:35], v[144:147]
    s_add_u32 s56, s50, 11264
    s_and_b32 s56, s56, 3072
    s_cmp_eq_u32 s56, s73
    s_cselect_b32 s56, 1073741824, s56
    s_add_u32 s56, s56, 8192
    v_add_u32 v27, s56, v4
    v_mfma_f32_16x16x32_bf16 v[164:167], a[80:83], v[36:39], v[164:167]
    buffer_load_dwordx4 v[80:83], v27, s[8:11], s64 offen sc1
    v_mfma_f32_16x16x32_bf16 v[184:187], a[80:83], v[40:43], v[184:187]
    buffer_load_dwordx4 v[84:87], v27, s[8:11], s65 offen sc1
    v_mfma_f32_16x16x32_bf16 v[204:207], a[80:83], v[44:47], v[204:207]
    v_mfma_f32_16x16x32_bf16 v[148:151], a[84:87], v[32:35], v[148:151]
    v_mfma_f32_16x16x32_bf16 v[168:171], a[84:87], v[36:39], v[168:171]
    buffer_load_dwordx4 v[88:91], v27, s[8:11], s66 offen sc1
    v_mfma_f32_16x16x32_bf16 v[188:191], a[84:87], v[40:43], v[188:191]
    v_mfma_f32_16x16x32_bf16 v[208:211], a[84:87], v[44:47], v[208:211]
    v_mfma_f32_16x16x32_bf16 v[152:155], a[88:91], v[32:35], v[152:155]
    buffer_load_dwordx4 v[92:95], v27, s[8:11], s67 offen sc1
    v_mfma_f32_16x16x32_bf16 v[172:175], a[88:91], v[36:39], v[172:175]
    v_mfma_f32_16x16x32_bf16 v[192:195], a[88:91], v[40:43], v[192:195]
    v_mfma_f32_16x16x32_bf16 v[212:215], a[88:91], v[44:47], v[212:215]
    buffer_load_dwordx4 a[168:171], v4, s[8:11], s63 offen offset:2048 sc1
    v_mfma_f32_16x16x32_bf16 v[156:159], a[92:95], v[32:35], v[156:159]
    v_mfma_f32_16x16x32_bf16 v[176:179], a[92:95], v[36:39], v[176:179]
    v_mfma_f32_16x16x32_bf16 v[196:199], a[92:95], v[40:43], v[196:199]
    buffer_load_dwordx4 a[172:175], v4, s[8:11], s63 offen offset:3072 sc1
    v_mfma_f32_16x16x32_bf16 v[216:219], a[92:95], v[44:47], v[216:219]
    v_mfma_f32_16x16x32_bf16 v[160:163], a[96:99], v[32:35], v[160:163]
    v_mfma_f32_16x16x32_bf16 v[180:183], a[96:99], v[36:39], v[180:183]
    s_addk_i32 s63, 4096
    buffer_load_dwordx4 a[176:179], v4, s[8:11], s63 offen offset:0 sc1
    v_mfma_f32_16x16x32_bf16 v[200:203], a[96:99], v[40:43], v[200:203]
    v_mfma_f32_16x16x32_bf16 v[220:223], a[96:99], v[44:47], v[220:223]
    s_waitcnt vmcnt(12)
    v_cmp_ne_u64 s[18:19], s[0:1], v[28:29]
    s_nop 0
    s_mov_b64 vcc, s[18:19]
    s_cbranch_vccz L_mok40
    s_mov_b32 s3, 0
L_mp39:
    s_mov_b64 exec, s[18:19]
    s_cbranch_execz L_mp39_0
    buffer_load_dwordx2 v[28:29], v26, s[8:11], s55 offen sc1
L_mp39_0:
    s_mov_b64 exec, -1
    s_waitcnt vmcnt(0)
    v_cmp_ne_u64 s[18:19], s[0:1], v[28:29]
    s_nop 0
    s_mov_b64 vcc, s[18:19]
    s_add_u32 s3, s3, 1
    s_cmp_gt_u32 s3, 1000000
    s_cbranch_scc1 L_mok40
    s_cbranch_vccnz L_mp39
L_mok40:
    s_waitcnt lgkmcnt(9)
    v_mfma_f32_16x16x32_bf16 v[144:147], a[100:103], v[48:51], v[144:147]
    s_add_u32 s56, s50, 12288
    s_and_b32 s56, s56, 1024
    s_add_u32 s56, s56, 12288
    v_add_u32_e64 v25, s56, v4
    v_mfma_f32_16x16x32_bf16 v[164:167], a[100:103], v[52:55], v[164:167]
    buffer_load_dwordx4 v[32:35], v25, s[8:11], s64 offen sc1
    v_mfma_f32_16x16x32_bf16 v[184:187], a[100:103], v[56:59], v[184:187]
    buffer_load_dwordx4 v[36:39], v25, s[8:11], s65 offen sc1
    v_mfma_f32_16x16x32_bf16 v[204:207], a[100:103], v[60:63], v[204:207]
    s_xor_b32 s58, s48, 1
    s_mul_i32 s58, s58, 15360
    v_mfma_f32_16x16x32_bf16 v[148:151], a[104:107], v[48:51], v[148:151]
    s_add_u32 s58, s58, 81920
    v_add_u32 v16, s58, v4
    v_mfma_f32_16x16x32_bf16 v[168:171], a[104:107], v[52:55], v[168:171]
    buffer_load_dwordx4 v[40:43], v25, s[8:11], s66 offen sc1
    v_mfma_f32_16x16x32_bf16 v[188:191], a[104:107], v[56:59], v[188:191]
    s_xor_b32 s58, s48, 2
    s_mul_i32 s58, s58, 15360
    v_mfma_f32_16x16x32_bf16 v[208:211], a[104:107], v[60:63], v[208:211]
    s_add_u32 s58, s58, 81920
    v_add_u32 v17, s58, v4
    v_mfma_f32_16x16x32_bf16 v[152:155], a[108:111], v[48:51], v[152:155]
    buffer_load_dwordx4 v[44:47], v25, s[8:11], s67 offen sc1
    v_mfma_f32_16x16x32_bf16 v[172:175], a[108:111], v[52:55], v[172:175]
    s_xor_b32 s58, s48, 3
    s_mul_i32 s58, s58, 15360
    v_mfma_f32_16x16x32_bf16 v[192:195], a[108:111], v[56:59], v[192:195]
    s_add_u32 s58, s58, 81920
    v_add_u32 v18, s58, v4
    v_mfma_f32_16x16x32_bf16 v[212:215], a[108:111], v[60:63], v[212:215]
    buffer_load_dwordx4 a[180:183], v4, s[8:11], s63 offen offset:1024 sc1
    v_mfma_f32_16x16x32_bf16 v[156:159], a[112:115], v[48:51], v[156:159]
    s_mul_i32 s58, s48, 15360
    s_add_u32 s58, s58, 81920
    v_mfma_f32_16x16x32_bf16 v[176:179], a[112:115], v[52:55], v[176:179]
    v_add_u32_e64 v19, s58, v4
    v_mfma_f32_16x16x32_bf16 v[196:199], a[112:115], v[56:59], v[196:199]
    buffer_load_dwordx4 a[184:187], v4, s[8:11], s63 offen offset:2048 sc1
    v_mfma_f32_16x16x32_bf16 v[216:219], a[112:115], v[60:63], v[216:219]
    v_mfma_f32_16x16x32_bf16 v[160:163], a[116:119], v[48:51], v[160:163]
    v_mfma_f32_16x16x32_bf16 v[180:183], a[116:119], v[52:55], v[180:183]
    buffer_load_dwordx4 a[188:191], v4, s[8:11], s63 offen offset:3072 sc1
    v_mfma_f32_16x16x32_bf16 v[200:203], a[116:119], v[56:59], v[200:203]
    v_mfma_f32_16x16x32_bf16 v[220:223], a[116:119], v[60:63], v[220:223]
    s_waitcnt vmcnt(17) lgkmcnt(4)
    v_mfma_f32_16x16x32_bf16 v[144:147], a[120:123], v[64:67], v[144:147]
    s_add_u32 s56, s50, 13312
    s_and_b32 s56, s56, 1024
    s_add_u32 s56, s56, 12288
    v_add_u32 v27, s56, v4
    v_mfma_f32_16x16x32_bf16 v[164:167], a[120:123], v[68:71], v[164:167]
    buffer_load_dwordx4 v[48:51], v27, s[8:11], s64 offen sc1
    v_mfma_f32_16x16x32_bf16 v[184:187], a[120:123], v[72:75], v[184:187]
    v_and_b32 v106, 0xffff0000, v106
    v_mfma_f32_16x16x32_bf16 v[204:207], a[120:123], v[76:79], v[204:207]
    buffer_load_dwordx4 v[52:55], v27, s[8:11], s65 offen sc1
    v_mfma_f32_16x16x32_bf16 v[148:151], a[124:127], v[64:67], v[148:151]
    v_rcp_f32_e64 v106, v106
    v_mfma_f32_16x16x32_bf16 v[168:171], a[124:127], v[68:71], v[168:171]
    v_accvgpr_read_b32 v96, a240
    v_mfma_f32_16x16x32_bf16 v[188:191], a[124:127], v[72:75], v[188:191]
    buffer_load_dwordx4 v[56:59], v27, s[8:11], s66 offen sc1
    v_mfma_f32_16x16x32_bf16 v[208:211], a[124:127], v[76:79], v[208:211]
    v_lshlrev_b32_e64 v108, 16, v96
    v_and_b32 v109, 0xffff0000, v96
    v_mfma_f32_16x16x32_bf16 v[152:155], a[128:131], v[64:67], v[152:155]
    v_accvgpr_read_b32 v97, a241
    v_mfma_f32_16x16x32_bf16 v[172:175], a[128:131], v[68:71], v[172:175]
    v_lshlrev_b32_e64 v110, 16, v97
    v_and_b32 v111, 0xffff0000, v97
    v_mfma_f32_16x16x32_bf16 v[192:195], a[128:131], v[72:75], v[192:195]
    buffer_load_dwordx4 v[60:63], v27, s[8:11], s67 offen sc1
    v_mfma_f32_16x16x32_bf16 v[212:215], a[128:131], v[76:79], v[212:215]
    v_accvgpr_read_b32 v98, a242
    v_mfma_f32_16x16x32_bf16 v[156:159], a[132:135], v[64:67], v[156:159]
    v_lshlrev_b32_e64 v112, 16, v98
    v_and_b32 v113, 0xffff0000, v98
    v_mfma_f32_16x16x32_bf16 v[176:179], a[132:135], v[68:71], v[176:179]
    s_add_u32 s63, s63, 4096
    buffer_load_dwordx4 a[192:195], v4, s[8:11], s63 offen offset:0 sc1
    v_mfma_f32_16x16x32_bf16 v[196:199], a[132:135], v[72:75], v[196:199]
    v_accvgpr_read_b32 v99, a243
    v_mfma_f32_16x16x32_bf16 v[216:219], a[132:135], v[76:79], v[216:219]
    v_lshlrev_b32_e64 v114, 16, v99
    v_and_b32 v115, 0xffff0000, v99
    v_mfma_f32_16x16x32_bf16 v[160:163], a[136:139], v[64:67], v[160:163]
    buffer_load_dwordx4 a[196:199], v4, s[8:11], s63 offen offset:1024 sc1
    v_mfma_f32_16x16x32_bf16 v[180:183], a[136:139], v[68:71], v[180:183]
    v_accvgpr_read_b32 v100, a244
    v_mfma_f32_16x16x32_bf16 v[200:203], a[136:139], v[72:75], v[200:203]
    v_lshlrev_b32_e64 v116, 16, v100
    v_and_b32 v117, 0xffff0000, v100
    v_mfma_f32_16x16x32_bf16 v[220:223], a[136:139], v[76:79], v[220:223]
    v_accvgpr_read_b32 v101, a245
    v_lshlrev_b32_e64 v118, 16, v101
    v_and_b32 v119, 0xffff0000, v101
    v_accvgpr_read_b32 v102, a246
    v_lshlrev_b32_e64 v120, 16, v102
    v_and_b32 v121, 0xffff0000, v102
    v_accvgpr_read_b32 v103, a247
    v_lshlrev_b32_e64 v122, 16, v103
    v_and_b32 v123, 0xffff0000, v103
    v_accvgpr_read_b32 v104, a248
    v_lshlrev_b32_e64 v124, 16, v104
    v_and_b32 v125, 0xffff0000, v104
    v_accvgpr_read_b32 v105, a249
    v_lshlrev_b32_e64 v126, 16, v105
    v_and_b32 v127, 0xffff0000, v105
    v_mul_f32 v106, v106, v106
    s_waitcnt vmcnt(16) lgkmcnt(0)
    v_mfma_f32_16x16x32_bf16 v[144:147], a[140:143], v[80:83], v[144:147]
    s_waitcnt vmcnt(9)
    v_mfma_f32_16x16x32_bf16 v[164:167], a[140:143], v[84:87], v[164:167]
    v_swap_b32 v34, v36
    v_mfma_f32_16x16x32_bf16 v[184:187], a[140:143], v[88:91], v[184:187]
    v_swap_b32 v35, v37
    v_mfma_f32_16x16x32_bf16 v[204:207], a[140:143], v[92:95], v[204:207]
    v_swap_b32 v42, v44
    v_mfma_f32_16x16x32_bf16 v[148:151], a[144:147], v[80:83], v[148:151]
    v_swap_b32 v43, v45
    v_mfma_f32_16x16x32_bf16 v[168:171], a[144:147], v[84:87], v[168:171]
    s_waitcnt vmcnt(2)
    v_mfma_f32_16x16x32_bf16 v[188:191], a[144:147], v[88:91], v[188:191]
    v_swap_b32 v50, v52
    v_mfma_f32_16x16x32_bf16 v[208:211], a[144:147], v[92:95], v[208:211]
    v_swap_b32 v51, v53
    v_mfma_f32_16x16x32_bf16 v[152:155], a[148:151], v[80:83], v[152:155]
    v_swap_b32 v58, v60
    v_mfma_f32_16x16x32_bf16 v[172:175], a[148:151], v[84:87], v[172:175]
    v_swap_b32 v59, v61
    v_mfma_f32_16x16x32_bf16 v[192:195], a[148:151], v[88:91], v[192:195]
    v_mfma_f32_16x16x32_bf16 v[212:215], a[148:151], v[92:95], v[212:215]
    v_mfma_f32_16x16x32_bf16 v[156:159], a[152:155], v[80:83], v[156:159]
    v_mfma_f32_16x16x32_bf16 v[176:179], a[152:155], v[84:87], v[176:179]
    v_mfma_f32_16x16x32_bf16 v[196:199], a[152:155], v[88:91], v[196:199]
    v_mfma_f32_16x16x32_bf16 v[216:219], a[152:155], v[92:95], v[216:219]
    v_mfma_f32_16x16x32_bf16 v[160:163], a[156:159], v[80:83], v[160:163]
    v_mfma_f32_16x16x32_bf16 v[180:183], a[156:159], v[84:87], v[180:183]
    v_mfma_f32_16x16x32_bf16 v[200:203], a[156:159], v[88:91], v[200:203]
    v_mfma_f32_16x16x32_bf16 v[220:223], a[156:159], v[92:95], v[220:223]
    s_waitcnt vmcnt(0)
    v_mfma_f32_16x16x32_bf16 v[164:167], a[160:163], v[36:39], v[164:167]
    v_mfma_f32_16x16x32_bf16 v[168:171], a[164:167], v[36:39], v[168:171]
    v_mfma_f32_16x16x32_bf16 v[172:175], a[168:171], v[36:39], v[172:175]
    v_mfma_f32_16x16x32_bf16 v[176:179], a[172:175], v[36:39], v[176:179]
    v_mfma_f32_16x16x32_bf16 v[180:183], a[176:179], v[36:39], v[180:183]
    v_mfma_f32_16x16x32_bf16 v[164:167], a[180:183], v[52:55], v[164:167]
    v_mfma_f32_16x16x32_bf16 v[168:171], a[184:187], v[52:55], v[168:171]
    v_mfma_f32_16x16x32_bf16 v[172:175], a[188:191], v[52:55], v[172:175]
    v_mfma_f32_16x16x32_bf16 v[176:179], a[192:195], v[52:55], v[176:179]
    v_mfma_f32_16x16x32_bf16 v[180:183], a[196:199], v[52:55], v[180:183]
    v_mfma_f32_16x16x32_bf16 v[184:187], a[160:163], v[40:43], v[184:187]
    v_mfma_f32_16x16x32_bf16 v[188:191], a[164:167], v[40:43], v[188:191]
    s_nop 1
    ds_write_b128 v16, v[164:167] offset:0
    v_mfma_f32_16x16x32_bf16 v[192:195], a[168:171], v[40:43], v[192:195]
    v_mfma_f32_16x16x32_bf16 v[196:199], a[172:175], v[40:43], v[196:199]
    ds_write_b128 v16, v[168:171] offset:1024
    v_mfma_f32_16x16x32_bf16 v[200:203], a[176:179], v[40:43], v[200:203]
    v_mfma_f32_16x16x32_bf16 v[184:187], a[180:183], v[56:59], v[184:187]
    ds_write_b128 v16, v[172:175] offset:2048
    v_mfma_f32_16x16x32_bf16 v[188:191], a[184:187], v[56:59], v[188:191]
    v_mfma_f32_16x16x32_bf16 v[192:195], a[188:191], v[56:59], v[192:195]
    ds_write_b128 v16, v[176:179] offset:3072
    v_mfma_f32_16x16x32_bf16 v[196:199], a[192:195], v[56:59], v[196:199]
    v_mfma_f32_16x16x32_bf16 v[200:203], a[196:199], v[56:59], v[200:203]
    ds_write_b128 v16, v[180:183] offset:4096
    v_mfma_f32_16x16x32_bf16 v[204:207], a[160:163], v[44:47], v[204:207]
    v_mfma_f32_16x16x32_bf16 v[208:211], a[164:167], v[44:47], v[208:211]
    ds_write_b128 v17, v[184:187] offset:5120
    v_mfma_f32_16x16x32_bf16 v[212:215], a[168:171], v[44:47], v[212:215]
    v_mfma_f32_16x16x32_bf16 v[216:219], a[172:175], v[44:47], v[216:219]
    ds_write_b128 v17, v[188:191] offset:6144
    v_mfma_f32_16x16x32_bf16 v[220:223], a[176:179], v[44:47], v[220:223]
    v_mfma_f32_16x16x32_bf16 v[204:207], a[180:183], v[60:63], v[204:207]
    ds_write_b128 v17, v[192:195] offset:7168
    v_mfma_f32_16x16x32_bf16 v[208:211], a[184:187], v[60:63], v[208:211]
    v_mfma_f32_16x16x32_bf16 v[212:215], a[188:191], v[60:63], v[212:215]
    ds_write_b128 v17, v[196:199] offset:8192
    v_mfma_f32_16x16x32_bf16 v[216:219], a[192:195], v[60:63], v[216:219]
    v_mfma_f32_16x16x32_bf16 v[220:223], a[196:199], v[60:63], v[220:223]
    ds_write_b128 v17, v[200:203] offset:9216
    v_mfma_f32_16x16x32_bf16 v[144:147], a[160:163], v[32:35], v[144:147]
    v_mfma_f32_16x16x32_bf16 v[148:151], a[164:167], v[32:35], v[148:151]
    ds_write_b128 v18, v[204:207] offset:10240
    v_mfma_f32_16x16x32_bf16 v[152:155], a[168:171], v[32:35], v[152:155]
    v_mfma_f32_16x16x32_bf16 v[156:159], a[172:175], v[32:35], v[156:159]
    ds_write_b128 v18, v[208:211] offset:11264
    v_mfma_f32_16x16x32_bf16 v[160:163], a[176:179], v[32:35], v[160:163]
    v_mfma_f32_16x16x32_bf16 v[144:147], a[180:183], v[48:51], v[144:147]
    ds_write_b128 v18, v[212:215] offset:12288
    v_mfma_f32_16x16x32_bf16 v[148:151], a[184:187], v[48:51], v[148:151]
    v_mfma_f32_16x16x32_bf16 v[152:155], a[188:191], v[48:51], v[152:155]
    ds_write_b128 v18, v[216:219] offset:13312
    v_mfma_f32_16x16x32_bf16 v[156:159], a[192:195], v[48:51], v[156:159]
    v_mfma_f32_16x16x32_bf16 v[160:163], a[196:199], v[48:51], v[160:163]
    ds_write_b128 v18, v[220:223] offset:14336
    s_waitcnt lgkmcnt(0)
    s_barrier
    ds_read_b128 v[32:35], v19 offset:0
    ds_read_b128 v[36:39], v19 offset:5120
    ds_read_b128 v[40:43], v19 offset:10240
    ds_read_b128 v[44:47], v19 offset:1024
    ds_read_b128 v[48:51], v19 offset:6144
    ds_read_b128 v[52:55], v19 offset:11264
    ds_read_b128 v[56:59], v19 offset:2048
    ds_read_b128 v[60:63], v19 offset:7168
    ds_read_b128 v[64:67], v19 offset:12288
    ds_read_b128 v[68:71], v19 offset:3072
    ds_read_b128 v[72:75], v19 offset:8192
    ds_read_b128 v[76:79], v19 offset:13312
    ds_read_b128 v[80:83], v19 offset:4096
    ds_read_b128 v[84:87], v19 offset:9216
    ds_read_b128 v[88:91], v19 offset:14336
    s_nop 0
    s_waitcnt lgkmcnt(12)
    v_pk_add_f32 v[144:145], v[144:145], v[32:33]
    v_pk_add_f32 v[36:37], v[36:37], v[40:41]
    v_pk_add_f32 v[146:147], v[146:147], v[34:35]
    v_pk_add_f32 v[38:39], v[38:39], v[42:43]
    v_pk_add_f32 v[144:145], v[144:145], v[36:37]
    v_pk_add_f32 v[146:147], v[146:147], v[38:39]
    v_pk_fma_f32 v[144:145], v[144:145], v[106:107], v[108:109] op_sel_hi:[1,0,1]
    v_pk_fma_f32 v[146:147], v[146:147], v[106:107], v[110:111] op_sel_hi:[1,0,1]
    v_cvt_pk_bf16_f32 v144, v144, v145
    v_cvt_pk_bf16_f32 v145, v146, v147
    buffer_store_dwordx2 v[144:145], v15, s[12:15], s77 offen offset:0
    s_nop 0
    s_waitcnt lgkmcnt(9)
    v_pk_add_f32 v[148:149], v[148:149], v[44:45]
    v_pk_add_f32 v[48:49], v[48:49], v[52:53]
    v_pk_add_f32 v[150:151], v[150:151], v[46:47]
    v_pk_add_f32 v[50:51], v[50:51], v[54:55]
    v_pk_add_f32 v[148:149], v[148:149], v[48:49]
    v_pk_add_f32 v[150:151], v[150:151], v[50:51]
    v_pk_fma_f32 v[148:149], v[148:149], v[106:107], v[112:113] op_sel_hi:[1,0,1]
    v_pk_fma_f32 v[150:151], v[150:151], v[106:107], v[114:115] op_sel_hi:[1,0,1]
    v_cvt_pk_bf16_f32 v148, v148, v149
    v_cvt_pk_bf16_f32 v149, v150, v151
    buffer_store_dwordx2 v[148:149], v15, s[12:15], s77 offen offset:32
    s_nop 0
    s_waitcnt lgkmcnt(6)
    v_pk_add_f32 v[152:153], v[152:153], v[56:57]
    v_pk_add_f32 v[60:61], v[60:61], v[64:65]
    v_pk_add_f32 v[154:155], v[154:155], v[58:59]
    v_pk_add_f32 v[62:63], v[62:63], v[66:67]
    v_pk_add_f32 v[152:153], v[152:153], v[60:61]
    v_pk_add_f32 v[154:155], v[154:155], v[62:63]
    v_pk_fma_f32 v[152:153], v[152:153], v[106:107], v[116:117] op_sel_hi:[1,0,1]
    v_pk_fma_f32 v[154:155], v[154:155], v[106:107], v[118:119] op_sel_hi:[1,0,1]
    v_cvt_pk_bf16_f32 v152, v152, v153
    v_cvt_pk_bf16_f32 v153, v154, v155
    buffer_store_dwordx2 v[152:153], v15, s[12:15], s77 offen offset:64
    s_nop 0
    s_waitcnt lgkmcnt(3)
    v_pk_add_f32 v[156:157], v[156:157], v[68:69]
    v_pk_add_f32 v[72:73], v[72:73], v[76:77]
    v_pk_add_f32 v[158:159], v[158:159], v[70:71]
    v_pk_add_f32 v[74:75], v[74:75], v[78:79]
    v_pk_add_f32 v[156:157], v[156:157], v[72:73]
    v_pk_add_f32 v[158:159], v[158:159], v[74:75]
    v_pk_fma_f32 v[156:157], v[156:157], v[106:107], v[120:121] op_sel_hi:[1,0,1]
    v_pk_fma_f32 v[158:159], v[158:159], v[106:107], v[122:123] op_sel_hi:[1,0,1]
    v_cvt_pk_bf16_f32 v156, v156, v157
    v_cvt_pk_bf16_f32 v157, v158, v159
    buffer_store_dwordx2 v[156:157], v15, s[12:15], s77 offen offset:96
    s_nop 0
    s_waitcnt lgkmcnt(0)
    v_pk_add_f32 v[160:161], v[160:161], v[80:81]
    v_pk_add_f32 v[84:85], v[84:85], v[88:89]
    v_pk_add_f32 v[162:163], v[162:163], v[82:83]
    v_pk_add_f32 v[86:87], v[86:87], v[90:91]
    v_pk_add_f32 v[160:161], v[160:161], v[84:85]
    v_pk_add_f32 v[162:163], v[162:163], v[86:87]
    v_pk_fma_f32 v[160:161], v[160:161], v[106:107], v[124:125] op_sel_hi:[1,0,1]
    v_pk_fma_f32 v[162:163], v[162:163], v[106:107], v[126:127] op_sel_hi:[1,0,1]
    v_cvt_pk_bf16_f32 v160, v160, v161
    v_cvt_pk_bf16_f32 v161, v162, v163
    buffer_store_dwordx2 v[160:161], v15, s[12:15], s77 offen offset:128
    s_endpgm
L_exit:
    s_endpgm
L_code_end:
.section .rodata,"a"
.p2align 6
.amdhsa_kernel sequential_preLN__ssm_conv_s4__glu_gated_reglu__prompt_kernel
  .amdhsa_next_free_vgpr 512
  .amdhsa_next_free_sgpr 102
  .amdhsa_accum_offset 256
  .amdhsa_group_segment_fixed_size 0
  .amdhsa_kernarg_size 128
  .amdhsa_user_sgpr_count 2
  .amdhsa_user_sgpr_kernarg_segment_ptr 1
  .amdhsa_system_sgpr_workgroup_id_x 1
.end_amdhsa_kernel
```
